```python
import torch

def _softmax(x, axis=-1):
    return torch.softmax(x, dim=axis)
def _gelu(x):
    return torch.nn.functional.gelu(x, approximate="tanh")
def _silu(x):
    return torch.nn.functional.silu(x)
def _sigmoid(x):
    return torch.sigmoid(x)
def _layernorm(x, axis=-1, eps=1e-5):
    m = x.mean(dim=axis, keepdim=True)
    v = x.var(dim=axis, keepdim=True, unbiased=False)
    return (x - m) / torch.sqrt(v + eps)
def _scatter_add(tgt, idx, src, axis=0):
    return tgt.clone().index_add_(axis, idx, src)
def _segment_sum(src, seg, n):
    out = torch.zeros((n,) + src.shape[1:], dtype=src.dtype)
    return out.index_add_(0, seg, src)
def _pad(x, pw):
    flat = tuple(v for pair in reversed(pw) for v in pair)
    return torch.nn.functional.pad(x, flat)

kernel_name = 'parallel_sum__softmax_full_mha__dense_activation_gelu__prompt'

def setup_inputs():

    _w = (lambda a: (lambda t: t.to(torch.bfloat16) if t.is_floating_point() else t)(torch.as_tensor(a)))
    def _A_setup():
        B, S, D = 1, 2048, 1024
        return {
            "x": _w((lambda *s: torch.randn(*s, dtype=torch.bfloat16) * 0.05)(B, S, D)),
            "wqkv": _w((lambda *s: torch.randn(*s, dtype=torch.bfloat16) * 0.05)(D, 3 * D)),
            "wo": _w((lambda *s: torch.randn(*s, dtype=torch.bfloat16) * 0.05)(D, D)),
        }
    _A_in = _A_setup()

    def _B_setup():
        B, S, D, F = 1, 2048, 1024, 3584
        return {
            "x": _w((lambda *s: torch.randn(*s, dtype=torch.bfloat16) * 0.05)(B, S, D)),
            "w1": _w((lambda *s: torch.randn(*s, dtype=torch.bfloat16) * 3.2)(D, F) * (D ** -0.5)),
            "b1": _w((lambda *s: torch.randn(*s, dtype=torch.bfloat16) * 3.2)(F) * 0.01),
            "w2": _w((lambda *s: torch.randn(*s, dtype=torch.bfloat16) * 0.4)(F, D) * (F ** -0.5)),
            "b2": _w((lambda *s: torch.randn(*s, dtype=torch.bfloat16) * 0.4)(D) * 0.01),
        }
    _B_in = _B_setup()

    return {
        "A_x": _A_in["x"],
        "A_wqkv": _A_in["wqkv"],
        "A_wo": _A_in["wo"],
        "B_x": _B_in["x"],
        "B_w1": _B_in["w1"],
        "B_b1": _B_in["b1"],
        "B_w2": _B_in["w2"],
        "B_b2": _B_in["b2"],
    }

def reference(A_x, A_wqkv, A_wo, B_x, B_w1, B_b1, B_w2, B_b2):
    def _A_ref(x, wqkv, wo):
        B, S, D = x.shape
        H = 32; Dh = D // H
        qkv = (lambda x, *d: x.permute(*d))((x @ wqkv).reshape(B, S, 3, H, Dh), 2, 0, 3, 1, 4)
        q, k, v = qkv[0], qkv[1], qkv[2]
        scale = Dh ** -0.5
        scores = torch.einsum("bhqd,bhkd->bhqk", q, k) * scale
        p = _softmax(scores, axis=-1)
        o = torch.einsum("bhqk,bhkd->bhqd", p, v)
        return (lambda x, *d: x.permute(*d))(o, 0, 2, 1, 3).reshape(B, S, D) @ wo

    def _B_ref(x, w1, b1, w2, b2):
        h = torch.einsum("bsd,df->bsf", x, w1) + b1
        h = _gelu(h)
        return torch.einsum("bsf,fd->bsd", h, w2) + b2

    x = A_x
    xn = _layernorm(x, axis=-1)
    return x + _A_ref(xn, A_wqkv, A_wo) + _B_ref(xn, B_w1, B_b1, B_w2, B_b2)
```

```asm
; @launch grid=(256,1,1) block=(512,1,1) lds=163840
.amdgcn_target "amdgcn-amd-amdhsa--gfx950"
.text
.globl parallel_sum__softmax_full_mha__dense_activation_gelu__prompt_kernel
.p2align 8
.type parallel_sum__softmax_full_mha__dense_activation_gelu__prompt_kernel,@function
parallel_sum__softmax_full_mha__dense_activation_gelu__prompt_kernel:
    s_getpc_b64 s[96:97]
mk_code0:
    s_cmp_ge_u32 s2, 256
    s_cbranch_scc1 mk_end
    s_load_dwordx16 s[40:55], s[0:1], 0
    s_load_dwordx4 s[56:59], s[0:1], 64
    s_load_dwordx2 s[60:61], s[0:1], 80
    v_lshrrev_b32 v1, 6, v0
    v_and_b32 v0, 63, v0
    s_lshr_b32 s26, s2, 5
    v_readfirstlane_b32 s24, v1
    s_and_b32 s27, s2, 7
    s_lshl_b32 s27, s27, 2
    s_lshr_b32 s3, s2, 3
    s_and_b32 s3, s3, 3
    s_add_u32 s27, s27, s3
    v_lshlrev_b32 v3, 4, v0
    s_and_b32 s62, s24, 3
    s_mul_i32 s63, s26, 4
    s_lshr_b32 s63, s63, 3
    s_mul_i32 s63, s63, 8
    s_cmp_ge_u32 s24, 4
    s_cbranch_scc1 mk_w_entry
    v_bfe_u32 v16, v0, 2, 1
    v_lshlrev_b32 v16, 11, v16
    v_lshrrev_b32 v17, 3, v0
    v_lshl_add_u32 v16, v17, 6, v16
    v_and_b32 v18, 3, v0
    v_lshl_add_u32 v16, v18, 4, v16
    s_lshl_b32 s38, s2, 2
    s_add_u32 s38, s38, s62
    s_lshl_b32 s3, s38, 12
    s_lshl_b32 s4, s26, 8
    s_lshl_b32 s5, s62, 6
    s_add_u32 s4, s4, s5
    s_lshl_b32 s4, s4, 11
    v_lshlrev_b32 v17, 11, v17
    v_add_u32 v17, s4, v17
    v_and_b32 v18, 7, v0
    v_lshrrev_b32 v19, 4, v0
    v_xor_b32 v18, v18, v19
    v_lshlrev_b32 v19, 4, v18
    v_xor_b32 v20, 64, v19
    v_add_u32 v4, v17, v19
    v_add_u32 v5, v17, v20
    v_add_u32 v5, 15360, v5
    v_add_u32 v6, 30720, v4
    v_add_u32 v7, 30720, v5
    s_lshl_b32 s39, s62, 13
    s_lshl_b32 s28, s63, 6
    s_waitcnt lgkmcnt(0)
    s_mov_b32 s16, s40
    s_mov_b32 s17, s41
    s_mov_b32 s18, 0x400000
    s_mov_b32 s19, 0x00020000
    v_mov_b32 v21, v16
    s_mov_b32 s7, s3
    buffer_load_dwordx4 v[32:35], v21, s[16:19], s7 offen offset:0
    buffer_load_dwordx4 v[36:39], v21, s[16:19], s7 offen offset:512
    buffer_load_dwordx4 v[40:43], v21, s[16:19], s7 offen offset:1024
    buffer_load_dwordx4 v[44:47], v21, s[16:19], s7 offen offset:1536
    s_mov_b32 m0, s39
    s_nop 0
    buffer_load_dwordx4 v4, s[16:19], s28 offen  lds
    buffer_load_dwordx4 v5, s[16:19], s28 offen offset:1024  lds
    buffer_load_dwordx4 v6, s[16:19], s28 offen offset:2048  lds
    buffer_load_dwordx4 v7, s[16:19], s28 offen offset:3072  lds
    v_mov_b32 v128, 0
    v_mov_b32 v129, 0
    v_mov_b32 v130, 0
    v_mov_b32 v131, 0
    v_mov_b32 v132, 0
    v_mov_b32 v133, 0
    v_mov_b32 v134, 0
    v_mov_b32 v135, 0
    v_mov_b32 v136, 0
    v_mov_b32 v137, 0
    v_mov_b32 v138, 0
    v_mov_b32 v139, 0
    v_mov_b32 v140, 0
    v_mov_b32 v141, 0
    v_mov_b32 v142, 0
    v_mov_b32 v143, 0
    v_mov_b32 v144, 0
    v_mov_b32 v145, 0
    v_mov_b32 v146, 0
    v_mov_b32 v147, 0
    v_mov_b32 v148, 0
    v_mov_b32 v149, 0
    v_mov_b32 v150, 0
    v_mov_b32 v151, 0
    v_mov_b32 v152, 0
    v_mov_b32 v153, 0
    v_mov_b32 v154, 0
    v_mov_b32 v155, 0
    v_mov_b32 v156, 0
    v_mov_b32 v157, 0
    v_mov_b32 v158, 0
    v_mov_b32 v159, 0
    v_mov_b32 v160, 0
    v_mov_b32 v161, 0
    v_mov_b32 v162, 0
    v_mov_b32 v163, 0
    v_mov_b32 v164, 0
    v_mov_b32 v165, 0
    v_mov_b32 v166, 0
    v_mov_b32 v167, 0
    v_mov_b32 v168, 0
    v_mov_b32 v169, 0
    v_mov_b32 v170, 0
    v_mov_b32 v171, 0
    v_mov_b32 v172, 0
    v_mov_b32 v173, 0
    v_mov_b32 v174, 0
    v_mov_b32 v175, 0
    v_mov_b32 v176, 0
    v_mov_b32 v177, 0
    v_mov_b32 v178, 0
    v_mov_b32 v179, 0
    v_mov_b32 v180, 0
    v_mov_b32 v181, 0
    v_mov_b32 v182, 0
    v_mov_b32 v183, 0
    v_mov_b32 v184, 0
    v_mov_b32 v185, 0
    v_mov_b32 v186, 0
    v_mov_b32 v187, 0
    v_mov_b32 v188, 0
    v_mov_b32 v189, 0
    v_mov_b32 v190, 0
    v_mov_b32 v191, 0
    v_mov_b32 v192, 0
    v_mov_b32 v193, 0
    v_mov_b32 v194, 0
    v_mov_b32 v195, 0
    v_mov_b32 v196, 0
    v_mov_b32 v197, 0
    v_mov_b32 v198, 0
    v_mov_b32 v199, 0
    v_mov_b32 v200, 0
    v_mov_b32 v201, 0
    v_mov_b32 v202, 0
    v_mov_b32 v203, 0
    v_mov_b32 v204, 0
    v_mov_b32 v205, 0
    v_mov_b32 v206, 0
    v_mov_b32 v207, 0
    v_mov_b32 v208, 0
    v_mov_b32 v209, 0
    v_mov_b32 v210, 0
    v_mov_b32 v211, 0
    v_mov_b32 v212, 0
    v_mov_b32 v213, 0
    v_mov_b32 v214, 0
    v_mov_b32 v215, 0
    v_mov_b32 v216, 0
    v_mov_b32 v217, 0
    v_mov_b32 v218, 0
    v_mov_b32 v219, 0
    v_mov_b32 v220, 0
    v_mov_b32 v221, 0
    v_mov_b32 v222, 0
    v_mov_b32 v223, 0
    v_mov_b32 v120, 0
    v_mov_b32 v121, 0
    v_mov_b32 v122, 0
    v_mov_b32 v123, 0
    v_mov_b32 v124, 0
    v_mov_b32 v125, 0
    v_mov_b32 v126, 0
    v_mov_b32 v127, 0
    v_mov_b32 v240, 0
    v_mov_b32 v241, 0
    v_mov_b32 v242, 0
    v_mov_b32 v243, 0
    v_mov_b32 v244, 0
    v_mov_b32 v245, 0
    v_mov_b32 v246, 0
    v_mov_b32 v247, 0
    v_mov_b32 v248, 0
    v_mov_b32 v249, 0
    v_mov_b32 v250, 0
    v_mov_b32 v251, 0
    v_mov_b32 v252, 0
    v_mov_b32 v253, 0
    v_mov_b32 v254, 0
    v_mov_b32 v255, 0
    v_mov_b32 v24, 0x3f803f80
    v_mov_b32 v25, 0x3f803f80
    v_mov_b32 v26, 0x3f803f80
    v_mov_b32 v27, 0x3f803f80
    s_add_u32 s3, s28, 65536
    s_add_u32 m0, s39, 4096
    s_nop 0
    buffer_load_dwordx4 v4, s[16:19], s3 offen  lds
    buffer_load_dwordx4 v5, s[16:19], s3 offen offset:1024  lds
    buffer_load_dwordx4 v6, s[16:19], s3 offen offset:2048  lds
    buffer_load_dwordx4 v7, s[16:19], s3 offen offset:3072  lds
    s_add_u32 s4, s60, 50331648
    s_addc_u32 s5, s61, 0
    s_load_dword s25, s[4:5], 0
    s_mov_b32 s8, s60
    s_mov_b32 s9, s61
    s_mov_b32 s10, 0x10000000
    s_mov_b32 s11, 0x00020000
    s_mov_b32 s12, s48
    s_mov_b32 s13, s49
    s_mov_b32 s14, 0x700000
    s_mov_b32 s15, 0x00020000
    s_mov_b32 s30, 229376
    s_mul_i32 s29, s63, s30
    s_lshl_b32 s3, s24, 6
    s_add_u32 s3, s3, 192
    v_add_u32 v16, s3, v0
    s_mul_i32 s6, s27, 224
    s_lshl_b32 s32, s24, 10
    s_add_u32 s32, s32, 107520
    v_mul_u32_u24 v17, 4682, v16
    v_lshrrev_b32 v17, 16, v17
    v_mul_u32_u24 v18, 14, v17
    v_sub_u32 v18, v16, v18
    v_lshlrev_b32 v18, 4, v18
    v_and_b32 v11, 0x13, v17
    v_bfe_u32 v16, v17, 2, 1
    v_lshl_or_b32 v11, v16, 3, v11
    v_bfe_u32 v16, v17, 3, 1
    v_lshl_or_b32 v11, v16, 2, v11
    v_mul_u32_u24 v11, 7168, v11
    v_add3_u32 v11, v11, v18, s6
    s_add_u32 m0, s32, 0
    s_nop 0
    buffer_load_dwordx4 v11, s[12:15], s29 offen  lds
    s_add_u32 s29, s29, s30
    s_cmp_eq_u32 s29, 7340032
    s_cselect_b32 s29, 0, s29
    s_add_u32 m0, s32, 13312
    s_nop 0
    buffer_load_dwordx4 v11, s[12:15], s29 offen  lds
    s_add_u32 s29, s29, s30
    s_cmp_eq_u32 s29, 7340032
    s_cselect_b32 s29, 0, s29
    v_and_b32 v16, 15, v0
    s_lshl_b32 s3, s62, 13
    v_lshlrev_b32 v17, 7, v16
    v_add_u32 v17, s3, v17
    v_bfe_u32 v18, v0, 1, 3
    v_lshrrev_b32 v19, 4, v0
    v_xor_b32 v18, v18, v19
    v_lshl_add_u32 v8, v18, 4, v17
    v_xor_b32 v9, 64, v8
    v_lshrrev_b32 v16, 5, v0
    v_lshlrev_b32 v16, 4, v16
    v_bfe_u32 v17, v0, 4, 1
    v_lshl_add_u32 v16, v17, 2, v16
    v_bfe_u32 v18, v0, 2, 2
    v_add_u32 v16, v16, v18
    v_and_b32 v18, 3, v0
    v_lshlrev_b32 v18, 3, v18
    s_mov_b32 s33, 0
    s_mov_b32 s34, 0
    s_mov_b32 s35, 0
    v_mul_u32_u24 v16, 192, v16
    v_add_u32 v16, v16, v18
    v_add_u32 v16, 98304, v16
    v_lshlrev_b32 v17, 5, v17
    v_add_u32 v10, v16, v17
    v_sub_u32 v15, v16, v17
    v_mov_b32 v13, v10
    v_mov_b32 v14, v15
    s_and_b32 s3, s26, 1
    s_lshl_b32 s3, s3, 1
    s_lshl_b32 s36, 3, s3
    s_cmp_eq_u32 s24, 0
    s_cselect_b32 s36, s36, 0
    s_cselect_b32 s37, 80, 0
    s_cmp_eq_u32 s24, 1
    s_cselect_b32 s37, 51200, s37
    s_lshl_b32 s3, s62, 8
    s_add_u32 s3, s3, 162048
    v_lshl_add_u32 v16, v0, 2, s3
    ds_write_b32 v16, v128
    v_mov_b32 v16, 163072
    ds_write_b64 v16, v[128:129]
    s_waitcnt vmcnt(10)
    v_lshlrev_b32 v64, 16, v32
    v_and_b32 v65, 0xffff0000, v32
    v_lshlrev_b32 v66, 16, v33
    v_and_b32 v67, 0xffff0000, v33
    v_lshlrev_b32 v68, 16, v34
    v_and_b32 v69, 0xffff0000, v34
    v_lshlrev_b32 v70, 16, v35
    v_and_b32 v71, 0xffff0000, v35
    v_lshlrev_b32 v72, 16, v36
    v_and_b32 v73, 0xffff0000, v36
    v_lshlrev_b32 v74, 16, v37
    v_and_b32 v75, 0xffff0000, v37
    v_lshlrev_b32 v76, 16, v38
    v_and_b32 v77, 0xffff0000, v38
    v_lshlrev_b32 v78, 16, v39
    v_and_b32 v79, 0xffff0000, v39
    v_lshlrev_b32 v80, 16, v40
    v_and_b32 v81, 0xffff0000, v40
    v_lshlrev_b32 v82, 16, v41
    v_and_b32 v83, 0xffff0000, v41
    v_lshlrev_b32 v84, 16, v42
    v_and_b32 v85, 0xffff0000, v42
    v_lshlrev_b32 v86, 16, v43
    v_and_b32 v87, 0xffff0000, v43
    v_lshlrev_b32 v88, 16, v44
    v_and_b32 v89, 0xffff0000, v44
    v_lshlrev_b32 v90, 16, v45
    v_and_b32 v91, 0xffff0000, v45
    v_lshlrev_b32 v92, 16, v46
    v_and_b32 v93, 0xffff0000, v46
    v_lshlrev_b32 v94, 16, v47
    v_and_b32 v95, 0xffff0000, v47
    v_add_f32 v48, v64, v68
    v_add_f32 v49, v65, v69
    v_add_f32 v50, v66, v70
    v_add_f32 v51, v67, v71
    v_add_f32 v48, v48, v72
    v_add_f32 v49, v49, v73
    v_add_f32 v50, v50, v74
    v_add_f32 v51, v51, v75
    v_add_f32 v48, v48, v76
    v_add_f32 v49, v49, v77
    v_add_f32 v50, v50, v78
    v_add_f32 v51, v51, v79
    v_add_f32 v48, v48, v80
    v_add_f32 v49, v49, v81
    v_add_f32 v50, v50, v82
    v_add_f32 v51, v51, v83
    v_add_f32 v48, v48, v84
    v_add_f32 v49, v49, v85
    v_add_f32 v50, v50, v86
    v_add_f32 v51, v51, v87
    v_add_f32 v48, v48, v88
    v_add_f32 v49, v49, v89
    v_add_f32 v50, v50, v90
    v_add_f32 v51, v51, v91
    v_add_f32 v48, v48, v92
    v_add_f32 v49, v49, v93
    v_add_f32 v50, v50, v94
    v_add_f32 v51, v51, v95
    v_add_f32 v48, v48, v49
    v_add_f32 v50, v50, v51
    v_add_f32 v48, v48, v50
    s_nop 1
    v_add_f32_dpp v48, v48, v48 quad_perm:[1,0,3,2] row_mask:0xf bank_mask:0xf
    s_nop 1
    v_add_f32_dpp v48, v48, v48 quad_perm:[2,3,0,1] row_mask:0xf bank_mask:0xf
    s_nop 1
    v_add_f32_dpp v48, v48, v48 row_ror:8 row_mask:0xf bank_mask:0xf
    v_mov_b32 v49, v48
    s_nop 1
    v_permlane16_swap_b32 v48, v49
    s_nop 1
    v_add_f32 v48, v48, v49
    v_mov_b32 v49, v48
    s_nop 1
    v_permlane32_swap_b32 v48, v49
    s_nop 1
    v_add_f32 v48, v48, v49
    v_mul_f32 v52, 0x3a800000, v48
    v_sub_f32 v64, v64, v52
    v_sub_f32 v65, v65, v52
    v_sub_f32 v66, v66, v52
    v_sub_f32 v67, v67, v52
    v_sub_f32 v68, v68, v52
    v_sub_f32 v69, v69, v52
    v_sub_f32 v70, v70, v52
    v_sub_f32 v71, v71, v52
    v_sub_f32 v72, v72, v52
    v_sub_f32 v73, v73, v52
    v_sub_f32 v74, v74, v52
    v_sub_f32 v75, v75, v52
    v_sub_f32 v76, v76, v52
    v_sub_f32 v77, v77, v52
    v_sub_f32 v78, v78, v52
    v_sub_f32 v79, v79, v52
    v_sub_f32 v80, v80, v52
    v_sub_f32 v81, v81, v52
    v_sub_f32 v82, v82, v52
    v_sub_f32 v83, v83, v52
    v_sub_f32 v84, v84, v52
    v_sub_f32 v85, v85, v52
    v_sub_f32 v86, v86, v52
    v_sub_f32 v87, v87, v52
    v_sub_f32 v88, v88, v52
    v_sub_f32 v89, v89, v52
    v_sub_f32 v90, v90, v52
    v_sub_f32 v91, v91, v52
    v_sub_f32 v92, v92, v52
    v_sub_f32 v93, v93, v52
    v_sub_f32 v94, v94, v52
    v_sub_f32 v95, v95, v52
    v_mul_f32 v48, v64, v64
    v_mul_f32 v49, v65, v65
    v_mul_f32 v50, v66, v66
    v_mul_f32 v51, v67, v67
    v_fmac_f32 v48, v68, v68
    v_fmac_f32 v49, v69, v69
    v_fmac_f32 v50, v70, v70
    v_fmac_f32 v51, v71, v71
    v_fmac_f32 v48, v72, v72
    v_fmac_f32 v49, v73, v73
    v_fmac_f32 v50, v74, v74
    v_fmac_f32 v51, v75, v75
    v_fmac_f32 v48, v76, v76
    v_fmac_f32 v49, v77, v77
    v_fmac_f32 v50, v78, v78
    v_fmac_f32 v51, v79, v79
    v_fmac_f32 v48, v80, v80
    v_fmac_f32 v49, v81, v81
    v_fmac_f32 v50, v82, v82
    v_fmac_f32 v51, v83, v83
    v_fmac_f32 v48, v84, v84
    v_fmac_f32 v49, v85, v85
    v_fmac_f32 v50, v86, v86
    v_fmac_f32 v51, v87, v87
    v_fmac_f32 v48, v88, v88
    v_fmac_f32 v49, v89, v89
    v_fmac_f32 v50, v90, v90
    v_fmac_f32 v51, v91, v91
    v_fmac_f32 v48, v92, v92
    v_fmac_f32 v49, v93, v93
    v_fmac_f32 v50, v94, v94
    v_fmac_f32 v51, v95, v95
    v_add_f32 v48, v48, v49
    v_add_f32 v50, v50, v51
    v_add_f32 v48, v48, v50
    s_nop 1
    v_add_f32_dpp v48, v48, v48 quad_perm:[1,0,3,2] row_mask:0xf bank_mask:0xf
    s_nop 1
    v_add_f32_dpp v48, v48, v48 quad_perm:[2,3,0,1] row_mask:0xf bank_mask:0xf
    s_nop 1
    v_add_f32_dpp v48, v48, v48 row_ror:8 row_mask:0xf bank_mask:0xf
    v_mov_b32 v49, v48
    s_nop 1
    v_permlane16_swap_b32 v48, v49
    s_nop 1
    v_add_f32 v48, v48, v49
    v_mov_b32 v49, v48
    s_nop 1
    v_permlane32_swap_b32 v48, v49
    s_nop 1
    v_add_f32 v48, v48, v49
    v_mov_b32 v50, 0x3727c5ac
    v_fmac_f32 v50, 0x3a800000, v48
    v_rsq_f32 v50, v50
    v_lshlrev_b32 v53, 1, v0
    s_lshl_b32 s3, s38, 4
    s_add_u32 s3, s3, 50397184
    v_mul_f32 v51, v52, v50
    v_sub_f32 v51, 0, v51
    s_mov_b64 exec, 0x11
    buffer_store_dwordx2 v[50:51], v53, s[8:11], s3 offen sc1
    s_mov_b64 exec, -1
    s_waitcnt vmcnt(2) lgkmcnt(0)
    s_add_u32 s25, s25, 1
    s_barrier
    ds_read_b128 v[32:35], v8 offset:0
    ds_read_b128 v[36:39], v8 offset:2048
    ds_read_b128 v[40:43], v8 offset:4096
    ds_read_b128 v[44:47], v8 offset:6144
    ds_read_b64_tr_b16 v[48:49], v13 offset:0
    ds_read_b64_tr_b16 v[50:51], v13 offset:1536
    ds_read_b64_tr_b16 v[52:53], v14 offset:32
    ds_read_b64_tr_b16 v[54:55], v14 offset:1568
    ds_read_b64_tr_b16 v[56:57], v13 offset:64
    ds_read_b64_tr_b16 v[58:59], v13 offset:1600
    ds_read_b64_tr_b16 v[60:61], v14 offset:96
    ds_read_b64_tr_b16 v[62:63], v14 offset:1632
    ds_read_b64_tr_b16 v[64:65], v13 offset:128
    ds_read_b64_tr_b16 v[66:67], v13 offset:1664
    ds_read_b64_tr_b16 v[68:69], v14 offset:160
    ds_read_b64_tr_b16 v[70:71], v14 offset:1696
    s_add_u32 s28, s28, 128
    s_and_b32 s28, s28, 0x7ff
    s_add_u32 m0, s39, 32768
    s_nop 0
    buffer_load_dwordx4 v4, s[16:19], s28 offen  lds
    buffer_load_dwordx4 v5, s[16:19], s28 offen offset:1024  lds
    buffer_load_dwordx4 v6, s[16:19], s28 offen offset:2048  lds
    buffer_load_dwordx4 v7, s[16:19], s28 offen offset:3072  lds
    s_add_u32 s3, s28, 65536
    s_add_u32 m0, s39, 36864
    s_nop 0
    buffer_load_dwordx4 v4, s[16:19], s3 offen  lds
    buffer_load_dwordx4 v5, s[16:19], s3 offen offset:1024  lds
    buffer_load_dwordx4 v6, s[16:19], s3 offen offset:2048  lds
    buffer_load_dwordx4 v7, s[16:19], s3 offen offset:3072  lds
    s_add_u32 m0, s32, 26624
    s_nop 0
    buffer_load_dwordx4 v11, s[12:15], s29 offen  lds
    s_add_u32 s29, s29, s30
    s_cmp_eq_u32 s29, 7340032
    s_cselect_b32 s29, 0, s29
    s_waitcnt vmcnt(9) lgkmcnt(0)
    s_barrier
    v_mfma_f32_16x16x32_bf16 v[128:131], v[48:51], v[32:35], v[128:131]
    v_add_u32 v12, s33, v9
    ds_read_b128 v[76:79], v12 offset:0
    v_mfma_f32_16x16x32_bf16 v[132:135], v[48:51], v[36:39], v[132:135]
    ds_read_b128 v[80:83], v12 offset:2048
    ds_read_b128 v[84:87], v12 offset:4096
    v_mfma_f32_16x16x32_bf16 v[136:139], v[48:51], v[40:43], v[136:139]
    ds_read_b128 v[88:91], v12 offset:6144
    ds_read_b64_tr_b16 v[92:93], v13 offset:13312
    v_mfma_f32_16x16x32_bf16 v[140:143], v[48:51], v[44:47], v[140:143]
    ds_read_b64_tr_b16 v[94:95], v13 offset:14848
    ds_read_b64_tr_b16 v[96:97], v14 offset:13344
    v_mfma_f32_16x16x32_bf16 v[144:147], v[52:55], v[32:35], v[144:147]
    ds_read_b64_tr_b16 v[98:99], v14 offset:14880
    ds_read_b64_tr_b16 v[100:101], v13 offset:13376
    v_mfma_f32_16x16x32_bf16 v[148:151], v[52:55], v[36:39], v[148:151]
    ds_read_b64_tr_b16 v[102:103], v13 offset:14912
    v_mfma_f32_16x16x32_bf16 v[152:155], v[52:55], v[40:43], v[152:155]
    ds_read_b64_tr_b16 v[104:105], v14 offset:13408
    v_mfma_f32_16x16x32_bf16 v[156:159], v[52:55], v[44:47], v[156:159]
    ds_read_b64_tr_b16 v[106:107], v14 offset:14944
    v_mfma_f32_16x16x32_bf16 v[160:163], v[56:59], v[32:35], v[160:163]
    ds_read_b64_tr_b16 v[108:109], v13 offset:13440
    v_mfma_f32_16x16x32_bf16 v[164:167], v[56:59], v[36:39], v[164:167]
    ds_read_b64_tr_b16 v[110:111], v13 offset:14976
    v_mfma_f32_16x16x32_bf16 v[168:171], v[56:59], v[40:43], v[168:171]
    ds_read_b64_tr_b16 v[112:113], v14 offset:13472
    v_mfma_f32_16x16x32_bf16 v[172:175], v[56:59], v[44:47], v[172:175]
    ds_read_b64_tr_b16 v[114:115], v14 offset:15008
    v_mfma_f32_16x16x32_bf16 v[176:179], v[60:63], v[32:35], v[176:179]
    v_mfma_f32_16x16x32_bf16 v[180:183], v[60:63], v[36:39], v[180:183]
    v_mfma_f32_16x16x32_bf16 v[184:187], v[60:63], v[40:43], v[184:187]
    v_mfma_f32_16x16x32_bf16 v[188:191], v[60:63], v[44:47], v[188:191]
    v_mfma_f32_16x16x32_bf16 v[192:195], v[64:67], v[32:35], v[192:195]
    v_mfma_f32_16x16x32_bf16 v[196:199], v[64:67], v[36:39], v[196:199]
    v_mfma_f32_16x16x32_bf16 v[200:203], v[64:67], v[40:43], v[200:203]
    v_mfma_f32_16x16x32_bf16 v[204:207], v[64:67], v[44:47], v[204:207]
    v_mfma_f32_16x16x32_bf16 v[208:211], v[68:71], v[32:35], v[208:211]
    v_mfma_f32_16x16x32_bf16 v[212:215], v[68:71], v[36:39], v[212:215]
    v_mfma_f32_16x16x32_bf16 v[216:219], v[68:71], v[40:43], v[216:219]
    v_mfma_f32_16x16x32_bf16 v[220:223], v[68:71], v[44:47], v[220:223]
    s_bitcmp1_b32 s36, s34
    s_cbranch_scc1 mk_qcsp
mk_qcspd:
    s_add_u32 s28, s28, 128
    s_and_b32 s28, s28, 0x7ff
    s_add_u32 s31, s39, 65536
    s_mov_b32 m0, s31
    s_nop 0
    buffer_load_dwordx4 v4, s[16:19], s28 offen  lds
    buffer_load_dwordx4 v5, s[16:19], s28 offen offset:1024  lds
    buffer_load_dwordx4 v6, s[16:19], s28 offen offset:2048  lds
    buffer_load_dwordx4 v7, s[16:19], s28 offen offset:3072  lds
    s_add_u32 m0, s32, 39936
    s_nop 0
    buffer_load_dwordx4 v11, s[12:15], s29 offen  lds
    s_add_u32 s29, s29, s30
    s_cmp_eq_u32 s29, 7340032
    s_cselect_b32 s29, 0, s29
    s_add_u32 s3, s28, 65536
    s_add_u32 m0, s31, 4096
    s_nop 0
    buffer_load_dwordx4 v4, s[16:19], s3 offen  lds
    buffer_load_dwordx4 v5, s[16:19], s3 offen offset:1024  lds
    buffer_load_dwordx4 v6, s[16:19], s3 offen offset:2048  lds
    buffer_load_dwordx4 v7, s[16:19], s3 offen offset:3072  lds
    s_add_u32 m0, s32, s35
    s_nop 0
    buffer_load_dwordx4 v11, s[12:15], s29 offen  lds
    s_add_u32 s29, s29, s30
    s_cmp_eq_u32 s29, 7340032
    s_cselect_b32 s29, 0, s29
    s_branch mk_qloop_s1
    .p2align 6
mk_qloop:
    ds_read_b64_tr_b16 v[102:103], v13 offset:14912
    v_mfma_f32_16x16x32_bf16 v[152:155], v[52:55], v[40:43], v[152:155]
    ds_read_b64_tr_b16 v[104:105], v14 offset:13408
    v_mfma_f32_16x16x32_bf16 v[156:159], v[52:55], v[44:47], v[156:159]
    ds_read_b64_tr_b16 v[106:107], v14 offset:14944
    v_mfma_f32_16x16x32_bf16 v[160:163], v[56:59], v[32:35], v[160:163]
    ds_read_b64_tr_b16 v[108:109], v13 offset:13440
    v_mfma_f32_16x16x32_bf16 v[164:167], v[56:59], v[36:39], v[164:167]
    ds_read_b64_tr_b16 v[110:111], v13 offset:14976
    v_mfma_f32_16x16x32_bf16 v[168:171], v[56:59], v[40:43], v[168:171]
    ds_read_b64_tr_b16 v[112:113], v14 offset:13472
    v_mfma_f32_16x16x32_bf16 v[172:175], v[56:59], v[44:47], v[172:175]
    ds_read_b64_tr_b16 v[114:115], v14 offset:15008
    v_mfma_f32_16x16x32_bf16 v[176:179], v[60:63], v[32:35], v[176:179]
    s_add_u32 s3, s28, 65536
    s_add_u32 m0, s31, 4096
    s_nop 0
    buffer_load_dwordx4 v4, s[16:19], s3 offen  lds
    v_mfma_f32_16x16x32_bf16 v[180:183], v[60:63], v[36:39], v[180:183]
    buffer_load_dwordx4 v5, s[16:19], s3 offen offset:1024  lds
    v_mfma_f32_16x16x32_bf16 v[184:187], v[60:63], v[40:43], v[184:187]
    buffer_load_dwordx4 v6, s[16:19], s3 offen offset:2048  lds
    v_mfma_f32_16x16x32_bf16 v[188:191], v[60:63], v[44:47], v[188:191]
    buffer_load_dwordx4 v7, s[16:19], s3 offen offset:3072  lds
    v_mfma_f32_16x16x32_bf16 v[192:195], v[64:67], v[32:35], v[192:195]
    s_add_u32 m0, s32, s35
    s_nop 0
    buffer_load_dwordx4 v11, s[12:15], s29 offen  lds
    v_mfma_f32_16x16x32_bf16 v[196:199], v[64:67], v[36:39], v[196:199]
    s_add_u32 s29, s29, s30
    s_cmp_eq_u32 s29, 7340032
    s_cselect_b32 s29, 0, s29
    v_mfma_f32_16x16x32_bf16 v[200:203], v[64:67], v[40:43], v[200:203]
    s_bitcmp1_b32 s36, s34
    s_cbranch_scc1 mk_qcs0
mk_qcs0d:
    v_mfma_f32_16x16x32_bf16 v[204:207], v[64:67], v[44:47], v[204:207]
    v_mfma_f32_16x16x32_bf16 v[208:211], v[68:71], v[32:35], v[208:211]
    v_mfma_f32_16x16x32_bf16 v[212:215], v[68:71], v[36:39], v[212:215]
    v_mfma_f32_16x16x32_bf16 v[216:219], v[68:71], v[40:43], v[216:219]
    v_mfma_f32_16x16x32_bf16 v[220:223], v[68:71], v[44:47], v[220:223]
mk_qloop_s1:
    s_waitcnt vmcnt(10) lgkmcnt(0)
    s_barrier
    v_mfma_f32_16x16x32_bf16 v[128:131], v[92:95], v[76:79], v[128:131]
    s_add_u32 s33, s33, 32768
    s_cmp_eq_u32 s33, 98304
    s_cselect_b32 s33, 0, s33
    s_add_u32 s7, s35, 13312
    s_xor_b32 s35, s35, 26624
    v_add_u32 v12, s33, v8
    v_add_u32 v13, s35, v10
    v_add_u32 v14, s35, v15
    ds_read_b128 v[32:35], v12 offset:0
    v_mfma_f32_16x16x32_bf16 v[132:135], v[92:95], v[80:83], v[132:135]
    ds_read_b128 v[36:39], v12 offset:2048
    ds_read_b128 v[40:43], v12 offset:4096
    v_mfma_f32_16x16x32_bf16 v[136:139], v[92:95], v[84:87], v[136:139]
    ds_read_b128 v[44:47], v12 offset:6144
    ds_read_b64_tr_b16 v[48:49], v13 offset:0
    v_mfma_f32_16x16x32_bf16 v[140:143], v[92:95], v[88:91], v[140:143]
    ds_read_b64_tr_b16 v[50:51], v13 offset:1536
    ds_read_b64_tr_b16 v[52:53], v14 offset:32
    v_mfma_f32_16x16x32_bf16 v[144:147], v[96:99], v[76:79], v[144:147]
    ds_read_b64_tr_b16 v[54:55], v14 offset:1568
    ds_read_b64_tr_b16 v[56:57], v13 offset:64
    v_mfma_f32_16x16x32_bf16 v[148:151], v[96:99], v[80:83], v[148:151]
    ds_read_b64_tr_b16 v[58:59], v13 offset:1600
    v_mfma_f32_16x16x32_bf16 v[152:155], v[96:99], v[84:87], v[152:155]
    ds_read_b64_tr_b16 v[60:61], v14 offset:96
    v_mfma_f32_16x16x32_bf16 v[156:159], v[96:99], v[88:91], v[156:159]
    ds_read_b64_tr_b16 v[62:63], v14 offset:1632
    v_mfma_f32_16x16x32_bf16 v[160:163], v[100:103], v[76:79], v[160:163]
    ds_read_b64_tr_b16 v[64:65], v13 offset:128
    v_mfma_f32_16x16x32_bf16 v[164:167], v[100:103], v[80:83], v[164:167]
    ds_read_b64_tr_b16 v[66:67], v13 offset:1664
    v_mfma_f32_16x16x32_bf16 v[168:171], v[100:103], v[84:87], v[168:171]
    ds_read_b64_tr_b16 v[68:69], v14 offset:160
    v_mfma_f32_16x16x32_bf16 v[172:175], v[100:103], v[88:91], v[172:175]
    ds_read_b64_tr_b16 v[70:71], v14 offset:1696
    v_mfma_f32_16x16x32_bf16 v[176:179], v[104:107], v[76:79], v[176:179]
    s_add_u32 s28, s28, 128
    s_and_b32 s28, s28, 0x7ff
    s_cmp_ge_u32 s34, 13
    s_cselect_b32 s28, 0x40000000, s28
    s_add_u32 s31, s31, 32768
    s_cmp_ge_u32 s31, 98304
    s_cselect_b32 s31, s39, s31
    s_mov_b32 m0, s31
    s_nop 0
    buffer_load_dwordx4 v4, s[16:19], s28 offen  lds
    v_mfma_f32_16x16x32_bf16 v[180:183], v[104:107], v[80:83], v[180:183]
    buffer_load_dwordx4 v5, s[16:19], s28 offen offset:1024  lds
    v_mfma_f32_16x16x32_bf16 v[184:187], v[104:107], v[84:87], v[184:187]
    buffer_load_dwordx4 v6, s[16:19], s28 offen offset:2048  lds
    v_mfma_f32_16x16x32_bf16 v[188:191], v[104:107], v[88:91], v[188:191]
    buffer_load_dwordx4 v7, s[16:19], s28 offen offset:3072  lds
    v_mfma_f32_16x16x32_bf16 v[192:195], v[108:111], v[76:79], v[192:195]
    s_add_u32 m0, s32, s7
    s_nop 0
    buffer_load_dwordx4 v11, s[12:15], s29 offen  lds
    v_mfma_f32_16x16x32_bf16 v[196:199], v[108:111], v[80:83], v[196:199]
    s_add_u32 s29, s29, s30
    s_cmp_eq_u32 s29, 7340032
    s_cselect_b32 s29, 0, s29
    s_cmp_eq_u32 s34, 13
    s_cselect_b32 s29, 0x40000000, s29
    v_mfma_f32_16x16x32_bf16 v[200:203], v[108:111], v[84:87], v[200:203]
    s_bitcmp1_b32 s36, s34
    s_cbranch_scc1 mk_qcs1
mk_qcs1d:
    v_mfma_f32_16x16x32_bf16 v[204:207], v[108:111], v[88:91], v[204:207]
    s_bitcmp1_b32 s37, s34
    s_cbranch_scc1 mk_qsp
mk_qspd:
    v_mfma_f32_16x16x32_bf16 v[208:211], v[112:115], v[76:79], v[208:211]
    v_mfma_f32_16x16x32_bf16 v[212:215], v[112:115], v[80:83], v[212:215]
    v_mfma_f32_16x16x32_bf16 v[216:219], v[112:115], v[84:87], v[216:219]
    v_mfma_f32_16x16x32_bf16 v[220:223], v[112:115], v[88:91], v[220:223]
    s_add_u32 s34, s34, 1
    s_cmp_eq_u32 s34, 16
    s_cbranch_scc1 mk_qloop_x
    s_waitcnt vmcnt(10) lgkmcnt(0)
    s_barrier
    v_mfma_f32_16x16x32_bf16 v[128:131], v[48:51], v[32:35], v[128:131]
    v_add_u32 v12, s33, v9
    ds_read_b128 v[76:79], v12 offset:0
    v_mfma_f32_16x16x32_bf16 v[132:135], v[48:51], v[36:39], v[132:135]
    ds_read_b128 v[80:83], v12 offset:2048
    ds_read_b128 v[84:87], v12 offset:4096
    v_mfma_f32_16x16x32_bf16 v[136:139], v[48:51], v[40:43], v[136:139]
    ds_read_b128 v[88:91], v12 offset:6144
    ds_read_b64_tr_b16 v[92:93], v13 offset:13312
    v_mfma_f32_16x16x32_bf16 v[140:143], v[48:51], v[44:47], v[140:143]
    ds_read_b64_tr_b16 v[94:95], v13 offset:14848
    ds_read_b64_tr_b16 v[96:97], v14 offset:13344
    v_mfma_f32_16x16x32_bf16 v[144:147], v[52:55], v[32:35], v[144:147]
    ds_read_b64_tr_b16 v[98:99], v14 offset:14880
    ds_read_b64_tr_b16 v[100:101], v13 offset:13376
    v_mfma_f32_16x16x32_bf16 v[148:151], v[52:55], v[36:39], v[148:151]
    s_branch mk_qloop
mk_qcsp:
    v_mfma_f32_16x16x32_bf16 v[120:123], v[48:51], v[24:27], v[120:123]
    v_mfma_f32_16x16x32_bf16 v[124:127], v[52:55], v[24:27], v[124:127]
    v_mfma_f32_16x16x32_bf16 v[240:243], v[56:59], v[24:27], v[240:243]
    v_mfma_f32_16x16x32_bf16 v[244:247], v[60:63], v[24:27], v[244:247]
    v_mfma_f32_16x16x32_bf16 v[248:251], v[64:67], v[24:27], v[248:251]
    v_mfma_f32_16x16x32_bf16 v[252:255], v[68:71], v[24:27], v[252:255]
    s_branch mk_qcspd
mk_qcs0:
    v_mfma_f32_16x16x32_bf16 v[120:123], v[48:51], v[24:27], v[120:123]
    v_mfma_f32_16x16x32_bf16 v[124:127], v[52:55], v[24:27], v[124:127]
    v_mfma_f32_16x16x32_bf16 v[240:243], v[56:59], v[24:27], v[240:243]
    v_mfma_f32_16x16x32_bf16 v[244:247], v[60:63], v[24:27], v[244:247]
    v_mfma_f32_16x16x32_bf16 v[248:251], v[64:67], v[24:27], v[248:251]
    v_mfma_f32_16x16x32_bf16 v[252:255], v[68:71], v[24:27], v[252:255]
    s_branch mk_qcs0d
mk_qcs1:
    v_mfma_f32_16x16x32_bf16 v[120:123], v[92:95], v[24:27], v[120:123]
    v_mfma_f32_16x16x32_bf16 v[124:127], v[96:99], v[24:27], v[124:127]
    v_mfma_f32_16x16x32_bf16 v[240:243], v[100:103], v[24:27], v[240:243]
    v_mfma_f32_16x16x32_bf16 v[244:247], v[104:107], v[24:27], v[244:247]
    v_mfma_f32_16x16x32_bf16 v[248:251], v[108:111], v[24:27], v[248:251]
    v_mfma_f32_16x16x32_bf16 v[252:255], v[112:115], v[24:27], v[252:255]
    s_branch mk_qcs1d
mk_qsp:
    s_cmp_eq_u32 s34, 4
    s_cbranch_scc1 mk_qsp_st
    s_cmp_eq_u32 s34, 11
    s_cbranch_scc1 mk_qsp_ld
    s_cmp_eq_u32 s34, 14
    s_cbranch_scc1 mk_qsp_ck
    s_cmp_eq_u32 s34, 15
    s_cbranch_scc1 mk_qsp_rd
    s_lshl_b32 s3, s2, 2
    s_add_u32 s3, s3, 50335744
    v_mov_b32 v1, s25
    v_mov_b32 v2, 0
    s_mov_b64 exec, 1
    buffer_store_dword v1, v2, s[8:11], s3 offen sc1
    s_mov_b64 exec, -1
    s_branch mk_qspd
mk_qsp_st:
    s_lshl_b32 s3, s27, 3
    s_add_u32 s3, s3, s26
    s_lshl_b32 s3, s3, 10
    s_add_u32 s3, s3, 50462720
    v_and_b32 v1, 48, v0
    v_and_b32 v2, 15, v0
    v_lshl_add_u32 v1, v2, 6, v1
    v_cmp_eq_u32 vcc, 1, v2
    s_nop 1
    v_cndmask_b32 v120, v120, v124, vcc
    v_cndmask_b32 v121, v121, v125, vcc
    v_cndmask_b32 v122, v122, v126, vcc
    v_cndmask_b32 v123, v123, v127, vcc
    v_cmp_eq_u32 vcc, 2, v2
    s_nop 1
    v_cndmask_b32 v120, v120, v240, vcc
    v_cndmask_b32 v121, v121, v241, vcc
    v_cndmask_b32 v122, v122, v242, vcc
    v_cndmask_b32 v123, v123, v243, vcc
    v_cmp_eq_u32 vcc, 3, v2
    s_nop 1
    v_cndmask_b32 v120, v120, v244, vcc
    v_cndmask_b32 v121, v121, v245, vcc
    v_cndmask_b32 v122, v122, v246, vcc
    v_cndmask_b32 v123, v123, v247, vcc
    v_cmp_eq_u32 vcc, 4, v2
    s_nop 1
    v_cndmask_b32 v120, v120, v248, vcc
    v_cndmask_b32 v121, v121, v249, vcc
    v_cndmask_b32 v122, v122, v250, vcc
    v_cndmask_b32 v123, v123, v251, vcc
    v_cmp_eq_u32 vcc, 5, v2
    s_nop 1
    v_cndmask_b32 v120, v120, v252, vcc
    v_cndmask_b32 v121, v121, v253, vcc
    v_cndmask_b32 v122, v122, v254, vcc
    v_cndmask_b32 v123, v123, v255, vcc
    s_mov_b32 exec_lo, 0x3f003f
    s_mov_b32 exec_hi, 0x3f003f
    buffer_store_dwordx4 v[120:123], v1, s[8:11], s3 offen sc1
    s_mov_b64 exec, -1
    s_branch mk_qspd
mk_qsp_ld:
    s_lshl_b32 s3, s26, 5
    v_add_u32 v20, s3, v0
    v_and_b32 v21, 7, v0
    v_lshlrev_b32 v21, 5, v21
    s_and_b32 s3, s2, 31
    v_add_u32 v21, s3, v21
    v_cmp_gt_u32 vcc, 32, v0
    s_mov_b32 s3, 50335744
    s_nop 0
    v_cndmask_b32 v20, v21, v20, vcc
    v_lshlrev_b32 v20, 2, v20
    buffer_load_dword v21, v20, s[8:11], s3 offen sc1
    s_branch mk_qspd
mk_qsp_ck:
    v_cmp_ne_u32 vcc, s25, v21
    s_cbranch_vccz mk_qsp_ok
    s_mov_b32 s3, 50335744
    s_mov_b32 s4, 200000
mk_poll0:
    buffer_load_dword v21, v20, s[8:11], s3 offen sc1
    s_waitcnt vmcnt(0)
    v_cmp_ne_u32 vcc, s25, v21
    s_cbranch_vccz mk_polld0
    s_sleep 2
    s_sub_u32 s4, s4, 1
    s_cmp_lg_u32 s4, 0
    s_cbranch_scc1 mk_poll0
mk_polld0:
mk_qsp_ok:
    s_lshl_b32 s3, s27, 13
    s_add_u32 s3, s3, 50462720
    s_mov_b32 m0, 151552
    s_add_u32 s4, s3, 4096
    buffer_load_dwordx4 v3, s[8:11], s3 offen offset:0 sc1 lds
    buffer_load_dwordx4 v3, s[8:11], s3 offen offset:1024 sc1 lds
    buffer_load_dwordx4 v3, s[8:11], s3 offen offset:2048 sc1 lds
    buffer_load_dwordx4 v3, s[8:11], s3 offen offset:3072 sc1 lds
    s_mov_b32 m0, 155648
    s_lshl_b32 s3, s26, 11
    buffer_load_dwordx4 v3, s[8:11], s4 offen offset:0 sc1 lds
    buffer_load_dwordx4 v3, s[8:11], s4 offen offset:1024 sc1 lds
    buffer_load_dwordx4 v3, s[8:11], s4 offen offset:2048 sc1 lds
    buffer_load_dwordx4 v3, s[8:11], s4 offen offset:3072 sc1 lds
    s_mov_b32 m0, 159744
    s_add_u32 s3, s3, 50397184
    buffer_load_dwordx4 v3, s[8:11], s3 offen offset:0 sc1 lds
    buffer_load_dwordx4 v3, s[8:11], s3 offen offset:1024 sc1 lds
    s_branch mk_qspd
mk_qsp_rd:
    s_waitcnt vmcnt(10)
    v_add_u32 v20, 151552, v3
    ds_read_b128 v[224:227], v20 offset:0
    ds_read_b128 v[228:231], v20 offset:1024
    ds_read_b128 v[232:235], v20 offset:2048
    ds_read_b128 v[236:239], v20 offset:3072
    ds_read_b128 v[240:243], v20 offset:4096
    ds_read_b128 v[244:247], v20 offset:5120
    ds_read_b128 v[248:251], v20 offset:6144
    ds_read_b128 v[252:255], v20 offset:7168
    s_waitcnt lgkmcnt(0)
    v_add_f32 v224, v224, v240
    v_add_f32 v225, v225, v241
    v_add_f32 v226, v226, v242
    v_add_f32 v227, v227, v243
    v_add_f32 v228, v228, v244
    v_add_f32 v229, v229, v245
    v_add_f32 v230, v230, v246
    v_add_f32 v231, v231, v247
    v_add_f32 v232, v232, v248
    v_add_f32 v233, v233, v249
    v_add_f32 v234, v234, v250
    v_add_f32 v235, v235, v251
    v_add_f32 v236, v236, v252
    v_add_f32 v237, v237, v253
    v_add_f32 v238, v238, v254
    v_add_f32 v239, v239, v255
    v_add_f32 v224, v224, v232
    v_add_f32 v225, v225, v233
    v_add_f32 v226, v226, v234
    v_add_f32 v227, v227, v235
    v_add_f32 v228, v228, v236
    v_add_f32 v229, v229, v237
    v_add_f32 v230, v230, v238
    v_add_f32 v231, v231, v239
    v_add_f32 v224, v224, v228
    v_add_f32 v225, v225, v229
    v_add_f32 v226, v226, v230
    v_add_f32 v227, v227, v231
    ds_write_b128 v20, v[224:227]
    s_branch mk_qspd
mk_qloop_x:
    s_waitcnt vmcnt(0) lgkmcnt(0)
    s_barrier
    s_setprio 2
    v_and_b32 v4, 15, v0
    v_lshlrev_b32 v4, 3, v4
    s_lshl_b32 s3, s62, 9
    s_add_u32 s3, s3, 159744
    v_add_u32 v4, s3, v4
    v_and_b32 v6, 48, v0
    v_add_u32 v5, 151552, v6
    v_lshrrev_b32 v6, 1, v6
    v_add_u32 v6, 161792, v6
    ds_read_b128 v[64:67], v5 offset:0
    ds_read_b128 v[68:71], v5 offset:64
    ds_read_b128 v[72:75], v5 offset:128
    ds_read_b128 v[76:79], v5 offset:192
    ds_read_b128 v[80:83], v5 offset:256
    ds_read_b128 v[84:87], v5 offset:320
    ds_read_b64 v[16:17], v4 offset:0
    ds_read_b64 v[18:19], v4 offset:128
    ds_read_b64 v[20:21], v4 offset:256
    ds_read_b64 v[22:23], v4 offset:384
    s_lshr_b32 s3, s62, 1
    s_lshl_b32 s3, s3, 14
    s_and_b32 s4, s62, 1
    s_lshl_b32 s4, s4, 12
    s_add_u32 s3, s3, s4
    v_add_u32 v9, s3, v3
    s_lshl_b32 s28, s27, 18
    s_add_u32 s28, s28, 4194304
    s_lshl_b32 s6, s26, 15
    s_add_u32 s6, s6, s3
    s_add_u32 s6, s6, s28
    s_add_u32 s7, s6, 8192
    v_lshrrev_b32 v7, 5, v0
    v_lshlrev_b32 v7, 4, v7
    v_and_b32 v8, 15, v0
    v_add_u32 v7, v7, v8
    v_lshlrev_b32 v7, 6, v7
    v_and_b32 v8, 16, v0
    v_add_u32 v7, v7, v8
    s_add_u32 s3, s3, 8192
    v_add_u32 v11, s3, v7
    s_lshl_b32 s3, s26, 3
    s_lshl_b32 s4, s62, 1
    s_add_u32 s33, s3, s4
    s_waitcnt lgkmcnt(0)
    v_mul_f32 v108, 0x3e8293ee, v16
    v_mul_f32 v109, 0x3e8293ee, v17
    v_mul_f32 v110, 0x3e8293ee, v18
    v_mul_f32 v111, 0x3e8293ee, v19
    v_mul_f32 v112, 0x3e8293ee, v20
    v_mul_f32 v113, 0x3e8293ee, v21
    v_mul_f32 v114, 0x3e8293ee, v22
    v_mul_f32 v115, 0x3e8293ee, v23
    v_pk_mul_f32 v[96:97], v[16:17], v[80:81] op_sel:[1,0] op_sel_hi:[1,1]
    v_pk_mul_f32 v[98:99], v[16:17], v[82:83] op_sel:[1,0] op_sel_hi:[1,1]
    v_pk_fma_f32 v[192:193], v[16:17], v[192:193], v[96:97] op_sel:[0,0,0] op_sel_hi:[0,1,1]
    v_pk_fma_f32 v[194:195], v[16:17], v[194:195], v[98:99] op_sel:[0,0,0] op_sel_hi:[0,1,1]
    v_pk_mul_f32 v[100:101], v[18:19], v[80:81] op_sel:[1,0] op_sel_hi:[1,1]
    v_pk_mul_f32 v[102:103], v[18:19], v[82:83] op_sel:[1,0] op_sel_hi:[1,1]
    v_pk_fma_f32 v[196:197], v[18:19], v[196:197], v[100:101] op_sel:[0,0,0] op_sel_hi:[0,1,1]
    v_pk_fma_f32 v[198:199], v[18:19], v[198:199], v[102:103] op_sel:[0,0,0] op_sel_hi:[0,1,1]
    v_cvt_pk_bf16_f32 v48, v192, v193
    v_cvt_pk_bf16_f32 v49, v194, v195
    v_cvt_pk_bf16_f32 v50, v196, v197
    v_cvt_pk_bf16_f32 v51, v198, v199
    s_nop 1
    v_permlane32_swap_b32 v48, v50
    v_permlane32_swap_b32 v49, v51
    ds_write_b128 v11, v[48:51] offset:0
    v_pk_mul_f32 v[96:97], v[20:21], v[80:81] op_sel:[1,0] op_sel_hi:[1,1]
    v_pk_mul_f32 v[98:99], v[20:21], v[82:83] op_sel:[1,0] op_sel_hi:[1,1]
    v_pk_fma_f32 v[200:201], v[20:21], v[200:201], v[96:97] op_sel:[0,0,0] op_sel_hi:[0,1,1]
    v_pk_fma_f32 v[202:203], v[20:21], v[202:203], v[98:99] op_sel:[0,0,0] op_sel_hi:[0,1,1]
    v_pk_mul_f32 v[100:101], v[22:23], v[80:81] op_sel:[1,0] op_sel_hi:[1,1]
    v_pk_mul_f32 v[102:103], v[22:23], v[82:83] op_sel:[1,0] op_sel_hi:[1,1]
    v_pk_fma_f32 v[204:205], v[22:23], v[204:205], v[100:101] op_sel:[0,0,0] op_sel_hi:[0,1,1]
    v_pk_fma_f32 v[206:207], v[22:23], v[206:207], v[102:103] op_sel:[0,0,0] op_sel_hi:[0,1,1]
    v_cvt_pk_bf16_f32 v52, v200, v201
    v_cvt_pk_bf16_f32 v53, v202, v203
    v_cvt_pk_bf16_f32 v54, v204, v205
    v_cvt_pk_bf16_f32 v55, v206, v207
    s_nop 1
    v_permlane32_swap_b32 v52, v54
    v_permlane32_swap_b32 v53, v55
    ds_write_b128 v11, v[52:55] offset:2048
    v_pk_mul_f32 v[96:97], v[16:17], v[84:85] op_sel:[1,0] op_sel_hi:[1,1]
    v_pk_mul_f32 v[98:99], v[16:17], v[86:87] op_sel:[1,0] op_sel_hi:[1,1]
    v_pk_fma_f32 v[208:209], v[16:17], v[208:209], v[96:97] op_sel:[0,0,0] op_sel_hi:[0,1,1]
    v_pk_fma_f32 v[210:211], v[16:17], v[210:211], v[98:99] op_sel:[0,0,0] op_sel_hi:[0,1,1]
    v_pk_mul_f32 v[100:101], v[18:19], v[84:85] op_sel:[1,0] op_sel_hi:[1,1]
    v_pk_mul_f32 v[102:103], v[18:19], v[86:87] op_sel:[1,0] op_sel_hi:[1,1]
    v_pk_fma_f32 v[212:213], v[18:19], v[212:213], v[100:101] op_sel:[0,0,0] op_sel_hi:[0,1,1]
    v_pk_fma_f32 v[214:215], v[18:19], v[214:215], v[102:103] op_sel:[0,0,0] op_sel_hi:[0,1,1]
    v_cvt_pk_bf16_f32 v56, v208, v209
    v_cvt_pk_bf16_f32 v57, v210, v211
    v_cvt_pk_bf16_f32 v58, v212, v213
    v_cvt_pk_bf16_f32 v59, v214, v215
    s_nop 1
    v_permlane32_swap_b32 v56, v58
    v_permlane32_swap_b32 v57, v59
    ds_write_b128 v11, v[56:59] offset:32
    v_pk_mul_f32 v[96:97], v[20:21], v[84:85] op_sel:[1,0] op_sel_hi:[1,1]
    v_pk_mul_f32 v[98:99], v[20:21], v[86:87] op_sel:[1,0] op_sel_hi:[1,1]
    v_pk_fma_f32 v[216:217], v[20:21], v[216:217], v[96:97] op_sel:[0,0,0] op_sel_hi:[0,1,1]
    v_pk_fma_f32 v[218:219], v[20:21], v[218:219], v[98:99] op_sel:[0,0,0] op_sel_hi:[0,1,1]
    v_pk_mul_f32 v[100:101], v[22:23], v[84:85] op_sel:[1,0] op_sel_hi:[1,1]
    v_pk_mul_f32 v[102:103], v[22:23], v[86:87] op_sel:[1,0] op_sel_hi:[1,1]
    v_pk_fma_f32 v[220:221], v[22:23], v[220:221], v[100:101] op_sel:[0,0,0] op_sel_hi:[0,1,1]
    v_pk_fma_f32 v[222:223], v[22:23], v[222:223], v[102:103] op_sel:[0,0,0] op_sel_hi:[0,1,1]
    v_cvt_pk_bf16_f32 v60, v216, v217
    v_cvt_pk_bf16_f32 v61, v218, v219
    v_cvt_pk_bf16_f32 v62, v220, v221
    v_cvt_pk_bf16_f32 v63, v222, v223
    s_nop 1
    v_permlane32_swap_b32 v60, v62
    v_permlane32_swap_b32 v61, v63
    ds_write_b128 v11, v[60:63] offset:2080
    ds_read_b128 v[240:243], v9 offset:8192
    ds_read_b128 v[244:247], v9 offset:9216
    ds_read_b128 v[248:251], v9 offset:10240
    ds_read_b128 v[252:255], v9 offset:11264
    v_pk_mul_f32 v[96:97], v[16:17], v[72:73] op_sel:[1,0] op_sel_hi:[1,1]
    v_pk_mul_f32 v[98:99], v[16:17], v[74:75] op_sel:[1,0] op_sel_hi:[1,1]
    v_pk_fma_f32 v[160:161], v[16:17], v[160:161], v[96:97] op_sel:[0,0,0] op_sel_hi:[0,1,1]
    v_pk_fma_f32 v[162:163], v[16:17], v[162:163], v[98:99] op_sel:[0,0,0] op_sel_hi:[0,1,1]
    v_pk_mul_f32 v[100:101], v[18:19], v[72:73] op_sel:[1,0] op_sel_hi:[1,1]
    v_pk_mul_f32 v[102:103], v[18:19], v[74:75] op_sel:[1,0] op_sel_hi:[1,1]
    v_pk_fma_f32 v[164:165], v[18:19], v[164:165], v[100:101] op_sel:[0,0,0] op_sel_hi:[0,1,1]
    v_pk_fma_f32 v[166:167], v[18:19], v[166:167], v[102:103] op_sel:[0,0,0] op_sel_hi:[0,1,1]
    v_cvt_pk_bf16_f32 v32, v160, v161
    v_cvt_pk_bf16_f32 v33, v162, v163
    v_cvt_pk_bf16_f32 v34, v164, v165
    v_cvt_pk_bf16_f32 v35, v166, v167
    s_nop 1
    v_permlane16_swap_b32 v32, v34
    v_permlane16_swap_b32 v33, v35
    buffer_store_dwordx4 v[32:35], v3, s[8:11], s6 offen offset:0 sc1
    ds_write_b128 v9, v[32:35] offset:0
    v_pk_mul_f32 v[96:97], v[20:21], v[72:73] op_sel:[1,0] op_sel_hi:[1,1]
    v_pk_mul_f32 v[98:99], v[20:21], v[74:75] op_sel:[1,0] op_sel_hi:[1,1]
    v_pk_fma_f32 v[168:169], v[20:21], v[168:169], v[96:97] op_sel:[0,0,0] op_sel_hi:[0,1,1]
    v_pk_fma_f32 v[170:171], v[20:21], v[170:171], v[98:99] op_sel:[0,0,0] op_sel_hi:[0,1,1]
    v_pk_mul_f32 v[100:101], v[22:23], v[72:73] op_sel:[1,0] op_sel_hi:[1,1]
    v_pk_mul_f32 v[102:103], v[22:23], v[74:75] op_sel:[1,0] op_sel_hi:[1,1]
    v_pk_fma_f32 v[172:173], v[22:23], v[172:173], v[100:101] op_sel:[0,0,0] op_sel_hi:[0,1,1]
    v_pk_fma_f32 v[174:175], v[22:23], v[174:175], v[102:103] op_sel:[0,0,0] op_sel_hi:[0,1,1]
    v_cvt_pk_bf16_f32 v36, v168, v169
    v_cvt_pk_bf16_f32 v37, v170, v171
    v_cvt_pk_bf16_f32 v38, v172, v173
    v_cvt_pk_bf16_f32 v39, v174, v175
    s_nop 1
    v_permlane16_swap_b32 v36, v38
    v_permlane16_swap_b32 v37, v39
    buffer_store_dwordx4 v[36:39], v3, s[8:11], s6 offen offset:2048 sc1
    ds_write_b128 v9, v[36:39] offset:2048
    v_pk_mul_f32 v[96:97], v[16:17], v[76:77] op_sel:[1,0] op_sel_hi:[1,1]
    v_pk_mul_f32 v[98:99], v[16:17], v[78:79] op_sel:[1,0] op_sel_hi:[1,1]
    v_pk_fma_f32 v[176:177], v[16:17], v[176:177], v[96:97] op_sel:[0,0,0] op_sel_hi:[0,1,1]
    v_pk_fma_f32 v[178:179], v[16:17], v[178:179], v[98:99] op_sel:[0,0,0] op_sel_hi:[0,1,1]
    v_pk_mul_f32 v[100:101], v[18:19], v[76:77] op_sel:[1,0] op_sel_hi:[1,1]
    v_pk_mul_f32 v[102:103], v[18:19], v[78:79] op_sel:[1,0] op_sel_hi:[1,1]
    v_pk_fma_f32 v[180:181], v[18:19], v[180:181], v[100:101] op_sel:[0,0,0] op_sel_hi:[0,1,1]
    v_pk_fma_f32 v[182:183], v[18:19], v[182:183], v[102:103] op_sel:[0,0,0] op_sel_hi:[0,1,1]
    v_cvt_pk_bf16_f32 v40, v176, v177
    v_cvt_pk_bf16_f32 v41, v178, v179
    v_cvt_pk_bf16_f32 v42, v180, v181
    v_cvt_pk_bf16_f32 v43, v182, v183
    s_nop 1
    v_permlane16_swap_b32 v40, v42
    v_permlane16_swap_b32 v41, v43
    buffer_store_dwordx4 v[40:43], v3, s[8:11], s6 offen offset:1024 sc1
    ds_write_b128 v9, v[40:43] offset:1024
    v_pk_mul_f32 v[96:97], v[20:21], v[76:77] op_sel:[1,0] op_sel_hi:[1,1]
    v_pk_mul_f32 v[98:99], v[20:21], v[78:79] op_sel:[1,0] op_sel_hi:[1,1]
    v_pk_fma_f32 v[184:185], v[20:21], v[184:185], v[96:97] op_sel:[0,0,0] op_sel_hi:[0,1,1]
    v_pk_fma_f32 v[186:187], v[20:21], v[186:187], v[98:99] op_sel:[0,0,0] op_sel_hi:[0,1,1]
    v_pk_mul_f32 v[100:101], v[22:23], v[76:77] op_sel:[1,0] op_sel_hi:[1,1]
    v_pk_mul_f32 v[102:103], v[22:23], v[78:79] op_sel:[1,0] op_sel_hi:[1,1]
    v_pk_fma_f32 v[188:189], v[22:23], v[188:189], v[100:101] op_sel:[0,0,0] op_sel_hi:[0,1,1]
    v_pk_fma_f32 v[190:191], v[22:23], v[190:191], v[102:103] op_sel:[0,0,0] op_sel_hi:[0,1,1]
    v_cvt_pk_bf16_f32 v44, v184, v185
    v_cvt_pk_bf16_f32 v45, v186, v187
    v_cvt_pk_bf16_f32 v46, v188, v189
    v_cvt_pk_bf16_f32 v47, v190, v191
    s_nop 1
    v_permlane16_swap_b32 v44, v46
    v_permlane16_swap_b32 v45, v47
    buffer_store_dwordx4 v[44:47], v3, s[8:11], s6 offen offset:3072 sc1
    ds_write_b128 v9, v[44:47] offset:3072
    s_lshl_b32 s3, s62, 8
    s_add_u32 s3, s3, 162048
    v_lshl_add_u32 v4, v0, 2, s3
    v_mov_b32 v5, 1
    s_waitcnt lgkmcnt(0)
    ds_write_b32 v4, v5
    buffer_store_dwordx4 v[240:243], v3, s[8:11], s7 offen offset:0 sc1
    buffer_store_dwordx4 v[244:247], v3, s[8:11], s7 offen offset:1024 sc1
    buffer_store_dwordx4 v[248:251], v3, s[8:11], s7 offen offset:2048 sc1
    buffer_store_dwordx4 v[252:255], v3, s[8:11], s7 offen offset:3072 sc1
    v_pk_mul_f32 v[96:97], v[108:109], v[64:65] op_sel:[1,0] op_sel_hi:[1,1]
    v_pk_mul_f32 v[98:99], v[108:109], v[66:67] op_sel:[1,0] op_sel_hi:[1,1]
    v_pk_fma_f32 v[128:129], v[108:109], v[128:129], v[96:97] op_sel:[0,0,0] op_sel_hi:[0,1,1]
    v_pk_fma_f32 v[130:131], v[108:109], v[130:131], v[98:99] op_sel:[0,0,0] op_sel_hi:[0,1,1]
    v_pk_mul_f32 v[100:101], v[110:111], v[64:65] op_sel:[1,0] op_sel_hi:[1,1]
    v_pk_mul_f32 v[102:103], v[110:111], v[66:67] op_sel:[1,0] op_sel_hi:[1,1]
    v_pk_fma_f32 v[132:133], v[110:111], v[132:133], v[100:101] op_sel:[0,0,0] op_sel_hi:[0,1,1]
    v_pk_fma_f32 v[134:135], v[110:111], v[134:135], v[102:103] op_sel:[0,0,0] op_sel_hi:[0,1,1]
    v_cvt_pk_bf16_f32 v224, v128, v129
    v_cvt_pk_bf16_f32 v225, v130, v131
    v_cvt_pk_bf16_f32 v226, v132, v133
    v_cvt_pk_bf16_f32 v227, v134, v135
    s_nop 1
    v_permlane16_swap_b32 v224, v226
    v_permlane16_swap_b32 v225, v227
    v_pk_mul_f32 v[96:97], v[112:113], v[64:65] op_sel:[1,0] op_sel_hi:[1,1]
    v_pk_mul_f32 v[98:99], v[112:113], v[66:67] op_sel:[1,0] op_sel_hi:[1,1]
    v_pk_fma_f32 v[136:137], v[112:113], v[136:137], v[96:97] op_sel:[0,0,0] op_sel_hi:[0,1,1]
    v_pk_fma_f32 v[138:139], v[112:113], v[138:139], v[98:99] op_sel:[0,0,0] op_sel_hi:[0,1,1]
    v_pk_mul_f32 v[100:101], v[114:115], v[64:65] op_sel:[1,0] op_sel_hi:[1,1]
    v_pk_mul_f32 v[102:103], v[114:115], v[66:67] op_sel:[1,0] op_sel_hi:[1,1]
    v_pk_fma_f32 v[140:141], v[114:115], v[140:141], v[100:101] op_sel:[0,0,0] op_sel_hi:[0,1,1]
    v_pk_fma_f32 v[142:143], v[114:115], v[142:143], v[102:103] op_sel:[0,0,0] op_sel_hi:[0,1,1]
    v_cvt_pk_bf16_f32 v232, v136, v137
    v_cvt_pk_bf16_f32 v233, v138, v139
    v_cvt_pk_bf16_f32 v234, v140, v141
    v_cvt_pk_bf16_f32 v235, v142, v143
    s_nop 1
    v_permlane16_swap_b32 v232, v234
    v_permlane16_swap_b32 v233, v235
    v_pk_mul_f32 v[96:97], v[108:109], v[68:69] op_sel:[1,0] op_sel_hi:[1,1]
    v_pk_mul_f32 v[98:99], v[108:109], v[70:71] op_sel:[1,0] op_sel_hi:[1,1]
    v_pk_fma_f32 v[144:145], v[108:109], v[144:145], v[96:97] op_sel:[0,0,0] op_sel_hi:[0,1,1]
    v_pk_fma_f32 v[146:147], v[108:109], v[146:147], v[98:99] op_sel:[0,0,0] op_sel_hi:[0,1,1]
    v_pk_mul_f32 v[100:101], v[110:111], v[68:69] op_sel:[1,0] op_sel_hi:[1,1]
    v_pk_mul_f32 v[102:103], v[110:111], v[70:71] op_sel:[1,0] op_sel_hi:[1,1]
    v_pk_fma_f32 v[148:149], v[110:111], v[148:149], v[100:101] op_sel:[0,0,0] op_sel_hi:[0,1,1]
    v_pk_fma_f32 v[150:151], v[110:111], v[150:151], v[102:103] op_sel:[0,0,0] op_sel_hi:[0,1,1]
    v_cvt_pk_bf16_f32 v228, v144, v145
    v_cvt_pk_bf16_f32 v229, v146, v147
    v_cvt_pk_bf16_f32 v230, v148, v149
    v_cvt_pk_bf16_f32 v231, v150, v151
    s_nop 1
    v_permlane16_swap_b32 v228, v230
    v_permlane16_swap_b32 v229, v231
    v_pk_mul_f32 v[96:97], v[112:113], v[68:69] op_sel:[1,0] op_sel_hi:[1,1]
    v_pk_mul_f32 v[98:99], v[112:113], v[70:71] op_sel:[1,0] op_sel_hi:[1,1]
    v_pk_fma_f32 v[152:153], v[112:113], v[152:153], v[96:97] op_sel:[0,0,0] op_sel_hi:[0,1,1]
    v_pk_fma_f32 v[154:155], v[112:113], v[154:155], v[98:99] op_sel:[0,0,0] op_sel_hi:[0,1,1]
    v_pk_mul_f32 v[100:101], v[114:115], v[68:69] op_sel:[1,0] op_sel_hi:[1,1]
    v_pk_mul_f32 v[102:103], v[114:115], v[70:71] op_sel:[1,0] op_sel_hi:[1,1]
    v_pk_fma_f32 v[156:157], v[114:115], v[156:157], v[100:101] op_sel:[0,0,0] op_sel_hi:[0,1,1]
    v_pk_fma_f32 v[158:159], v[114:115], v[158:159], v[102:103] op_sel:[0,0,0] op_sel_hi:[0,1,1]
    v_cvt_pk_bf16_f32 v236, v152, v153
    v_cvt_pk_bf16_f32 v237, v154, v155
    v_cvt_pk_bf16_f32 v238, v156, v157
    v_cvt_pk_bf16_f32 v239, v158, v159
    s_nop 1
    v_permlane16_swap_b32 v236, v238
    v_permlane16_swap_b32 v237, v239
    s_lshl_b32 s32, s62, 12
    s_add_u32 s3, s28, s32
    v_add_u32 v8, s3, v3
    s_lshl_b32 s30, s26, 15
    s_add_u32 s30, s30, 16384
    v_and_b32 v10, 3, v0
    v_lshlrev_b32 v10, 8, v10
    v_add_u32 v10, 162048, v10
    v_mov_b32 v11, 163072
    v_mov_b32 v1, v3
    v_lshrrev_b32 v30, 5, v0
    v_bfe_u32 v31, v0, 2, 2
    v_lshl_add_u32 v30, v30, 2, v31
    v_lshlrev_b32 v2, 6, v30
    v_bfe_u32 v30, v0, 4, 1
    v_lshl_add_u32 v2, v30, 5, v2
    v_and_b32 v30, 1, v0
    v_lshl_add_u32 v2, v30, 4, v2
    v_bfe_u32 v30, v0, 1, 1
    v_lshl_add_u32 v2, v30, 3, v2
    v_mov_b32 v14, v2
    v_add_u32 v2, 8192, v2
    v_bfe_u32 v30, v0, 2, 1
    v_bfe_u32 v31, v0, 4, 1
    v_xor_b32 v30, v30, v31
    v_and_b32 v31, 3, v0
    v_or_b32 v30, v30, v31
    v_cmp_eq_u32 vcc, 0, v30
    v_mov_b32 v31, 0x3f803f80
    v_and_b32 v12, 31, v0
    v_cndmask_b32 v96, 0, v31, vcc
    v_cndmask_b32 v97, 0, v31, vcc
    v_cndmask_b32 v98, 0, v31, vcc
    v_cndmask_b32 v99, 0, v31, vcc
    v_lshlrev_b32 v12, 7, v12
    s_mov_b32 s34, 0
    s_mov_b32 s6, -1
    v_mov_b32 v160, 0
    v_mov_b32 v161, 0
    v_mov_b32 v162, 0
    v_mov_b32 v163, 0
    v_mov_b32 v164, 0
    v_mov_b32 v165, 0
    v_mov_b32 v166, 0
    v_mov_b32 v167, 0
    v_mov_b32 v168, 0
    v_mov_b32 v169, 0
    v_mov_b32 v170, 0
    v_mov_b32 v171, 0
    v_mov_b32 v172, 0
    v_mov_b32 v173, 0
    v_mov_b32 v174, 0
    v_mov_b32 v175, 0
    v_mov_b32 v88, 0
    v_mov_b32 v89, 0
    v_mov_b32 v90, 0
    v_mov_b32 v91, 0
    v_mov_b32 v176, 0
    v_mov_b32 v177, 0
    v_mov_b32 v178, 0
    v_mov_b32 v179, 0
    v_mov_b32 v180, 0
    v_mov_b32 v181, 0
    v_mov_b32 v182, 0
    v_mov_b32 v183, 0
    v_mov_b32 v184, 0
    v_mov_b32 v185, 0
    v_mov_b32 v186, 0
    v_mov_b32 v187, 0
    v_mov_b32 v188, 0
    v_mov_b32 v189, 0
    v_mov_b32 v190, 0
    v_mov_b32 v191, 0
    v_mov_b32 v92, 0
    v_mov_b32 v93, 0
    v_mov_b32 v94, 0
    v_mov_b32 v95, 0
    s_mov_b32 s4, 1600000
mk_spin0:
    ds_read_b32 v6, v10
    s_waitcnt lgkmcnt(0)
    v_cmp_lt_u32 vcc, v6, v5
    s_cbranch_vccz mk_spind0
    s_sub_u32 s4, s4, 1
    s_cmp_lg_u32 s4, 0
    s_cbranch_scc1 mk_spin0
mk_spind0:
    ds_read_b128 v[72:75], v1 offset:0
    ds_read_b128 v[76:79], v1 offset:1024
    ds_read_b64_tr_b16 v[80:81], v2 offset:0
    ds_read_b64_tr_b16 v[82:83], v2 offset:512
    ds_read_b64_tr_b16 v[84:85], v2 offset:1024
    ds_read_b64_tr_b16 v[86:87], v2 offset:1536
    s_waitcnt lgkmcnt(4)
    v_mfma_f32_32x32x16_bf16 v[32:47], v[72:75], v[224:227], 0
    v_mfma_f32_32x32x16_bf16 v[32:47], v[76:79], v[228:231], v[32:47]
    v_mfma_f32_32x32x16_bf16 v[48:63], v[72:75], v[232:235], 0
    v_mfma_f32_32x32x16_bf16 v[48:63], v[76:79], v[236:239], v[48:63]
    v_mov_b32 v68, 0
    v_mov_b32 v69, 0
    v_mov_b32 v70, 0
    v_mov_b32 v71, 0
    s_nop 5
    v_max3_f32 v30, v32, v33, v34
    v_max3_f32 v30, v30, v35, v36
    v_max3_f32 v30, v30, v37, v38
    v_max3_f32 v30, v30, v39, v40
    v_max3_f32 v30, v30, v41, v42
    v_max3_f32 v30, v30, v43, v44
    v_max3_f32 v30, v30, v45, v46
    v_max_f32 v30, v30, v47
    v_mov_b32 v31, v30
    s_nop 1
    v_permlane32_swap_b32 v30, v31
    s_nop 1
    v_max_f32 v30, v30, v31
    v_sub_f32 v128, 0, v30
    v_sub_f32 v129, 0, v30
    v_sub_f32 v130, 0, v30
    v_sub_f32 v131, 0, v30
    v_sub_f32 v132, 0, v30
    v_sub_f32 v133, 0, v30
    v_sub_f32 v134, 0, v30
    v_sub_f32 v135, 0, v30
    v_sub_f32 v136, 0, v30
    v_sub_f32 v137, 0, v30
    v_sub_f32 v138, 0, v30
    v_sub_f32 v139, 0, v30
    v_sub_f32 v140, 0, v30
    v_sub_f32 v141, 0, v30
    v_sub_f32 v142, 0, v30
    v_sub_f32 v143, 0, v30
    v_max3_f32 v30, v48, v49, v50
    v_max3_f32 v30, v30, v51, v52
    v_max3_f32 v30, v30, v53, v54
    v_max3_f32 v30, v30, v55, v56
    v_max3_f32 v30, v30, v57, v58
    v_max3_f32 v30, v30, v59, v60
    v_max3_f32 v30, v30, v61, v62
    v_max_f32 v30, v30, v63
    v_mfma_f32_32x32x16_bf16 v[32:47], v[72:75], v[224:227], v[128:143]
    v_mfma_f32_32x32x16_bf16 v[32:47], v[76:79], v[228:231], v[32:47]
    v_mov_b32 v31, v30
    s_nop 1
    v_permlane32_swap_b32 v30, v31
    s_nop 1
    v_max_f32 v30, v30, v31
    v_sub_f32 v144, 0, v30
    v_sub_f32 v145, 0, v30
    v_sub_f32 v146, 0, v30
    v_sub_f32 v147, 0, v30
    v_sub_f32 v148, 0, v30
    v_sub_f32 v149, 0, v30
    v_sub_f32 v150, 0, v30
    v_sub_f32 v151, 0, v30
    v_sub_f32 v152, 0, v30
    v_sub_f32 v153, 0, v30
    v_sub_f32 v154, 0, v30
    v_sub_f32 v155, 0, v30
    v_sub_f32 v156, 0, v30
    v_sub_f32 v157, 0, v30
    v_sub_f32 v158, 0, v30
    v_sub_f32 v159, 0, v30
    s_waitcnt lgkmcnt(0)
    s_nop 0
    s_lshl_b32 s3, s27, 5
    s_lshl_b32 s4, s26, 2
    s_add_u32 s3, s3, s4
    s_add_u32 s3, s3, s62
    s_lshl_b32 s3, s3, 7
    s_add_u32 s3, s3, 51380224
    s_waitcnt vmcnt(0)
    v_mov_b32 v30, s25
    v_mov_b32 v31, 0
    s_mov_b64 exec, 1
    buffer_store_dword v30, v31, s[8:11], s3 offen sc1
    s_mov_b64 exec, -1
    s_setprio 0
    s_lshl_b32 s5, s27, 12
    s_add_u32 s5, s5, 51380224
    s_mov_b32 s35, 0
    s_mov_b32 s4, 200000
    v_mov_b32 v7, s25
    v_add_u32 v7, 1, v7
mk_a_w0:
    ds_read_b32 v6, v11
    s_waitcnt lgkmcnt(0)
    v_readfirstlane_b32 s3, v6
    s_cmp_ge_u32 s3, 4
    s_cbranch_scc1 mk_a_w2
    s_sleep 2
    s_sub_u32 s4, s4, 1
    s_cmp_lg_u32 s4, 0
    s_cbranch_scc1 mk_a_w0
mk_a_w2:
    buffer_load_dword v7, v12, s[8:11], s5 offen sc1
mk_a_w4:
    .p2align 6
mk_aloop:
    v_mfma_f32_32x32x16_bf16 v[48:63], v[72:75], v[232:235], v[144:159]
    ds_read_b128 v[72:75], v1 offset:2048
    v_exp_f32 v32, v32
    v_exp_f32 v33, v33
    v_exp_f32 v34, v34
    v_exp_f32 v35, v35
    v_mfma_f32_32x32x16_bf16 v[176:191], v[84:87], v[68:71], v[176:191]
    ds_read_b64_tr_b16 v[84:85], v2 offset:1024
    ds_read_b64_tr_b16 v[86:87], v2 offset:1536
    v_exp_f32 v36, v36
    v_exp_f32 v37, v37
    v_exp_f32 v38, v38
    v_exp_f32 v39, v39
    v_mfma_f32_32x32x16_bf16 v[48:63], v[76:79], v[236:239], v[48:63]
    ds_read_b128 v[76:79], v1 offset:3072
    v_exp_f32 v40, v40
    v_cvt_pk_bf16_f32 v64, v32, v33
    v_cvt_pk_bf16_f32 v65, v34, v35
    v_cvt_pk_bf16_f32 v66, v36, v37
    v_cvt_pk_bf16_f32 v67, v38, v39
    v_exp_f32 v41, v41
    v_mfma_f32_16x16x32_bf16 v[92:95], v[96:99], v[68:71], v[92:95]
    v_exp_f32 v42, v42
    v_exp_f32 v43, v43
    s_waitcnt lgkmcnt(1)
    v_mfma_f32_32x32x16_bf16 v[160:175], v[80:83], v[64:67], v[160:175]
    v_exp_f32 v44, v44
    v_exp_f32 v45, v45
    v_exp_f32 v46, v46
    v_exp_f32 v47, v47
    v_mfma_f32_16x16x32_bf16 v[88:91], v[96:99], v[64:67], v[88:91]
    v_cvt_pk_bf16_f32 v68, v40, v41
    v_cvt_pk_bf16_f32 v69, v42, v43
    v_cvt_pk_bf16_f32 v70, v44, v45
    v_cvt_pk_bf16_f32 v71, v46, v47
    v_mfma_f32_32x32x16_bf16 v[32:47], v[72:75], v[224:227], v[128:143]
    v_exp_f32 v48, v48
    v_exp_f32 v49, v49
    v_exp_f32 v50, v50
    v_exp_f32 v51, v51
    v_mfma_f32_32x32x16_bf16 v[160:175], v[84:87], v[68:71], v[160:175]
    v_exp_f32 v52, v52
    v_exp_f32 v53, v53
    v_exp_f32 v54, v54
    v_exp_f32 v55, v55
    s_waitcnt lgkmcnt(0)
    v_mfma_f32_32x32x16_bf16 v[32:47], v[76:79], v[228:231], v[32:47]
    v_exp_f32 v56, v56
    v_cvt_pk_bf16_f32 v64, v48, v49
    v_cvt_pk_bf16_f32 v65, v50, v51
    v_cvt_pk_bf16_f32 v66, v52, v53
    v_cvt_pk_bf16_f32 v67, v54, v55
    v_exp_f32 v57, v57
    v_mfma_f32_16x16x32_bf16 v[88:91], v[96:99], v[68:71], v[88:91]
    v_exp_f32 v58, v58
    v_exp_f32 v59, v59
    v_mfma_f32_32x32x16_bf16 v[176:191], v[80:83], v[64:67], v[176:191]
    ds_read_b64_tr_b16 v[80:81], v2 offset:2048
    ds_read_b64_tr_b16 v[82:83], v2 offset:2560
    v_exp_f32 v60, v60
    v_exp_f32 v61, v61
    v_exp_f32 v62, v62
    v_exp_f32 v63, v63
    v_mfma_f32_16x16x32_bf16 v[92:95], v[96:99], v[64:67], v[92:95]
    v_cvt_pk_bf16_f32 v68, v56, v57
    v_cvt_pk_bf16_f32 v69, v58, v59
    v_cvt_pk_bf16_f32 v70, v60, v61
    v_cvt_pk_bf16_f32 v71, v62, v63
    v_mfma_f32_32x32x16_bf16 v[48:63], v[72:75], v[232:235], v[144:159]
    ds_read_b128 v[72:75], v1 offset:4096
    v_exp_f32 v32, v32
    v_exp_f32 v33, v33
    v_exp_f32 v34, v34
    v_exp_f32 v35, v35
    v_mfma_f32_32x32x16_bf16 v[176:191], v[84:87], v[68:71], v[176:191]
    ds_read_b64_tr_b16 v[84:85], v2 offset:3072
    ds_read_b64_tr_b16 v[86:87], v2 offset:3584
    v_exp_f32 v36, v36
    v_exp_f32 v37, v37
    v_exp_f32 v38, v38
    v_exp_f32 v39, v39
    v_mfma_f32_32x32x16_bf16 v[48:63], v[76:79], v[236:239], v[48:63]
    ds_read_b128 v[76:79], v1 offset:5120
    v_exp_f32 v40, v40
    v_cvt_pk_bf16_f32 v64, v32, v33
    v_cvt_pk_bf16_f32 v65, v34, v35
    v_cvt_pk_bf16_f32 v66, v36, v37
    v_cvt_pk_bf16_f32 v67, v38, v39
    v_exp_f32 v41, v41
    v_mfma_f32_16x16x32_bf16 v[92:95], v[96:99], v[68:71], v[92:95]
    v_exp_f32 v42, v42
    v_exp_f32 v43, v43
    s_waitcnt lgkmcnt(1)
    v_mfma_f32_32x32x16_bf16 v[160:175], v[80:83], v[64:67], v[160:175]
    v_exp_f32 v44, v44
    v_exp_f32 v45, v45
    v_exp_f32 v46, v46
    v_exp_f32 v47, v47
    v_mfma_f32_16x16x32_bf16 v[88:91], v[96:99], v[64:67], v[88:91]
    v_cvt_pk_bf16_f32 v68, v40, v41
    v_cvt_pk_bf16_f32 v69, v42, v43
    v_cvt_pk_bf16_f32 v70, v44, v45
    v_cvt_pk_bf16_f32 v71, v46, v47
    v_mfma_f32_32x32x16_bf16 v[32:47], v[72:75], v[224:227], v[128:143]
    v_add_u32 v5, 1, v5
    s_waitcnt vmcnt(4)
    ds_write_b32 v4, v5
    v_exp_f32 v48, v48
    v_exp_f32 v49, v49
    v_exp_f32 v50, v50
    v_exp_f32 v51, v51
    v_mfma_f32_32x32x16_bf16 v[160:175], v[84:87], v[68:71], v[160:175]
    v_exp_f32 v52, v52
    v_exp_f32 v53, v53
    v_exp_f32 v54, v54
    v_exp_f32 v55, v55
    s_waitcnt lgkmcnt(1)
    v_mfma_f32_32x32x16_bf16 v[32:47], v[76:79], v[228:231], v[32:47]
    v_exp_f32 v56, v56
    v_cvt_pk_bf16_f32 v64, v48, v49
    v_cvt_pk_bf16_f32 v65, v50, v51
    v_cvt_pk_bf16_f32 v66, v52, v53
    v_cvt_pk_bf16_f32 v67, v54, v55
    v_exp_f32 v57, v57
    v_mfma_f32_16x16x32_bf16 v[88:91], v[96:99], v[68:71], v[88:91]
    v_exp_f32 v58, v58
    v_exp_f32 v59, v59
    v_mfma_f32_32x32x16_bf16 v[176:191], v[80:83], v[64:67], v[176:191]
    ds_read_b64_tr_b16 v[80:81], v2 offset:4096
    ds_read_b64_tr_b16 v[82:83], v2 offset:4608
    v_exp_f32 v60, v60
    v_exp_f32 v61, v61
    v_exp_f32 v62, v62
    v_exp_f32 v63, v63
    v_mfma_f32_16x16x32_bf16 v[92:95], v[96:99], v[64:67], v[92:95]
    v_cvt_pk_bf16_f32 v68, v56, v57
    v_cvt_pk_bf16_f32 v69, v58, v59
    v_cvt_pk_bf16_f32 v70, v60, v61
    v_cvt_pk_bf16_f32 v71, v62, v63
    v_mfma_f32_32x32x16_bf16 v[48:63], v[72:75], v[232:235], v[144:159]
    ds_read_b128 v[72:75], v1 offset:6144
    v_exp_f32 v32, v32
    v_exp_f32 v33, v33
    v_exp_f32 v34, v34
    v_exp_f32 v35, v35
    v_mfma_f32_32x32x16_bf16 v[176:191], v[84:87], v[68:71], v[176:191]
    ds_read_b64_tr_b16 v[84:85], v2 offset:5120
    ds_read_b64_tr_b16 v[86:87], v2 offset:5632
    v_exp_f32 v36, v36
    v_exp_f32 v37, v37
    v_exp_f32 v38, v38
    v_exp_f32 v39, v39
    v_mfma_f32_32x32x16_bf16 v[48:63], v[76:79], v[236:239], v[48:63]
    ds_read_b128 v[76:79], v1 offset:7168
    v_exp_f32 v40, v40
    v_cvt_pk_bf16_f32 v64, v32, v33
    v_cvt_pk_bf16_f32 v65, v34, v35
    v_cvt_pk_bf16_f32 v66, v36, v37
    v_cvt_pk_bf16_f32 v67, v38, v39
    v_exp_f32 v41, v41
    v_mfma_f32_16x16x32_bf16 v[92:95], v[96:99], v[68:71], v[92:95]
    v_exp_f32 v42, v42
    v_exp_f32 v43, v43
    s_waitcnt lgkmcnt(1)
    v_mfma_f32_32x32x16_bf16 v[160:175], v[80:83], v[64:67], v[160:175]
    v_exp_f32 v44, v44
    v_exp_f32 v45, v45
    v_exp_f32 v46, v46
    v_exp_f32 v47, v47
    v_mfma_f32_16x16x32_bf16 v[88:91], v[96:99], v[64:67], v[88:91]
    v_cvt_pk_bf16_f32 v68, v40, v41
    v_cvt_pk_bf16_f32 v69, v42, v43
    v_cvt_pk_bf16_f32 v70, v44, v45
    v_cvt_pk_bf16_f32 v71, v46, v47
    v_mfma_f32_32x32x16_bf16 v[32:47], v[72:75], v[224:227], v[128:143]
    v_exp_f32 v48, v48
    v_exp_f32 v49, v49
    v_exp_f32 v50, v50
    v_exp_f32 v51, v51
    v_mfma_f32_32x32x16_bf16 v[160:175], v[84:87], v[68:71], v[160:175]
    v_exp_f32 v52, v52
    v_exp_f32 v53, v53
    v_exp_f32 v54, v54
    v_exp_f32 v55, v55
    s_waitcnt lgkmcnt(0)
    v_mfma_f32_32x32x16_bf16 v[32:47], v[76:79], v[228:231], v[32:47]
    ds_read_b32 v6, v10
    v_exp_f32 v56, v56
    v_cvt_pk_bf16_f32 v64, v48, v49
    v_cvt_pk_bf16_f32 v65, v50, v51
    v_cvt_pk_bf16_f32 v66, v52, v53
    v_cvt_pk_bf16_f32 v67, v54, v55
    v_exp_f32 v57, v57
    v_mfma_f32_16x16x32_bf16 v[88:91], v[96:99], v[68:71], v[88:91]
    v_exp_f32 v58, v58
    v_exp_f32 v59, v59
    v_mfma_f32_32x32x16_bf16 v[176:191], v[80:83], v[64:67], v[176:191]
    ds_read_b64_tr_b16 v[80:81], v2 offset:6144
    ds_read_b64_tr_b16 v[82:83], v2 offset:6656
    v_exp_f32 v60, v60
    v_exp_f32 v61, v61
    v_exp_f32 v62, v62
    v_exp_f32 v63, v63
    v_mfma_f32_16x16x32_bf16 v[92:95], v[96:99], v[64:67], v[92:95]
    s_waitcnt lgkmcnt(2)
    v_cmp_lt_u32 vcc, v6, v5
    v_cvt_pk_bf16_f32 v68, v56, v57
    v_cvt_pk_bf16_f32 v69, v58, v59
    v_cvt_pk_bf16_f32 v70, v60, v61
    v_cvt_pk_bf16_f32 v71, v62, v63
    s_cbranch_vccnz mk_a_spin0
mk_a_spind0:
    s_cmp_eq_u32 s34, s35
    s_cbranch_scc1 mk_a_sp
mk_a_spd:
    v_mfma_f32_32x32x16_bf16 v[48:63], v[72:75], v[232:235], v[144:159]
    ds_read_b128 v[72:75], v1 offset:16384
    v_exp_f32 v32, v32
    v_exp_f32 v33, v33
    v_exp_f32 v34, v34
    v_exp_f32 v35, v35
    v_mfma_f32_32x32x16_bf16 v[176:191], v[84:87], v[68:71], v[176:191]
    ds_read_b64_tr_b16 v[84:85], v2 offset:7168
    ds_read_b64_tr_b16 v[86:87], v2 offset:7680
    v_exp_f32 v36, v36
    v_exp_f32 v37, v37
    v_exp_f32 v38, v38
    v_exp_f32 v39, v39
    v_mfma_f32_32x32x16_bf16 v[48:63], v[76:79], v[236:239], v[48:63]
    ds_read_b128 v[76:79], v1 offset:17408
    v_exp_f32 v40, v40
    v_cvt_pk_bf16_f32 v64, v32, v33
    v_cvt_pk_bf16_f32 v65, v34, v35
    v_cvt_pk_bf16_f32 v66, v36, v37
    v_cvt_pk_bf16_f32 v67, v38, v39
    v_exp_f32 v41, v41
    v_mfma_f32_16x16x32_bf16 v[92:95], v[96:99], v[68:71], v[92:95]
    v_exp_f32 v42, v42
    v_exp_f32 v43, v43
    s_waitcnt lgkmcnt(1)
    v_mfma_f32_32x32x16_bf16 v[160:175], v[80:83], v[64:67], v[160:175]
    s_add_u32 m0, s32, 49152
    s_add_u32 s30, s30, 16384
    s_and_b32 s30, s30, 0x3ffff
    buffer_load_dwordx4 v8, s[8:11], s30 offen sc1 lds
    v_exp_f32 v44, v44
    v_exp_f32 v45, v45
    v_exp_f32 v46, v46
    v_exp_f32 v47, v47
    v_mfma_f32_16x16x32_bf16 v[88:91], v[96:99], v[64:67], v[88:91]
    v_cvt_pk_bf16_f32 v68, v40, v41
    v_cvt_pk_bf16_f32 v69, v42, v43
    v_cvt_pk_bf16_f32 v70, v44, v45
    v_cvt_pk_bf16_f32 v71, v46, v47
    v_mfma_f32_32x32x16_bf16 v[32:47], v[72:75], v[224:227], v[128:143]
    buffer_load_dwordx4 v8, s[8:11], s30 offen offset:1024 sc1 lds
    v_exp_f32 v48, v48
    v_exp_f32 v49, v49
    v_exp_f32 v50, v50
    v_exp_f32 v51, v51
    v_mfma_f32_32x32x16_bf16 v[160:175], v[84:87], v[68:71], v[160:175]
    buffer_load_dwordx4 v8, s[8:11], s30 offen offset:2048 sc1 lds
    v_exp_f32 v52, v52
    v_exp_f32 v53, v53
    v_exp_f32 v54, v54
    v_exp_f32 v55, v55
    s_waitcnt lgkmcnt(0)
    v_mfma_f32_32x32x16_bf16 v[32:47], v[76:79], v[228:231], v[32:47]
    buffer_load_dwordx4 v8, s[8:11], s30 offen offset:3072 sc1 lds
    v_exp_f32 v56, v56
    v_cvt_pk_bf16_f32 v64, v48, v49
    v_cvt_pk_bf16_f32 v65, v50, v51
    v_cvt_pk_bf16_f32 v66, v52, v53
    v_cvt_pk_bf16_f32 v67, v54, v55
    v_exp_f32 v57, v57
    v_mfma_f32_16x16x32_bf16 v[88:91], v[96:99], v[68:71], v[88:91]
    v_exp_f32 v58, v58
    v_exp_f32 v59, v59
    v_mfma_f32_32x32x16_bf16 v[176:191], v[80:83], v[64:67], v[176:191]
    ds_read_b64_tr_b16 v[80:81], v2 offset:16384
    ds_read_b64_tr_b16 v[82:83], v2 offset:16896
    v_exp_f32 v60, v60
    v_exp_f32 v61, v61
    v_exp_f32 v62, v62
    v_exp_f32 v63, v63
    v_mfma_f32_16x16x32_bf16 v[92:95], v[96:99], v[64:67], v[92:95]
    v_cvt_pk_bf16_f32 v68, v56, v57
    v_cvt_pk_bf16_f32 v69, v58, v59
    v_cvt_pk_bf16_f32 v70, v60, v61
    v_cvt_pk_bf16_f32 v71, v62, v63
    v_mfma_f32_32x32x16_bf16 v[48:63], v[72:75], v[232:235], v[144:159]
    ds_read_b128 v[72:75], v1 offset:18432
    v_exp_f32 v32, v32
    v_exp_f32 v33, v33
    v_exp_f32 v34, v34
    v_exp_f32 v35, v35
    v_mfma_f32_32x32x16_bf16 v[176:191], v[84:87], v[68:71], v[176:191]
    ds_read_b64_tr_b16 v[84:85], v2 offset:17408
    ds_read_b64_tr_b16 v[86:87], v2 offset:17920
    v_exp_f32 v36, v36
    v_exp_f32 v37, v37
    v_exp_f32 v38, v38
    v_exp_f32 v39, v39
    v_mfma_f32_32x32x16_bf16 v[48:63], v[76:79], v[236:239], v[48:63]
    ds_read_b128 v[76:79], v1 offset:19456
    v_exp_f32 v40, v40
    v_cvt_pk_bf16_f32 v64, v32, v33
    v_cvt_pk_bf16_f32 v65, v34, v35
    v_cvt_pk_bf16_f32 v66, v36, v37
    v_cvt_pk_bf16_f32 v67, v38, v39
    v_exp_f32 v41, v41
    v_mfma_f32_16x16x32_bf16 v[92:95], v[96:99], v[68:71], v[92:95]
    v_exp_f32 v42, v42
    v_exp_f32 v43, v43
    s_waitcnt lgkmcnt(1)
    v_mfma_f32_32x32x16_bf16 v[160:175], v[80:83], v[64:67], v[160:175]
    v_exp_f32 v44, v44
    v_exp_f32 v45, v45
    v_exp_f32 v46, v46
    v_exp_f32 v47, v47
    v_mfma_f32_16x16x32_bf16 v[88:91], v[96:99], v[64:67], v[88:91]
    v_cvt_pk_bf16_f32 v68, v40, v41
    v_cvt_pk_bf16_f32 v69, v42, v43
    v_cvt_pk_bf16_f32 v70, v44, v45
    v_cvt_pk_bf16_f32 v71, v46, v47
    v_mfma_f32_32x32x16_bf16 v[32:47], v[72:75], v[224:227], v[128:143]
    v_exp_f32 v48, v48
    v_exp_f32 v49, v49
    v_exp_f32 v50, v50
    v_exp_f32 v51, v51
    v_mfma_f32_32x32x16_bf16 v[160:175], v[84:87], v[68:71], v[160:175]
    v_exp_f32 v52, v52
    v_exp_f32 v53, v53
    v_exp_f32 v54, v54
    v_exp_f32 v55, v55
    s_waitcnt lgkmcnt(0)
    v_mfma_f32_32x32x16_bf16 v[32:47], v[76:79], v[228:231], v[32:47]
    v_exp_f32 v56, v56
    v_cvt_pk_bf16_f32 v64, v48, v49
    v_cvt_pk_bf16_f32 v65, v50, v51
    v_cvt_pk_bf16_f32 v66, v52, v53
    v_cvt_pk_bf16_f32 v67, v54, v55
    v_exp_f32 v57, v57
    v_mfma_f32_16x16x32_bf16 v[88:91], v[96:99], v[68:71], v[88:91]
    v_exp_f32 v58, v58
    v_exp_f32 v59, v59
    v_mfma_f32_32x32x16_bf16 v[176:191], v[80:83], v[64:67], v[176:191]
    ds_read_b64_tr_b16 v[80:81], v2 offset:18432
    ds_read_b64_tr_b16 v[82:83], v2 offset:18944
    v_exp_f32 v60, v60
    v_exp_f32 v61, v61
    v_exp_f32 v62, v62
    v_exp_f32 v63, v63
    v_mfma_f32_16x16x32_bf16 v[92:95], v[96:99], v[64:67], v[92:95]
    v_cvt_pk_bf16_f32 v68, v56, v57
    v_cvt_pk_bf16_f32 v69, v58, v59
    v_cvt_pk_bf16_f32 v70, v60, v61
    v_cvt_pk_bf16_f32 v71, v62, v63
    v_mfma_f32_32x32x16_bf16 v[48:63], v[72:75], v[232:235], v[144:159]
    ds_read_b128 v[72:75], v1 offset:20480
    v_exp_f32 v32, v32
    v_exp_f32 v33, v33
    v_exp_f32 v34, v34
    v_exp_f32 v35, v35
    v_mfma_f32_32x32x16_bf16 v[176:191], v[84:87], v[68:71], v[176:191]
    ds_read_b64_tr_b16 v[84:85], v2 offset:19456
    ds_read_b64_tr_b16 v[86:87], v2 offset:19968
    v_exp_f32 v36, v36
    v_exp_f32 v37, v37
    v_exp_f32 v38, v38
    v_exp_f32 v39, v39
    v_mfma_f32_32x32x16_bf16 v[48:63], v[76:79], v[236:239], v[48:63]
    ds_read_b128 v[76:79], v1 offset:21504
    v_exp_f32 v40, v40
    v_cvt_pk_bf16_f32 v64, v32, v33
    v_cvt_pk_bf16_f32 v65, v34, v35
    v_cvt_pk_bf16_f32 v66, v36, v37
    v_cvt_pk_bf16_f32 v67, v38, v39
    v_exp_f32 v41, v41
    v_mfma_f32_16x16x32_bf16 v[92:95], v[96:99], v[68:71], v[92:95]
    v_exp_f32 v42, v42
    v_exp_f32 v43, v43
    s_waitcnt lgkmcnt(1)
    v_mfma_f32_32x32x16_bf16 v[160:175], v[80:83], v[64:67], v[160:175]
    v_exp_f32 v44, v44
    v_exp_f32 v45, v45
    v_exp_f32 v46, v46
    v_exp_f32 v47, v47
    v_mfma_f32_16x16x32_bf16 v[88:91], v[96:99], v[64:67], v[88:91]
    v_cvt_pk_bf16_f32 v68, v40, v41
    v_cvt_pk_bf16_f32 v69, v42, v43
    v_cvt_pk_bf16_f32 v70, v44, v45
    v_cvt_pk_bf16_f32 v71, v46, v47
    v_mfma_f32_32x32x16_bf16 v[32:47], v[72:75], v[224:227], v[128:143]
    v_add_u32 v5, 1, v5
    s_waitcnt vmcnt(4)
    ds_write_b32 v4, v5
    v_exp_f32 v48, v48
    v_exp_f32 v49, v49
    v_exp_f32 v50, v50
    v_exp_f32 v51, v51
    v_mfma_f32_32x32x16_bf16 v[160:175], v[84:87], v[68:71], v[160:175]
    v_exp_f32 v52, v52
    v_exp_f32 v53, v53
    v_exp_f32 v54, v54
    v_exp_f32 v55, v55
    s_waitcnt lgkmcnt(1)
    v_mfma_f32_32x32x16_bf16 v[32:47], v[76:79], v[228:231], v[32:47]
    v_exp_f32 v56, v56
    v_cvt_pk_bf16_f32 v64, v48, v49
    v_cvt_pk_bf16_f32 v65, v50, v51
    v_cvt_pk_bf16_f32 v66, v52, v53
    v_cvt_pk_bf16_f32 v67, v54, v55
    v_exp_f32 v57, v57
    v_mfma_f32_16x16x32_bf16 v[88:91], v[96:99], v[68:71], v[88:91]
    v_exp_f32 v58, v58
    v_exp_f32 v59, v59
    v_mfma_f32_32x32x16_bf16 v[176:191], v[80:83], v[64:67], v[176:191]
    ds_read_b64_tr_b16 v[80:81], v2 offset:20480
    ds_read_b64_tr_b16 v[82:83], v2 offset:20992
    v_exp_f32 v60, v60
    v_exp_f32 v61, v61
    v_exp_f32 v62, v62
    v_exp_f32 v63, v63
    v_mfma_f32_16x16x32_bf16 v[92:95], v[96:99], v[64:67], v[92:95]
    v_cvt_pk_bf16_f32 v68, v56, v57
    v_cvt_pk_bf16_f32 v69, v58, v59
    v_cvt_pk_bf16_f32 v70, v60, v61
    v_cvt_pk_bf16_f32 v71, v62, v63
    v_mfma_f32_32x32x16_bf16 v[48:63], v[72:75], v[232:235], v[144:159]
    ds_read_b128 v[72:75], v1 offset:22528
    v_exp_f32 v32, v32
    v_exp_f32 v33, v33
    v_exp_f32 v34, v34
    v_exp_f32 v35, v35
    v_mfma_f32_32x32x16_bf16 v[176:191], v[84:87], v[68:71], v[176:191]
    ds_read_b64_tr_b16 v[84:85], v2 offset:21504
    ds_read_b64_tr_b16 v[86:87], v2 offset:22016
    v_exp_f32 v36, v36
    v_exp_f32 v37, v37
    v_exp_f32 v38, v38
    v_exp_f32 v39, v39
    v_mfma_f32_32x32x16_bf16 v[48:63], v[76:79], v[236:239], v[48:63]
    ds_read_b128 v[76:79], v1 offset:23552
    v_exp_f32 v40, v40
    v_cvt_pk_bf16_f32 v64, v32, v33
    v_cvt_pk_bf16_f32 v65, v34, v35
    v_cvt_pk_bf16_f32 v66, v36, v37
    v_cvt_pk_bf16_f32 v67, v38, v39
    v_exp_f32 v41, v41
    v_mfma_f32_16x16x32_bf16 v[92:95], v[96:99], v[68:71], v[92:95]
    v_exp_f32 v42, v42
    v_exp_f32 v43, v43
    s_waitcnt lgkmcnt(1)
    v_mfma_f32_32x32x16_bf16 v[160:175], v[80:83], v[64:67], v[160:175]
    v_exp_f32 v44, v44
    v_exp_f32 v45, v45
    v_exp_f32 v46, v46
    v_exp_f32 v47, v47
    v_mfma_f32_16x16x32_bf16 v[88:91], v[96:99], v[64:67], v[88:91]
    v_cvt_pk_bf16_f32 v68, v40, v41
    v_cvt_pk_bf16_f32 v69, v42, v43
    v_cvt_pk_bf16_f32 v70, v44, v45
    v_cvt_pk_bf16_f32 v71, v46, v47
    v_mfma_f32_32x32x16_bf16 v[32:47], v[72:75], v[224:227], v[128:143]
    v_exp_f32 v48, v48
    v_exp_f32 v49, v49
    v_exp_f32 v50, v50
    v_exp_f32 v51, v51
    v_mfma_f32_32x32x16_bf16 v[160:175], v[84:87], v[68:71], v[160:175]
    v_exp_f32 v52, v52
    v_exp_f32 v53, v53
    v_exp_f32 v54, v54
    v_exp_f32 v55, v55
    s_waitcnt lgkmcnt(0)
    v_mfma_f32_32x32x16_bf16 v[32:47], v[76:79], v[228:231], v[32:47]
    ds_read_b32 v6, v10
    v_exp_f32 v56, v56
    v_cvt_pk_bf16_f32 v64, v48, v49
    v_cvt_pk_bf16_f32 v65, v50, v51
    v_cvt_pk_bf16_f32 v66, v52, v53
    v_cvt_pk_bf16_f32 v67, v54, v55
    v_exp_f32 v57, v57
    v_mfma_f32_16x16x32_bf16 v[88:91], v[96:99], v[68:71], v[88:91]
    v_exp_f32 v58, v58
    v_exp_f32 v59, v59
    v_mfma_f32_32x32x16_bf16 v[176:191], v[80:83], v[64:67], v[176:191]
    ds_read_b64_tr_b16 v[80:81], v2 offset:22528
    ds_read_b64_tr_b16 v[82:83], v2 offset:23040
    v_exp_f32 v60, v60
    v_exp_f32 v61, v61
    v_exp_f32 v62, v62
    v_exp_f32 v63, v63
    v_mfma_f32_16x16x32_bf16 v[92:95], v[96:99], v[64:67], v[92:95]
    s_waitcnt lgkmcnt(2)
    v_cmp_lt_u32 vcc, v6, v5
    v_cvt_pk_bf16_f32 v68, v56, v57
    v_cvt_pk_bf16_f32 v69, v58, v59
    v_cvt_pk_bf16_f32 v70, v60, v61
    v_cvt_pk_bf16_f32 v71, v62, v63
    s_cbranch_vccnz mk_a_spin1
mk_a_spind1:
    v_mfma_f32_32x32x16_bf16 v[48:63], v[72:75], v[232:235], v[144:159]
    ds_read_b128 v[72:75], v1 offset:32768
    v_exp_f32 v32, v32
    v_exp_f32 v33, v33
    v_exp_f32 v34, v34
    v_exp_f32 v35, v35
    v_mfma_f32_32x32x16_bf16 v[176:191], v[84:87], v[68:71], v[176:191]
    ds_read_b64_tr_b16 v[84:85], v2 offset:23552
    ds_read_b64_tr_b16 v[86:87], v2 offset:24064
    v_exp_f32 v36, v36
    v_exp_f32 v37, v37
    v_exp_f32 v38, v38
    v_exp_f32 v39, v39
    v_mfma_f32_32x32x16_bf16 v[48:63], v[76:79], v[236:239], v[48:63]
    ds_read_b128 v[76:79], v1 offset:33792
    v_exp_f32 v40, v40
    v_cvt_pk_bf16_f32 v64, v32, v33
    v_cvt_pk_bf16_f32 v65, v34, v35
    v_cvt_pk_bf16_f32 v66, v36, v37
    v_cvt_pk_bf16_f32 v67, v38, v39
    v_exp_f32 v41, v41
    v_mfma_f32_16x16x32_bf16 v[92:95], v[96:99], v[68:71], v[92:95]
    v_exp_f32 v42, v42
    v_exp_f32 v43, v43
    s_waitcnt lgkmcnt(1)
    v_mfma_f32_32x32x16_bf16 v[160:175], v[80:83], v[64:67], v[160:175]
    s_add_u32 m0, s32, 0
    s_add_u32 s30, s30, 16384
    s_and_b32 s30, s30, 0x3ffff
    buffer_load_dwordx4 v8, s[8:11], s30 offen sc1 lds
    v_exp_f32 v44, v44
    v_exp_f32 v45, v45
    v_exp_f32 v46, v46
    v_exp_f32 v47, v47
    v_mfma_f32_16x16x32_bf16 v[88:91], v[96:99], v[64:67], v[88:91]
    v_cvt_pk_bf16_f32 v68, v40, v41
    v_cvt_pk_bf16_f32 v69, v42, v43
    v_cvt_pk_bf16_f32 v70, v44, v45
    v_cvt_pk_bf16_f32 v71, v46, v47
    v_mfma_f32_32x32x16_bf16 v[32:47], v[72:75], v[224:227], v[128:143]
    buffer_load_dwordx4 v8, s[8:11], s30 offen offset:1024 sc1 lds
    v_exp_f32 v48, v48
    v_exp_f32 v49, v49
    v_exp_f32 v50, v50
    v_exp_f32 v51, v51
    v_mfma_f32_32x32x16_bf16 v[160:175], v[84:87], v[68:71], v[160:175]
    buffer_load_dwordx4 v8, s[8:11], s30 offen offset:2048 sc1 lds
    v_exp_f32 v52, v52
    v_exp_f32 v53, v53
    v_exp_f32 v54, v54
    v_exp_f32 v55, v55
    s_waitcnt lgkmcnt(0)
    v_mfma_f32_32x32x16_bf16 v[32:47], v[76:79], v[228:231], v[32:47]
    buffer_load_dwordx4 v8, s[8:11], s30 offen offset:3072 sc1 lds
    v_exp_f32 v56, v56
    v_cvt_pk_bf16_f32 v64, v48, v49
    v_cvt_pk_bf16_f32 v65, v50, v51
    v_cvt_pk_bf16_f32 v66, v52, v53
    v_cvt_pk_bf16_f32 v67, v54, v55
    v_exp_f32 v57, v57
    v_mfma_f32_16x16x32_bf16 v[88:91], v[96:99], v[68:71], v[88:91]
    v_exp_f32 v58, v58
    v_exp_f32 v59, v59
    v_mfma_f32_32x32x16_bf16 v[176:191], v[80:83], v[64:67], v[176:191]
    ds_read_b64_tr_b16 v[80:81], v2 offset:32768
    ds_read_b64_tr_b16 v[82:83], v2 offset:33280
    v_exp_f32 v60, v60
    v_exp_f32 v61, v61
    v_exp_f32 v62, v62
    v_exp_f32 v63, v63
    v_mfma_f32_16x16x32_bf16 v[92:95], v[96:99], v[64:67], v[92:95]
    v_cvt_pk_bf16_f32 v68, v56, v57
    v_cvt_pk_bf16_f32 v69, v58, v59
    v_cvt_pk_bf16_f32 v70, v60, v61
    v_cvt_pk_bf16_f32 v71, v62, v63
    v_mfma_f32_32x32x16_bf16 v[48:63], v[72:75], v[232:235], v[144:159]
    ds_read_b128 v[72:75], v1 offset:34816
    v_exp_f32 v32, v32
    v_exp_f32 v33, v33
    v_exp_f32 v34, v34
    v_exp_f32 v35, v35
    v_mfma_f32_32x32x16_bf16 v[176:191], v[84:87], v[68:71], v[176:191]
    ds_read_b64_tr_b16 v[84:85], v2 offset:33792
    ds_read_b64_tr_b16 v[86:87], v2 offset:34304
    v_exp_f32 v36, v36
    v_exp_f32 v37, v37
    v_exp_f32 v38, v38
    v_exp_f32 v39, v39
    v_mfma_f32_32x32x16_bf16 v[48:63], v[76:79], v[236:239], v[48:63]
    ds_read_b128 v[76:79], v1 offset:35840
    v_exp_f32 v40, v40
    v_cvt_pk_bf16_f32 v64, v32, v33
    v_cvt_pk_bf16_f32 v65, v34, v35
    v_cvt_pk_bf16_f32 v66, v36, v37
    v_cvt_pk_bf16_f32 v67, v38, v39
    v_exp_f32 v41, v41
    v_mfma_f32_16x16x32_bf16 v[92:95], v[96:99], v[68:71], v[92:95]
    v_exp_f32 v42, v42
    v_exp_f32 v43, v43
    s_waitcnt lgkmcnt(1)
    v_mfma_f32_32x32x16_bf16 v[160:175], v[80:83], v[64:67], v[160:175]
    v_exp_f32 v44, v44
    v_exp_f32 v45, v45
    v_exp_f32 v46, v46
    v_exp_f32 v47, v47
    v_mfma_f32_16x16x32_bf16 v[88:91], v[96:99], v[64:67], v[88:91]
    v_cvt_pk_bf16_f32 v68, v40, v41
    v_cvt_pk_bf16_f32 v69, v42, v43
    v_cvt_pk_bf16_f32 v70, v44, v45
    v_cvt_pk_bf16_f32 v71, v46, v47
    v_mfma_f32_32x32x16_bf16 v[32:47], v[72:75], v[224:227], v[128:143]
    v_exp_f32 v48, v48
    v_exp_f32 v49, v49
    v_exp_f32 v50, v50
    v_exp_f32 v51, v51
    v_mfma_f32_32x32x16_bf16 v[160:175], v[84:87], v[68:71], v[160:175]
    v_exp_f32 v52, v52
    v_exp_f32 v53, v53
    v_exp_f32 v54, v54
    v_exp_f32 v55, v55
    s_waitcnt lgkmcnt(0)
    v_mfma_f32_32x32x16_bf16 v[32:47], v[76:79], v[228:231], v[32:47]
    v_exp_f32 v56, v56
    v_cvt_pk_bf16_f32 v64, v48, v49
    v_cvt_pk_bf16_f32 v65, v50, v51
    v_cvt_pk_bf16_f32 v66, v52, v53
    v_cvt_pk_bf16_f32 v67, v54, v55
    v_exp_f32 v57, v57
    v_mfma_f32_16x16x32_bf16 v[88:91], v[96:99], v[68:71], v[88:91]
    v_exp_f32 v58, v58
    v_exp_f32 v59, v59
    v_mfma_f32_32x32x16_bf16 v[176:191], v[80:83], v[64:67], v[176:191]
    ds_read_b64_tr_b16 v[80:81], v2 offset:34816
    ds_read_b64_tr_b16 v[82:83], v2 offset:35328
    v_exp_f32 v60, v60
    v_exp_f32 v61, v61
    v_exp_f32 v62, v62
    v_exp_f32 v63, v63
    v_mfma_f32_16x16x32_bf16 v[92:95], v[96:99], v[64:67], v[92:95]
    v_cvt_pk_bf16_f32 v68, v56, v57
    v_cvt_pk_bf16_f32 v69, v58, v59
    v_cvt_pk_bf16_f32 v70, v60, v61
    v_cvt_pk_bf16_f32 v71, v62, v63
    v_mfma_f32_32x32x16_bf16 v[48:63], v[72:75], v[232:235], v[144:159]
    ds_read_b128 v[72:75], v1 offset:36864
    v_exp_f32 v32, v32
    v_exp_f32 v33, v33
    v_exp_f32 v34, v34
    v_exp_f32 v35, v35
    v_mfma_f32_32x32x16_bf16 v[176:191], v[84:87], v[68:71], v[176:191]
    ds_read_b64_tr_b16 v[84:85], v2 offset:35840
    ds_read_b64_tr_b16 v[86:87], v2 offset:36352
    v_exp_f32 v36, v36
    v_exp_f32 v37, v37
    v_exp_f32 v38, v38
    v_exp_f32 v39, v39
    v_mfma_f32_32x32x16_bf16 v[48:63], v[76:79], v[236:239], v[48:63]
    ds_read_b128 v[76:79], v1 offset:37888
    v_exp_f32 v40, v40
    v_cvt_pk_bf16_f32 v64, v32, v33
    v_cvt_pk_bf16_f32 v65, v34, v35
    v_cvt_pk_bf16_f32 v66, v36, v37
    v_cvt_pk_bf16_f32 v67, v38, v39
    v_exp_f32 v41, v41
    v_mfma_f32_16x16x32_bf16 v[92:95], v[96:99], v[68:71], v[92:95]
    v_exp_f32 v42, v42
    v_exp_f32 v43, v43
    s_waitcnt lgkmcnt(1)
    v_mfma_f32_32x32x16_bf16 v[160:175], v[80:83], v[64:67], v[160:175]
    v_exp_f32 v44, v44
    v_exp_f32 v45, v45
    v_exp_f32 v46, v46
    v_exp_f32 v47, v47
    v_mfma_f32_16x16x32_bf16 v[88:91], v[96:99], v[64:67], v[88:91]
    v_cvt_pk_bf16_f32 v68, v40, v41
    v_cvt_pk_bf16_f32 v69, v42, v43
    v_cvt_pk_bf16_f32 v70, v44, v45
    v_cvt_pk_bf16_f32 v71, v46, v47
    v_mfma_f32_32x32x16_bf16 v[32:47], v[72:75], v[224:227], v[128:143]
    v_add_u32 v5, 1, v5
    s_waitcnt vmcnt(4)
    ds_write_b32 v4, v5
    v_exp_f32 v48, v48
    v_exp_f32 v49, v49
    v_exp_f32 v50, v50
    v_exp_f32 v51, v51
    v_mfma_f32_32x32x16_bf16 v[160:175], v[84:87], v[68:71], v[160:175]
    v_exp_f32 v52, v52
    v_exp_f32 v53, v53
    v_exp_f32 v54, v54
    v_exp_f32 v55, v55
    s_waitcnt lgkmcnt(1)
    v_mfma_f32_32x32x16_bf16 v[32:47], v[76:79], v[228:231], v[32:47]
    v_exp_f32 v56, v56
    v_cvt_pk_bf16_f32 v64, v48, v49
    v_cvt_pk_bf16_f32 v65, v50, v51
    v_cvt_pk_bf16_f32 v66, v52, v53
    v_cvt_pk_bf16_f32 v67, v54, v55
    v_exp_f32 v57, v57
    v_mfma_f32_16x16x32_bf16 v[88:91], v[96:99], v[68:71], v[88:91]
    v_exp_f32 v58, v58
    v_exp_f32 v59, v59
    v_mfma_f32_32x32x16_bf16 v[176:191], v[80:83], v[64:67], v[176:191]
    ds_read_b64_tr_b16 v[80:81], v2 offset:36864
    ds_read_b64_tr_b16 v[82:83], v2 offset:37376
    v_exp_f32 v60, v60
    v_exp_f32 v61, v61
    v_exp_f32 v62, v62
    v_exp_f32 v63, v63
    v_mfma_f32_16x16x32_bf16 v[92:95], v[96:99], v[64:67], v[92:95]
    v_cvt_pk_bf16_f32 v68, v56, v57
    v_cvt_pk_bf16_f32 v69, v58, v59
    v_cvt_pk_bf16_f32 v70, v60, v61
    v_cvt_pk_bf16_f32 v71, v62, v63
    v_mfma_f32_32x32x16_bf16 v[48:63], v[72:75], v[232:235], v[144:159]
    ds_read_b128 v[72:75], v1 offset:38912
    v_exp_f32 v32, v32
    v_exp_f32 v33, v33
    v_exp_f32 v34, v34
    v_exp_f32 v35, v35
    v_mfma_f32_32x32x16_bf16 v[176:191], v[84:87], v[68:71], v[176:191]
    ds_read_b64_tr_b16 v[84:85], v2 offset:37888
    ds_read_b64_tr_b16 v[86:87], v2 offset:38400
    v_exp_f32 v36, v36
    v_exp_f32 v37, v37
    v_exp_f32 v38, v38
    v_exp_f32 v39, v39
    v_mfma_f32_32x32x16_bf16 v[48:63], v[76:79], v[236:239], v[48:63]
    ds_read_b128 v[76:79], v1 offset:39936
    v_exp_f32 v40, v40
    v_cvt_pk_bf16_f32 v64, v32, v33
    v_cvt_pk_bf16_f32 v65, v34, v35
    v_cvt_pk_bf16_f32 v66, v36, v37
    v_cvt_pk_bf16_f32 v67, v38, v39
    v_exp_f32 v41, v41
    v_mfma_f32_16x16x32_bf16 v[92:95], v[96:99], v[68:71], v[92:95]
    v_exp_f32 v42, v42
    v_exp_f32 v43, v43
    s_waitcnt lgkmcnt(1)
    v_mfma_f32_32x32x16_bf16 v[160:175], v[80:83], v[64:67], v[160:175]
    v_exp_f32 v44, v44
    v_exp_f32 v45, v45
    v_exp_f32 v46, v46
    v_exp_f32 v47, v47
    v_mfma_f32_16x16x32_bf16 v[88:91], v[96:99], v[64:67], v[88:91]
    v_cvt_pk_bf16_f32 v68, v40, v41
    v_cvt_pk_bf16_f32 v69, v42, v43
    v_cvt_pk_bf16_f32 v70, v44, v45
    v_cvt_pk_bf16_f32 v71, v46, v47
    v_mfma_f32_32x32x16_bf16 v[32:47], v[72:75], v[224:227], v[128:143]
    v_exp_f32 v48, v48
    v_exp_f32 v49, v49
    v_exp_f32 v50, v50
    v_exp_f32 v51, v51
    v_mfma_f32_32x32x16_bf16 v[160:175], v[84:87], v[68:71], v[160:175]
    v_exp_f32 v52, v52
    v_exp_f32 v53, v53
    v_exp_f32 v54, v54
    v_exp_f32 v55, v55
    s_waitcnt lgkmcnt(0)
    v_mfma_f32_32x32x16_bf16 v[32:47], v[76:79], v[228:231], v[32:47]
    ds_read_b32 v6, v10
    v_exp_f32 v56, v56
    v_cvt_pk_bf16_f32 v64, v48, v49
    v_cvt_pk_bf16_f32 v65, v50, v51
    v_cvt_pk_bf16_f32 v66, v52, v53
    v_cvt_pk_bf16_f32 v67, v54, v55
    v_exp_f32 v57, v57
    v_mfma_f32_16x16x32_bf16 v[88:91], v[96:99], v[68:71], v[88:91]
    v_exp_f32 v58, v58
    v_exp_f32 v59, v59
    v_mfma_f32_32x32x16_bf16 v[176:191], v[80:83], v[64:67], v[176:191]
    ds_read_b64_tr_b16 v[80:81], v2 offset:38912
    ds_read_b64_tr_b16 v[82:83], v2 offset:39424
    v_exp_f32 v60, v60
    v_exp_f32 v61, v61
    v_exp_f32 v62, v62
    v_exp_f32 v63, v63
    v_mfma_f32_16x16x32_bf16 v[92:95], v[96:99], v[64:67], v[92:95]
    s_waitcnt lgkmcnt(2)
    v_cmp_lt_u32 vcc, v6, v5
    v_cvt_pk_bf16_f32 v68, v56, v57
    v_cvt_pk_bf16_f32 v69, v58, v59
    v_cvt_pk_bf16_f32 v70, v60, v61
    v_cvt_pk_bf16_f32 v71, v62, v63
    s_cbranch_vccnz mk_a_spin2
mk_a_spind2:
    v_mfma_f32_32x32x16_bf16 v[48:63], v[72:75], v[232:235], v[144:159]
    ds_read_b128 v[72:75], v1 offset:49152
    v_exp_f32 v32, v32
    v_exp_f32 v33, v33
    v_exp_f32 v34, v34
    v_exp_f32 v35, v35
    v_mfma_f32_32x32x16_bf16 v[176:191], v[84:87], v[68:71], v[176:191]
    ds_read_b64_tr_b16 v[84:85], v2 offset:39936
    ds_read_b64_tr_b16 v[86:87], v2 offset:40448
    v_exp_f32 v36, v36
    v_exp_f32 v37, v37
    v_exp_f32 v38, v38
    v_exp_f32 v39, v39
    v_mfma_f32_32x32x16_bf16 v[48:63], v[76:79], v[236:239], v[48:63]
    ds_read_b128 v[76:79], v1 offset:50176
    v_exp_f32 v40, v40
    v_cvt_pk_bf16_f32 v64, v32, v33
    v_cvt_pk_bf16_f32 v65, v34, v35
    v_cvt_pk_bf16_f32 v66, v36, v37
    v_cvt_pk_bf16_f32 v67, v38, v39
    v_exp_f32 v41, v41
    v_mfma_f32_16x16x32_bf16 v[92:95], v[96:99], v[68:71], v[92:95]
    v_exp_f32 v42, v42
    v_exp_f32 v43, v43
    s_waitcnt lgkmcnt(1)
    v_mfma_f32_32x32x16_bf16 v[160:175], v[80:83], v[64:67], v[160:175]
    s_add_u32 m0, s32, 16384
    s_add_u32 s30, s30, 16384
    s_and_b32 s30, s30, 0x3ffff
    buffer_load_dwordx4 v8, s[8:11], s30 offen sc1 lds
    v_exp_f32 v44, v44
    v_exp_f32 v45, v45
    v_exp_f32 v46, v46
    v_exp_f32 v47, v47
    v_mfma_f32_16x16x32_bf16 v[88:91], v[96:99], v[64:67], v[88:91]
    v_cvt_pk_bf16_f32 v68, v40, v41
    v_cvt_pk_bf16_f32 v69, v42, v43
    v_cvt_pk_bf16_f32 v70, v44, v45
    v_cvt_pk_bf16_f32 v71, v46, v47
    v_mfma_f32_32x32x16_bf16 v[32:47], v[72:75], v[224:227], v[128:143]
    buffer_load_dwordx4 v8, s[8:11], s30 offen offset:1024 sc1 lds
    v_exp_f32 v48, v48
    v_exp_f32 v49, v49
    v_exp_f32 v50, v50
    v_exp_f32 v51, v51
    v_mfma_f32_32x32x16_bf16 v[160:175], v[84:87], v[68:71], v[160:175]
    buffer_load_dwordx4 v8, s[8:11], s30 offen offset:2048 sc1 lds
    v_exp_f32 v52, v52
    v_exp_f32 v53, v53
    v_exp_f32 v54, v54
    v_exp_f32 v55, v55
    s_waitcnt lgkmcnt(0)
    v_mfma_f32_32x32x16_bf16 v[32:47], v[76:79], v[228:231], v[32:47]
    buffer_load_dwordx4 v8, s[8:11], s30 offen offset:3072 sc1 lds
    v_exp_f32 v56, v56
    v_cvt_pk_bf16_f32 v64, v48, v49
    v_cvt_pk_bf16_f32 v65, v50, v51
    v_cvt_pk_bf16_f32 v66, v52, v53
    v_cvt_pk_bf16_f32 v67, v54, v55
    v_exp_f32 v57, v57
    v_mfma_f32_16x16x32_bf16 v[88:91], v[96:99], v[68:71], v[88:91]
    v_exp_f32 v58, v58
    v_exp_f32 v59, v59
    v_mfma_f32_32x32x16_bf16 v[176:191], v[80:83], v[64:67], v[176:191]
    ds_read_b64_tr_b16 v[80:81], v2 offset:49152
    ds_read_b64_tr_b16 v[82:83], v2 offset:49664
    v_exp_f32 v60, v60
    v_exp_f32 v61, v61
    v_exp_f32 v62, v62
    v_exp_f32 v63, v63
    v_mfma_f32_16x16x32_bf16 v[92:95], v[96:99], v[64:67], v[92:95]
    v_cvt_pk_bf16_f32 v68, v56, v57
    v_cvt_pk_bf16_f32 v69, v58, v59
    v_cvt_pk_bf16_f32 v70, v60, v61
    v_cvt_pk_bf16_f32 v71, v62, v63
    v_mfma_f32_32x32x16_bf16 v[48:63], v[72:75], v[232:235], v[144:159]
    ds_read_b128 v[72:75], v1 offset:51200
    v_exp_f32 v32, v32
    v_exp_f32 v33, v33
    v_exp_f32 v34, v34
    v_exp_f32 v35, v35
    v_mfma_f32_32x32x16_bf16 v[176:191], v[84:87], v[68:71], v[176:191]
    ds_read_b64_tr_b16 v[84:85], v2 offset:50176
    ds_read_b64_tr_b16 v[86:87], v2 offset:50688
    v_exp_f32 v36, v36
    v_exp_f32 v37, v37
    v_exp_f32 v38, v38
    v_exp_f32 v39, v39
    v_mfma_f32_32x32x16_bf16 v[48:63], v[76:79], v[236:239], v[48:63]
    ds_read_b128 v[76:79], v1 offset:52224
    v_exp_f32 v40, v40
    v_cvt_pk_bf16_f32 v64, v32, v33
    v_cvt_pk_bf16_f32 v65, v34, v35
    v_cvt_pk_bf16_f32 v66, v36, v37
    v_cvt_pk_bf16_f32 v67, v38, v39
    v_exp_f32 v41, v41
    v_mfma_f32_16x16x32_bf16 v[92:95], v[96:99], v[68:71], v[92:95]
    v_exp_f32 v42, v42
    v_exp_f32 v43, v43
    s_waitcnt lgkmcnt(1)
    v_mfma_f32_32x32x16_bf16 v[160:175], v[80:83], v[64:67], v[160:175]
    v_exp_f32 v44, v44
    v_exp_f32 v45, v45
    v_exp_f32 v46, v46
    v_exp_f32 v47, v47
    v_mfma_f32_16x16x32_bf16 v[88:91], v[96:99], v[64:67], v[88:91]
    v_cvt_pk_bf16_f32 v68, v40, v41
    v_cvt_pk_bf16_f32 v69, v42, v43
    v_cvt_pk_bf16_f32 v70, v44, v45
    v_cvt_pk_bf16_f32 v71, v46, v47
    v_mfma_f32_32x32x16_bf16 v[32:47], v[72:75], v[224:227], v[128:143]
    v_exp_f32 v48, v48
    v_exp_f32 v49, v49
    v_exp_f32 v50, v50
    v_exp_f32 v51, v51
    v_mfma_f32_32x32x16_bf16 v[160:175], v[84:87], v[68:71], v[160:175]
    v_exp_f32 v52, v52
    v_exp_f32 v53, v53
    v_exp_f32 v54, v54
    v_exp_f32 v55, v55
    s_waitcnt lgkmcnt(0)
    v_mfma_f32_32x32x16_bf16 v[32:47], v[76:79], v[228:231], v[32:47]
    v_exp_f32 v56, v56
    v_cvt_pk_bf16_f32 v64, v48, v49
    v_cvt_pk_bf16_f32 v65, v50, v51
    v_cvt_pk_bf16_f32 v66, v52, v53
    v_cvt_pk_bf16_f32 v67, v54, v55
    v_exp_f32 v57, v57
    v_mfma_f32_16x16x32_bf16 v[88:91], v[96:99], v[68:71], v[88:91]
    v_exp_f32 v58, v58
    v_exp_f32 v59, v59
    v_mfma_f32_32x32x16_bf16 v[176:191], v[80:83], v[64:67], v[176:191]
    ds_read_b64_tr_b16 v[80:81], v2 offset:51200
    ds_read_b64_tr_b16 v[82:83], v2 offset:51712
    v_exp_f32 v60, v60
    v_exp_f32 v61, v61
    v_exp_f32 v62, v62
    v_exp_f32 v63, v63
    v_mfma_f32_16x16x32_bf16 v[92:95], v[96:99], v[64:67], v[92:95]
    v_cvt_pk_bf16_f32 v68, v56, v57
    v_cvt_pk_bf16_f32 v69, v58, v59
    v_cvt_pk_bf16_f32 v70, v60, v61
    v_cvt_pk_bf16_f32 v71, v62, v63
    v_mfma_f32_32x32x16_bf16 v[48:63], v[72:75], v[232:235], v[144:159]
    ds_read_b128 v[72:75], v1 offset:53248
    v_exp_f32 v32, v32
    v_exp_f32 v33, v33
    v_exp_f32 v34, v34
    v_exp_f32 v35, v35
    v_mfma_f32_32x32x16_bf16 v[176:191], v[84:87], v[68:71], v[176:191]
    ds_read_b64_tr_b16 v[84:85], v2 offset:52224
    ds_read_b64_tr_b16 v[86:87], v2 offset:52736
    v_exp_f32 v36, v36
    v_exp_f32 v37, v37
    v_exp_f32 v38, v38
    v_exp_f32 v39, v39
    v_mfma_f32_32x32x16_bf16 v[48:63], v[76:79], v[236:239], v[48:63]
    ds_read_b128 v[76:79], v1 offset:54272
    v_exp_f32 v40, v40
    v_cvt_pk_bf16_f32 v64, v32, v33
    v_cvt_pk_bf16_f32 v65, v34, v35
    v_cvt_pk_bf16_f32 v66, v36, v37
    v_cvt_pk_bf16_f32 v67, v38, v39
    v_exp_f32 v41, v41
    v_mfma_f32_16x16x32_bf16 v[92:95], v[96:99], v[68:71], v[92:95]
    v_exp_f32 v42, v42
    v_exp_f32 v43, v43
    s_waitcnt lgkmcnt(1)
    v_mfma_f32_32x32x16_bf16 v[160:175], v[80:83], v[64:67], v[160:175]
    v_exp_f32 v44, v44
    v_exp_f32 v45, v45
    v_exp_f32 v46, v46
    v_exp_f32 v47, v47
    v_mfma_f32_16x16x32_bf16 v[88:91], v[96:99], v[64:67], v[88:91]
    v_cvt_pk_bf16_f32 v68, v40, v41
    v_cvt_pk_bf16_f32 v69, v42, v43
    v_cvt_pk_bf16_f32 v70, v44, v45
    v_cvt_pk_bf16_f32 v71, v46, v47
    v_mfma_f32_32x32x16_bf16 v[32:47], v[72:75], v[224:227], v[128:143]
    v_add_u32 v5, 1, v5
    s_waitcnt vmcnt(4)
    ds_write_b32 v4, v5
    v_exp_f32 v48, v48
    v_exp_f32 v49, v49
    v_exp_f32 v50, v50
    v_exp_f32 v51, v51
    v_mfma_f32_32x32x16_bf16 v[160:175], v[84:87], v[68:71], v[160:175]
    v_exp_f32 v52, v52
    v_exp_f32 v53, v53
    v_exp_f32 v54, v54
    v_exp_f32 v55, v55
    s_waitcnt lgkmcnt(1)
    v_mfma_f32_32x32x16_bf16 v[32:47], v[76:79], v[228:231], v[32:47]
    v_exp_f32 v56, v56
    v_cvt_pk_bf16_f32 v64, v48, v49
    v_cvt_pk_bf16_f32 v65, v50, v51
    v_cvt_pk_bf16_f32 v66, v52, v53
    v_cvt_pk_bf16_f32 v67, v54, v55
    v_exp_f32 v57, v57
    v_mfma_f32_16x16x32_bf16 v[88:91], v[96:99], v[68:71], v[88:91]
    v_exp_f32 v58, v58
    v_exp_f32 v59, v59
    v_mfma_f32_32x32x16_bf16 v[176:191], v[80:83], v[64:67], v[176:191]
    ds_read_b64_tr_b16 v[80:81], v2 offset:53248
    ds_read_b64_tr_b16 v[82:83], v2 offset:53760
    v_exp_f32 v60, v60
    v_exp_f32 v61, v61
    v_exp_f32 v62, v62
    v_exp_f32 v63, v63
    v_mfma_f32_16x16x32_bf16 v[92:95], v[96:99], v[64:67], v[92:95]
    v_cvt_pk_bf16_f32 v68, v56, v57
    v_cvt_pk_bf16_f32 v69, v58, v59
    v_cvt_pk_bf16_f32 v70, v60, v61
    v_cvt_pk_bf16_f32 v71, v62, v63
    v_mfma_f32_32x32x16_bf16 v[48:63], v[72:75], v[232:235], v[144:159]
    ds_read_b128 v[72:75], v1 offset:55296
    v_exp_f32 v32, v32
    v_exp_f32 v33, v33
    v_exp_f32 v34, v34
    v_exp_f32 v35, v35
    v_mfma_f32_32x32x16_bf16 v[176:191], v[84:87], v[68:71], v[176:191]
    ds_read_b64_tr_b16 v[84:85], v2 offset:54272
    ds_read_b64_tr_b16 v[86:87], v2 offset:54784
    v_exp_f32 v36, v36
    v_exp_f32 v37, v37
    v_exp_f32 v38, v38
    v_exp_f32 v39, v39
    v_mfma_f32_32x32x16_bf16 v[48:63], v[76:79], v[236:239], v[48:63]
    ds_read_b128 v[76:79], v1 offset:56320
    v_exp_f32 v40, v40
    v_cvt_pk_bf16_f32 v64, v32, v33
    v_cvt_pk_bf16_f32 v65, v34, v35
    v_cvt_pk_bf16_f32 v66, v36, v37
    v_cvt_pk_bf16_f32 v67, v38, v39
    v_exp_f32 v41, v41
    v_mfma_f32_16x16x32_bf16 v[92:95], v[96:99], v[68:71], v[92:95]
    v_exp_f32 v42, v42
    v_exp_f32 v43, v43
    s_waitcnt lgkmcnt(1)
    v_mfma_f32_32x32x16_bf16 v[160:175], v[80:83], v[64:67], v[160:175]
    v_exp_f32 v44, v44
    v_exp_f32 v45, v45
    v_exp_f32 v46, v46
    v_exp_f32 v47, v47
    v_mfma_f32_16x16x32_bf16 v[88:91], v[96:99], v[64:67], v[88:91]
    v_cvt_pk_bf16_f32 v68, v40, v41
    v_cvt_pk_bf16_f32 v69, v42, v43
    v_cvt_pk_bf16_f32 v70, v44, v45
    v_cvt_pk_bf16_f32 v71, v46, v47
    v_mfma_f32_32x32x16_bf16 v[32:47], v[72:75], v[224:227], v[128:143]
    v_exp_f32 v48, v48
    v_exp_f32 v49, v49
    v_exp_f32 v50, v50
    v_exp_f32 v51, v51
    v_mfma_f32_32x32x16_bf16 v[160:175], v[84:87], v[68:71], v[160:175]
    v_exp_f32 v52, v52
    v_exp_f32 v53, v53
    v_exp_f32 v54, v54
    v_exp_f32 v55, v55
    s_waitcnt lgkmcnt(0)
    v_mfma_f32_32x32x16_bf16 v[32:47], v[76:79], v[228:231], v[32:47]
    ds_read_b32 v6, v10
    v_exp_f32 v56, v56
    v_cvt_pk_bf16_f32 v64, v48, v49
    v_cvt_pk_bf16_f32 v65, v50, v51
    v_cvt_pk_bf16_f32 v66, v52, v53
    v_cvt_pk_bf16_f32 v67, v54, v55
    v_exp_f32 v57, v57
    v_mfma_f32_16x16x32_bf16 v[88:91], v[96:99], v[68:71], v[88:91]
    v_exp_f32 v58, v58
    v_exp_f32 v59, v59
    v_mfma_f32_32x32x16_bf16 v[176:191], v[80:83], v[64:67], v[176:191]
    ds_read_b64_tr_b16 v[80:81], v2 offset:55296
    ds_read_b64_tr_b16 v[82:83], v2 offset:55808
    v_exp_f32 v60, v60
    v_exp_f32 v61, v61
    v_exp_f32 v62, v62
    v_exp_f32 v63, v63
    v_mfma_f32_16x16x32_bf16 v[92:95], v[96:99], v[64:67], v[92:95]
    s_waitcnt lgkmcnt(2)
    v_cmp_lt_u32 vcc, v6, v5
    v_cvt_pk_bf16_f32 v68, v56, v57
    v_cvt_pk_bf16_f32 v69, v58, v59
    v_cvt_pk_bf16_f32 v70, v60, v61
    v_cvt_pk_bf16_f32 v71, v62, v63
    s_cbranch_vccnz mk_a_spin3
mk_a_spind3:
    v_mfma_f32_32x32x16_bf16 v[48:63], v[72:75], v[232:235], v[144:159]
    ds_read_b128 v[72:75], v1 offset:0
    v_exp_f32 v32, v32
    v_exp_f32 v33, v33
    v_exp_f32 v34, v34
    v_exp_f32 v35, v35
    v_mfma_f32_32x32x16_bf16 v[176:191], v[84:87], v[68:71], v[176:191]
    ds_read_b64_tr_b16 v[84:85], v2 offset:56320
    ds_read_b64_tr_b16 v[86:87], v2 offset:56832
    v_exp_f32 v36, v36
    v_exp_f32 v37, v37
    v_exp_f32 v38, v38
    v_exp_f32 v39, v39
    v_mfma_f32_32x32x16_bf16 v[48:63], v[76:79], v[236:239], v[48:63]
    ds_read_b128 v[76:79], v1 offset:1024
    v_exp_f32 v40, v40
    v_cvt_pk_bf16_f32 v64, v32, v33
    v_cvt_pk_bf16_f32 v65, v34, v35
    v_cvt_pk_bf16_f32 v66, v36, v37
    v_cvt_pk_bf16_f32 v67, v38, v39
    v_exp_f32 v41, v41
    v_mfma_f32_16x16x32_bf16 v[92:95], v[96:99], v[68:71], v[92:95]
    v_exp_f32 v42, v42
    v_exp_f32 v43, v43
    s_waitcnt lgkmcnt(1)
    v_mfma_f32_32x32x16_bf16 v[160:175], v[80:83], v[64:67], v[160:175]
    s_add_u32 m0, s32, 32768
    s_add_u32 s30, s30, 16384
    s_and_b32 s30, s30, 0x3ffff
    buffer_load_dwordx4 v8, s[8:11], s30 offen sc1 lds
    v_exp_f32 v44, v44
    v_exp_f32 v45, v45
    v_exp_f32 v46, v46
    v_exp_f32 v47, v47
    v_mfma_f32_16x16x32_bf16 v[88:91], v[96:99], v[64:67], v[88:91]
    v_cvt_pk_bf16_f32 v68, v40, v41
    v_cvt_pk_bf16_f32 v69, v42, v43
    v_cvt_pk_bf16_f32 v70, v44, v45
    v_cvt_pk_bf16_f32 v71, v46, v47
    v_mfma_f32_32x32x16_bf16 v[32:47], v[72:75], v[224:227], v[128:143]
    buffer_load_dwordx4 v8, s[8:11], s30 offen offset:1024 sc1 lds
    v_exp_f32 v48, v48
    v_exp_f32 v49, v49
    v_exp_f32 v50, v50
    v_exp_f32 v51, v51
    v_mfma_f32_32x32x16_bf16 v[160:175], v[84:87], v[68:71], v[160:175]
    buffer_load_dwordx4 v8, s[8:11], s30 offen offset:2048 sc1 lds
    v_exp_f32 v52, v52
    v_exp_f32 v53, v53
    v_exp_f32 v54, v54
    v_exp_f32 v55, v55
    s_waitcnt lgkmcnt(0)
    v_mfma_f32_32x32x16_bf16 v[32:47], v[76:79], v[228:231], v[32:47]
    buffer_load_dwordx4 v8, s[8:11], s30 offen offset:3072 sc1 lds
    v_exp_f32 v56, v56
    v_cvt_pk_bf16_f32 v64, v48, v49
    v_cvt_pk_bf16_f32 v65, v50, v51
    v_cvt_pk_bf16_f32 v66, v52, v53
    v_cvt_pk_bf16_f32 v67, v54, v55
    v_exp_f32 v57, v57
    v_mfma_f32_16x16x32_bf16 v[88:91], v[96:99], v[68:71], v[88:91]
    v_exp_f32 v58, v58
    v_exp_f32 v59, v59
    v_mfma_f32_32x32x16_bf16 v[176:191], v[80:83], v[64:67], v[176:191]
    ds_read_b64_tr_b16 v[80:81], v2 offset:0
    ds_read_b64_tr_b16 v[82:83], v2 offset:512
    v_exp_f32 v60, v60
    v_exp_f32 v61, v61
    v_exp_f32 v62, v62
    v_exp_f32 v63, v63
    v_mfma_f32_16x16x32_bf16 v[92:95], v[96:99], v[64:67], v[92:95]
    v_cvt_pk_bf16_f32 v68, v56, v57
    v_cvt_pk_bf16_f32 v69, v58, v59
    v_cvt_pk_bf16_f32 v70, v60, v61
    v_cvt_pk_bf16_f32 v71, v62, v63
    s_add_u32 s34, s34, 1
    s_cmp_lg_u32 s34, 4
    s_cbranch_scc1 mk_aloop
    s_waitcnt lgkmcnt(0)
    v_mfma_f32_32x32x16_bf16 v[176:191], v[84:87], v[68:71], v[176:191]
    v_mfma_f32_16x16x32_bf16 v[92:95], v[96:99], v[68:71], v[92:95]
    s_setprio 2
    v_mov_b32 v5, 1000
    ds_write_b32 v4, v5
    s_nop 9
    v_sub_f32 v31, v160, v160
    v_fma_f32 v31, v161, 0, v31
    v_fma_f32 v31, v162, 0, v31
    v_fma_f32 v31, v163, 0, v31
    v_fma_f32 v31, v164, 0, v31
    v_fma_f32 v31, v165, 0, v31
    v_fma_f32 v31, v166, 0, v31
    v_fma_f32 v31, v167, 0, v31
    v_fma_f32 v31, v168, 0, v31
    v_fma_f32 v31, v169, 0, v31
    v_fma_f32 v31, v170, 0, v31
    v_fma_f32 v31, v171, 0, v31
    v_fma_f32 v31, v172, 0, v31
    v_fma_f32 v31, v173, 0, v31
    v_fma_f32 v31, v174, 0, v31
    v_fma_f32 v31, v175, 0, v31
    v_add_f32 v31, v31, v88
    v_mov_b32 v30, 0x5f800000
    v_cmp_nlt_f32 vcc, v31, v30
    s_cmp_lg_u64 vcc, 0
    s_cbranch_scc1 mk_slow0
mk_fin0:
    v_rcp_f32 v30, v88
    s_add_u32 s3, s33, 0
    s_mul_i32 s3, s3, 294912
    s_lshl_b32 s4, s27, 11
    s_add_u32 s3, s3, s4
    s_add_u32 s3, s3, 16777216
    v_mul_f32 v160, v160, v30
    v_mul_f32 v161, v161, v30
    v_mul_f32 v162, v162, v30
    v_mul_f32 v163, v163, v30
    v_mul_f32 v164, v164, v30
    v_mul_f32 v165, v165, v30
    v_mul_f32 v166, v166, v30
    v_mul_f32 v167, v167, v30
    v_mul_f32 v168, v168, v30
    v_mul_f32 v169, v169, v30
    v_mul_f32 v170, v170, v30
    v_mul_f32 v171, v171, v30
    v_mul_f32 v172, v172, v30
    v_mul_f32 v173, v173, v30
    v_mul_f32 v174, v174, v30
    v_mul_f32 v175, v175, v30
    v_cvt_pk_bf16_f32 v192, v160, v161
    v_cvt_pk_bf16_f32 v193, v162, v163
    v_cvt_pk_bf16_f32 v194, v164, v165
    v_cvt_pk_bf16_f32 v195, v166, v167
    v_cvt_pk_bf16_f32 v196, v168, v169
    v_cvt_pk_bf16_f32 v197, v170, v171
    v_cvt_pk_bf16_f32 v198, v172, v173
    v_cvt_pk_bf16_f32 v199, v174, v175
    buffer_store_dwordx4 v[192:195], v3, s[8:11], s3 offen sc1
    buffer_store_dwordx4 v[196:199], v3, s[8:11], s3 offen offset:1024 sc1
    v_sub_f32 v31, v176, v176
    v_fma_f32 v31, v177, 0, v31
    v_fma_f32 v31, v178, 0, v31
    v_fma_f32 v31, v179, 0, v31
    v_fma_f32 v31, v180, 0, v31
    v_fma_f32 v31, v181, 0, v31
    v_fma_f32 v31, v182, 0, v31
    v_fma_f32 v31, v183, 0, v31
    v_fma_f32 v31, v184, 0, v31
    v_fma_f32 v31, v185, 0, v31
    v_fma_f32 v31, v186, 0, v31
    v_fma_f32 v31, v187, 0, v31
    v_fma_f32 v31, v188, 0, v31
    v_fma_f32 v31, v189, 0, v31
    v_fma_f32 v31, v190, 0, v31
    v_fma_f32 v31, v191, 0, v31
    v_add_f32 v31, v31, v92
    v_mov_b32 v30, 0x5f800000
    v_cmp_nlt_f32 vcc, v31, v30
    s_cmp_lg_u64 vcc, 0
    s_cbranch_scc1 mk_slow1
mk_fin1:
    v_rcp_f32 v30, v92
    s_add_u32 s3, s33, 1
    s_mul_i32 s3, s3, 294912
    s_lshl_b32 s4, s27, 11
    s_add_u32 s3, s3, s4
    s_add_u32 s3, s3, 16777216
    v_mul_f32 v176, v176, v30
    v_mul_f32 v177, v177, v30
    v_mul_f32 v178, v178, v30
    v_mul_f32 v179, v179, v30
    v_mul_f32 v180, v180, v30
    v_mul_f32 v181, v181, v30
    v_mul_f32 v182, v182, v30
    v_mul_f32 v183, v183, v30
    v_mul_f32 v184, v184, v30
    v_mul_f32 v185, v185, v30
    v_mul_f32 v186, v186, v30
    v_mul_f32 v187, v187, v30
    v_mul_f32 v188, v188, v30
    v_mul_f32 v189, v189, v30
    v_mul_f32 v190, v190, v30
    v_mul_f32 v191, v191, v30
    v_cvt_pk_bf16_f32 v200, v176, v177
    v_cvt_pk_bf16_f32 v201, v178, v179
    v_cvt_pk_bf16_f32 v202, v180, v181
    v_cvt_pk_bf16_f32 v203, v182, v183
    v_cvt_pk_bf16_f32 v204, v184, v185
    v_cvt_pk_bf16_f32 v205, v186, v187
    v_cvt_pk_bf16_f32 v206, v188, v189
    v_cvt_pk_bf16_f32 v207, v190, v191
    buffer_store_dwordx4 v[200:203], v3, s[8:11], s3 offen sc1
    buffer_store_dwordx4 v[204:207], v3, s[8:11], s3 offen offset:1024 sc1
    s_lshl_b32 s3, s33, 4
    s_add_u32 s3, s3, s27
    s_lshl_b32 s3, s3, 7
    s_add_u32 s3, s3, 51904512
    s_waitcnt vmcnt(0)
    v_mov_b32 v30, s25
    v_mov_b32 v31, 0
    s_mov_b64 exec, 1
    buffer_store_dword v30, v31, s[8:11], s3 offen sc1
    s_mov_b64 exec, -1
    s_setprio 0
    s_branch mk_final_a
mk_a_spin0:
    s_mov_b32 s4, 1600000
mk_spin1:
    ds_read_b32 v6, v10
    s_waitcnt lgkmcnt(0)
    v_cmp_lt_u32 vcc, v6, v5
    s_cbranch_vccz mk_spind1
    s_sub_u32 s4, s4, 1
    s_cmp_lg_u32 s4, 0
    s_cbranch_scc1 mk_spin1
mk_spind1:
    s_branch mk_a_spind0
mk_a_spin1:
    s_mov_b32 s4, 1600000
mk_spin2:
    ds_read_b32 v6, v10
    s_waitcnt lgkmcnt(0)
    v_cmp_lt_u32 vcc, v6, v5
    s_cbranch_vccz mk_spind2
    s_sub_u32 s4, s4, 1
    s_cmp_lg_u32 s4, 0
    s_cbranch_scc1 mk_spin2
mk_spind2:
    s_branch mk_a_spind1
mk_a_spin2:
    s_mov_b32 s4, 1600000
mk_spin3:
    ds_read_b32 v6, v10
    s_waitcnt lgkmcnt(0)
    v_cmp_lt_u32 vcc, v6, v5
    s_cbranch_vccz mk_spind3
    s_sub_u32 s4, s4, 1
    s_cmp_lg_u32 s4, 0
    s_cbranch_scc1 mk_spin3
mk_spind3:
    s_branch mk_a_spind2
mk_a_spin3:
    s_mov_b32 s4, 1600000
mk_spin4:
    ds_read_b32 v6, v10
    s_waitcnt lgkmcnt(0)
    v_cmp_lt_u32 vcc, v6, v5
    s_cbranch_vccz mk_spind4
    s_sub_u32 s4, s4, 1
    s_cmp_lg_u32 s4, 0
    s_cbranch_scc1 mk_spin4
mk_spind4:
    s_branch mk_a_spind3
mk_a_sp:
    s_waitcnt vmcnt(0)
    v_cmp_ne_u32 vcc, s25, v7
    s_cbranch_vccz mk_polld1
    s_lshl_b32 s3, s27, 12
    s_add_u32 s3, s3, 51380224
    s_mov_b32 s4, 200000
mk_poll1:
    buffer_load_dword v31, v12, s[8:11], s3 offen sc1
    s_waitcnt vmcnt(0)
    v_cmp_ne_u32 vcc, s25, v31
    s_cbranch_vccz mk_polld1
    s_sleep 4
    s_sub_u32 s4, s4, 1
    s_cmp_lg_u32 s4, 0
    s_cbranch_scc1 mk_poll1
mk_polld1:
    s_add_u32 m0, s32, 32768
    s_add_u32 s30, s30, 16384
    s_and_b32 s30, s30, 0x3ffff
    buffer_load_dwordx4 v8, s[8:11], s30 offen sc1 lds
    buffer_load_dwordx4 v8, s[8:11], s30 offen offset:1024 sc1 lds
    buffer_load_dwordx4 v8, s[8:11], s30 offen offset:2048 sc1 lds
    buffer_load_dwordx4 v8, s[8:11], s30 offen offset:3072 sc1 lds
    s_branch mk_a_spd
mk_slow0:
    s_waitcnt vmcnt(0)
    v_mov_b32 v30, 0xff800000
    s_mov_b32 s34, 0
mk_slow0a:
    s_lshr_b32 s3, s34, 2
    s_lshl_b32 s3, s3, 14
    s_and_b32 s4, s34, 3
    s_lshl_b32 s4, s4, 11
    s_add_u32 s3, s3, s4
    s_add_u32 s3, s3, s28
    buffer_load_dwordx4 v[72:75], v3, s[8:11], s3 offen sc1
    buffer_load_dwordx4 v[76:79], v3, s[8:11], s3 offen offset:1024 sc1
    s_waitcnt vmcnt(0)
    v_mfma_f32_32x32x16_bf16 v[32:47], v[72:75], v[224:227], 0
    v_mfma_f32_32x32x16_bf16 v[32:47], v[76:79], v[228:231], v[32:47]
    s_nop 11
    v_max3_f32 v31, v32, v33, v34
    v_max3_f32 v31, v31, v35, v36
    v_max3_f32 v31, v31, v37, v38
    v_max3_f32 v31, v31, v39, v40
    v_max3_f32 v31, v31, v41, v42
    v_max3_f32 v31, v31, v43, v44
    v_max3_f32 v31, v31, v45, v46
    v_max_f32 v31, v31, v47
    v_max_f32 v30, v30, v31
    s_add_u32 s34, s34, 1
    s_cmp_lt_u32 s34, 64
    s_cbranch_scc1 mk_slow0a
    v_mov_b32 v31, v30
    s_nop 1
    v_permlane32_swap_b32 v30, v31
    s_nop 1
    v_max_f32 v30, v30, v31
    v_sub_f32 v128, 0, v30
    v_sub_f32 v129, 0, v30
    v_sub_f32 v130, 0, v30
    v_sub_f32 v131, 0, v30
    v_sub_f32 v132, 0, v30
    v_sub_f32 v133, 0, v30
    v_sub_f32 v134, 0, v30
    v_sub_f32 v135, 0, v30
    v_sub_f32 v136, 0, v30
    v_sub_f32 v137, 0, v30
    v_sub_f32 v138, 0, v30
    v_sub_f32 v139, 0, v30
    v_sub_f32 v140, 0, v30
    v_sub_f32 v141, 0, v30
    v_sub_f32 v142, 0, v30
    v_sub_f32 v143, 0, v30
    v_mov_b32 v160, 0
    v_mov_b32 v161, 0
    v_mov_b32 v162, 0
    v_mov_b32 v163, 0
    v_mov_b32 v164, 0
    v_mov_b32 v165, 0
    v_mov_b32 v166, 0
    v_mov_b32 v167, 0
    v_mov_b32 v168, 0
    v_mov_b32 v169, 0
    v_mov_b32 v170, 0
    v_mov_b32 v171, 0
    v_mov_b32 v172, 0
    v_mov_b32 v173, 0
    v_mov_b32 v174, 0
    v_mov_b32 v175, 0
    v_mov_b32 v88, 0
    v_mov_b32 v89, 0
    v_mov_b32 v90, 0
    v_mov_b32 v91, 0
    s_lshr_b32 s38, s32, 1
    s_add_u32 s38, s38, 65536
    v_add_u32 v15, s38, v14
    s_mov_b32 s34, 0
mk_slow0b:
    s_lshr_b32 s3, s34, 2
    s_lshl_b32 s3, s3, 14
    s_and_b32 s4, s34, 3
    s_lshl_b32 s4, s4, 11
    s_add_u32 s3, s3, s4
    s_add_u32 s3, s3, s28
    buffer_load_dwordx4 v[72:75], v3, s[8:11], s3 offen sc1
    buffer_load_dwordx4 v[76:79], v3, s[8:11], s3 offen offset:1024 sc1
    s_mov_b32 m0, s38
    s_add_u32 s3, s3, 8192
    buffer_load_dwordx4 v3, s[8:11], s3 offen sc1 lds
    buffer_load_dwordx4 v3, s[8:11], s3 offen offset:1024 sc1 lds
    s_waitcnt vmcnt(0)
    v_mfma_f32_32x32x16_bf16 v[32:47], v[72:75], v[224:227], v[128:143]
    v_mfma_f32_32x32x16_bf16 v[32:47], v[76:79], v[228:231], v[32:47]
    ds_read_b64_tr_b16 v[80:81], v15 offset:0
    ds_read_b64_tr_b16 v[82:83], v15 offset:512
    ds_read_b64_tr_b16 v[84:85], v15 offset:1024
    ds_read_b64_tr_b16 v[86:87], v15 offset:1536
    s_nop 9
    v_exp_f32 v32, v32
    v_exp_f32 v33, v33
    v_exp_f32 v34, v34
    v_exp_f32 v35, v35
    v_exp_f32 v36, v36
    v_exp_f32 v37, v37
    v_exp_f32 v38, v38
    v_exp_f32 v39, v39
    v_exp_f32 v40, v40
    v_exp_f32 v41, v41
    v_exp_f32 v42, v42
    v_exp_f32 v43, v43
    v_exp_f32 v44, v44
    v_exp_f32 v45, v45
    v_exp_f32 v46, v46
    v_exp_f32 v47, v47
    s_nop 0
    v_cvt_pk_bf16_f32 v64, v32, v33
    v_cvt_pk_bf16_f32 v65, v34, v35
    v_cvt_pk_bf16_f32 v66, v36, v37
    v_cvt_pk_bf16_f32 v67, v38, v39
    v_cvt_pk_bf16_f32 v68, v40, v41
    v_cvt_pk_bf16_f32 v69, v42, v43
    v_cvt_pk_bf16_f32 v70, v44, v45
    v_cvt_pk_bf16_f32 v71, v46, v47
    s_waitcnt lgkmcnt(0)
    s_nop 0
    v_mfma_f32_32x32x16_bf16 v[160:175], v[80:83], v[64:67], v[160:175]
    v_mfma_f32_32x32x16_bf16 v[160:175], v[84:87], v[68:71], v[160:175]
    v_mfma_f32_16x16x32_bf16 v[88:91], v[96:99], v[64:67], v[88:91]
    v_mfma_f32_16x16x32_bf16 v[88:91], v[96:99], v[68:71], v[88:91]
    s_add_u32 s34, s34, 1
    s_cmp_lt_u32 s34, 64
    s_cbranch_scc1 mk_slow0b
    s_nop 15
    s_branch mk_fin0
mk_slow1:
    s_waitcnt vmcnt(0)
    v_mov_b32 v30, 0xff800000
    s_mov_b32 s34, 0
mk_slow1a:
    s_lshr_b32 s3, s34, 2
    s_lshl_b32 s3, s3, 14
    s_and_b32 s4, s34, 3
    s_lshl_b32 s4, s4, 11
    s_add_u32 s3, s3, s4
    s_add_u32 s3, s3, s28
    buffer_load_dwordx4 v[72:75], v3, s[8:11], s3 offen sc1
    buffer_load_dwordx4 v[76:79], v3, s[8:11], s3 offen offset:1024 sc1
    s_waitcnt vmcnt(0)
    v_mfma_f32_32x32x16_bf16 v[48:63], v[72:75], v[232:235], 0
    v_mfma_f32_32x32x16_bf16 v[48:63], v[76:79], v[236:239], v[48:63]
    s_nop 11
    v_max3_f32 v31, v48, v49, v50
    v_max3_f32 v31, v31, v51, v52
    v_max3_f32 v31, v31, v53, v54
    v_max3_f32 v31, v31, v55, v56
    v_max3_f32 v31, v31, v57, v58
    v_max3_f32 v31, v31, v59, v60
    v_max3_f32 v31, v31, v61, v62
    v_max_f32 v31, v31, v63
    v_max_f32 v30, v30, v31
    s_add_u32 s34, s34, 1
    s_cmp_lt_u32 s34, 64
    s_cbranch_scc1 mk_slow1a
    v_mov_b32 v31, v30
    s_nop 1
    v_permlane32_swap_b32 v30, v31
    s_nop 1
    v_max_f32 v30, v30, v31
    v_sub_f32 v144, 0, v30
    v_sub_f32 v145, 0, v30
    v_sub_f32 v146, 0, v30
    v_sub_f32 v147, 0, v30
    v_sub_f32 v148, 0, v30
    v_sub_f32 v149, 0, v30
    v_sub_f32 v150, 0, v30
    v_sub_f32 v151, 0, v30
    v_sub_f32 v152, 0, v30
    v_sub_f32 v153, 0, v30
    v_sub_f32 v154, 0, v30
    v_sub_f32 v155, 0, v30
    v_sub_f32 v156, 0, v30
    v_sub_f32 v157, 0, v30
    v_sub_f32 v158, 0, v30
    v_sub_f32 v159, 0, v30
    v_mov_b32 v176, 0
    v_mov_b32 v177, 0
    v_mov_b32 v178, 0
    v_mov_b32 v179, 0
    v_mov_b32 v180, 0
    v_mov_b32 v181, 0
    v_mov_b32 v182, 0
    v_mov_b32 v183, 0
    v_mov_b32 v184, 0
    v_mov_b32 v185, 0
    v_mov_b32 v186, 0
    v_mov_b32 v187, 0
    v_mov_b32 v188, 0
    v_mov_b32 v189, 0
    v_mov_b32 v190, 0
    v_mov_b32 v191, 0
    v_mov_b32 v92, 0
    v_mov_b32 v93, 0
    v_mov_b32 v94, 0
    v_mov_b32 v95, 0
    s_lshr_b32 s38, s32, 1
    s_add_u32 s38, s38, 65536
    v_add_u32 v15, s38, v14
    s_mov_b32 s34, 0
mk_slow1b:
    s_lshr_b32 s3, s34, 2
    s_lshl_b32 s3, s3, 14
    s_and_b32 s4, s34, 3
    s_lshl_b32 s4, s4, 11
    s_add_u32 s3, s3, s4
    s_add_u32 s3, s3, s28
    buffer_load_dwordx4 v[72:75], v3, s[8:11], s3 offen sc1
    buffer_load_dwordx4 v[76:79], v3, s[8:11], s3 offen offset:1024 sc1
    s_mov_b32 m0, s38
    s_add_u32 s3, s3, 8192
    buffer_load_dwordx4 v3, s[8:11], s3 offen sc1 lds
    buffer_load_dwordx4 v3, s[8:11], s3 offen offset:1024 sc1 lds
    s_waitcnt vmcnt(0)
    v_mfma_f32_32x32x16_bf16 v[48:63], v[72:75], v[232:235], v[144:159]
    v_mfma_f32_32x32x16_bf16 v[48:63], v[76:79], v[236:239], v[48:63]
    ds_read_b64_tr_b16 v[80:81], v15 offset:0
    ds_read_b64_tr_b16 v[82:83], v15 offset:512
    ds_read_b64_tr_b16 v[84:85], v15 offset:1024
    ds_read_b64_tr_b16 v[86:87], v15 offset:1536
    s_nop 9
    v_exp_f32 v48, v48
    v_exp_f32 v49, v49
    v_exp_f32 v50, v50
    v_exp_f32 v51, v51
    v_exp_f32 v52, v52
    v_exp_f32 v53, v53
    v_exp_f32 v54, v54
    v_exp_f32 v55, v55
    v_exp_f32 v56, v56
    v_exp_f32 v57, v57
    v_exp_f32 v58, v58
    v_exp_f32 v59, v59
    v_exp_f32 v60, v60
    v_exp_f32 v61, v61
    v_exp_f32 v62, v62
    v_exp_f32 v63, v63
    s_nop 0
    v_cvt_pk_bf16_f32 v64, v48, v49
    v_cvt_pk_bf16_f32 v65, v50, v51
    v_cvt_pk_bf16_f32 v66, v52, v53
    v_cvt_pk_bf16_f32 v67, v54, v55
    v_cvt_pk_bf16_f32 v68, v56, v57
    v_cvt_pk_bf16_f32 v69, v58, v59
    v_cvt_pk_bf16_f32 v70, v60, v61
    v_cvt_pk_bf16_f32 v71, v62, v63
    s_waitcnt lgkmcnt(0)
    s_nop 0
    v_mfma_f32_32x32x16_bf16 v[176:191], v[80:83], v[64:67], v[176:191]
    v_mfma_f32_32x32x16_bf16 v[176:191], v[84:87], v[68:71], v[176:191]
    v_mfma_f32_16x16x32_bf16 v[92:95], v[96:99], v[64:67], v[92:95]
    v_mfma_f32_16x16x32_bf16 v[92:95], v[96:99], v[68:71], v[92:95]
    s_add_u32 s34, s34, 1
    s_cmp_lt_u32 s34, 64
    s_cbranch_scc1 mk_slow1b
    s_nop 15
    s_branch mk_fin1
mk_w_entry:
    s_cmp_ge_u32 s24, 6
    s_cbranch_scc1 mk_w_e1
    s_mov_b32 s30, 196608
    s_mov_b32 s31, 6291456
    s_mul_i32 s32, s62, 3072
    s_add_u32 s32, s32, 98304
    s_mul_i32 s3, s62, 192
    s_lshl_b32 s6, s27, 6
    v_add_u32 v16, s3, v0
    v_mul_u32_u24 v17, 5462, v16
    v_lshrrev_b32 v17, 16, v17
    v_mul_u32_u24 v18, 12, v17
    v_sub_u32 v18, v16, v18
    v_bfe_u32 v16, v17, 2, 1
    v_lshlrev_b32 v16, 1, v16
    v_xor_b32 v18, v18, v16
    v_lshrrev_b32 v16, 2, v18
    v_and_b32 v18, 3, v18
    v_lshlrev_b32 v18, 4, v18
    v_lshl_add_u32 v18, v16, 11, v18
    v_and_b32 v4, 0x13, v17
    v_bfe_u32 v16, v17, 2, 1
    v_lshl_or_b32 v4, v16, 3, v4
    v_bfe_u32 v16, v17, 3, 1
    v_lshl_or_b32 v4, v16, 2, v4
    v_mul_u32_u24 v4, 6144, v4
    v_add3_u32 v4, v4, v18, s6
    v_add_u32 v16, s3, v0
    v_add_u32 v16, 64, v16
    v_mul_u32_u24 v17, 5462, v16
    v_lshrrev_b32 v17, 16, v17
    v_mul_u32_u24 v18, 12, v17
    v_sub_u32 v18, v16, v18
    v_bfe_u32 v16, v17, 2, 1
    v_lshlrev_b32 v16, 1, v16
    v_xor_b32 v18, v18, v16
    v_lshrrev_b32 v16, 2, v18
    v_and_b32 v18, 3, v18
    v_lshlrev_b32 v18, 4, v18
    v_lshl_add_u32 v18, v16, 11, v18
    v_and_b32 v5, 0x13, v17
    v_bfe_u32 v16, v17, 2, 1
    v_lshl_or_b32 v5, v16, 3, v5
    v_bfe_u32 v16, v17, 3, 1
    v_lshl_or_b32 v5, v16, 2, v5
    v_mul_u32_u24 v5, 6144, v5
    v_add3_u32 v5, v5, v18, s6
    v_subrev_u32 v5, 1024, v5
    v_add_u32 v16, s3, v0
    v_add_u32 v16, 128, v16
    v_mul_u32_u24 v17, 5462, v16
    v_lshrrev_b32 v17, 16, v17
    v_mul_u32_u24 v18, 12, v17
    v_sub_u32 v18, v16, v18
    v_bfe_u32 v16, v17, 2, 1
    v_lshlrev_b32 v16, 1, v16
    v_xor_b32 v18, v18, v16
    v_lshrrev_b32 v16, 2, v18
    v_and_b32 v18, 3, v18
    v_lshlrev_b32 v18, 4, v18
    v_lshl_add_u32 v18, v16, 11, v18
    v_and_b32 v6, 0x13, v17
    v_bfe_u32 v16, v17, 2, 1
    v_lshl_or_b32 v6, v16, 3, v6
    v_bfe_u32 v16, v17, 3, 1
    v_lshl_or_b32 v6, v16, 2, v6
    v_mul_u32_u24 v6, 6144, v6
    v_add3_u32 v6, v6, v18, s6
    v_subrev_u32 v6, 2048, v6
    s_waitcnt lgkmcnt(0)
    s_mov_b32 s12, s42
    s_mov_b32 s13, s43
    s_mov_b32 s14, 0x600000
    s_mov_b32 s15, 0x00020000
    s_branch mk_w_go
mk_w_e1:
    s_mov_b32 s30, 229376
    s_mov_b32 s31, 7340032
    s_sub_u32 s3, s24, 6
    s_mul_i32 s32, s3, 3072
    s_add_u32 s32, s32, 104448
    s_mul_i32 s3, s3, 192
    s_mul_i32 s6, s27, 224
    v_add_u32 v16, s3, v0
    v_mul_u32_u24 v17, 4682, v16
    v_lshrrev_b32 v17, 16, v17
    v_mul_u32_u24 v18, 14, v17
    v_sub_u32 v18, v16, v18
    v_lshlrev_b32 v18, 4, v18
    v_and_b32 v4, 0x13, v17
    v_bfe_u32 v16, v17, 2, 1
    v_lshl_or_b32 v4, v16, 3, v4
    v_bfe_u32 v16, v17, 3, 1
    v_lshl_or_b32 v4, v16, 2, v4
    v_mul_u32_u24 v4, 7168, v4
    v_add3_u32 v4, v4, v18, s6
    v_add_u32 v16, s3, v0
    v_add_u32 v16, 64, v16
    v_mul_u32_u24 v17, 4682, v16
    v_lshrrev_b32 v17, 16, v17
    v_mul_u32_u24 v18, 14, v17
    v_sub_u32 v18, v16, v18
    v_lshlrev_b32 v18, 4, v18
    v_and_b32 v5, 0x13, v17
    v_bfe_u32 v16, v17, 2, 1
    v_lshl_or_b32 v5, v16, 3, v5
    v_bfe_u32 v16, v17, 3, 1
    v_lshl_or_b32 v5, v16, 2, v5
    v_mul_u32_u24 v5, 7168, v5
    v_add3_u32 v5, v5, v18, s6
    v_subrev_u32 v5, 1024, v5
    v_add_u32 v16, s3, v0
    v_add_u32 v16, 128, v16
    v_mul_u32_u24 v17, 4682, v16
    v_lshrrev_b32 v17, 16, v17
    v_mul_u32_u24 v18, 14, v17
    v_sub_u32 v18, v16, v18
    v_lshlrev_b32 v18, 4, v18
    v_and_b32 v6, 0x13, v17
    v_bfe_u32 v16, v17, 2, 1
    v_lshl_or_b32 v6, v16, 3, v6
    v_bfe_u32 v16, v17, 3, 1
    v_lshl_or_b32 v6, v16, 2, v6
    v_mul_u32_u24 v6, 7168, v6
    v_add3_u32 v6, v6, v18, s6
    v_subrev_u32 v6, 2048, v6
    s_waitcnt lgkmcnt(0)
    s_mov_b32 s12, s48
    s_mov_b32 s13, s49
    s_mov_b32 s14, 0x700000
    s_mov_b32 s15, 0x00020000
mk_w_go:
    s_mul_i32 s29, s63, s30
    s_cmp_eq_u32 s24, 7
    s_cbranch_scc1 mk_w_nodma0
    s_add_u32 m0, s32, 0
    s_nop 0
    buffer_load_dwordx4 v4, s[12:15], s29 offen  lds
    buffer_load_dwordx4 v5, s[12:15], s29 offen offset:1024  lds
    buffer_load_dwordx4 v6, s[12:15], s29 offen offset:2048  lds
    s_add_u32 s29, s29, s30
    s_cmp_eq_u32 s29, s31
    s_cselect_b32 s29, 0, s29
    v_mov_b32 v128, 0
    v_mov_b32 v129, 0
    v_mov_b32 v130, 0
    v_mov_b32 v131, 0
    v_mov_b32 v132, 0
    v_mov_b32 v133, 0
    v_mov_b32 v134, 0
    v_mov_b32 v135, 0
    v_mov_b32 v136, 0
    v_mov_b32 v137, 0
    v_mov_b32 v138, 0
    v_mov_b32 v139, 0
    v_mov_b32 v140, 0
    v_mov_b32 v141, 0
    v_mov_b32 v142, 0
    v_mov_b32 v143, 0
    v_mov_b32 v144, 0
    v_mov_b32 v145, 0
    v_mov_b32 v146, 0
    v_mov_b32 v147, 0
    v_mov_b32 v148, 0
    v_mov_b32 v149, 0
    v_mov_b32 v150, 0
    v_mov_b32 v151, 0
    v_mov_b32 v152, 0
    v_mov_b32 v153, 0
    v_mov_b32 v154, 0
    v_mov_b32 v155, 0
    v_mov_b32 v156, 0
    v_mov_b32 v157, 0
    v_mov_b32 v158, 0
    v_mov_b32 v159, 0
    v_mov_b32 v160, 0
    v_mov_b32 v161, 0
    v_mov_b32 v162, 0
    v_mov_b32 v163, 0
    v_mov_b32 v164, 0
    v_mov_b32 v165, 0
    v_mov_b32 v166, 0
    v_mov_b32 v167, 0
    v_mov_b32 v168, 0
    v_mov_b32 v169, 0
    v_mov_b32 v170, 0
    v_mov_b32 v171, 0
    v_mov_b32 v172, 0
    v_mov_b32 v173, 0
    v_mov_b32 v174, 0
    v_mov_b32 v175, 0
    v_mov_b32 v176, 0
    v_mov_b32 v177, 0
    v_mov_b32 v178, 0
    v_mov_b32 v179, 0
    v_mov_b32 v180, 0
    v_mov_b32 v181, 0
    v_mov_b32 v182, 0
    v_mov_b32 v183, 0
    v_mov_b32 v184, 0
    v_mov_b32 v185, 0
    v_mov_b32 v186, 0
    v_mov_b32 v187, 0
    v_mov_b32 v188, 0
    v_mov_b32 v189, 0
    v_mov_b32 v190, 0
    v_mov_b32 v191, 0
    v_mov_b32 v192, 0
    v_mov_b32 v193, 0
    v_mov_b32 v194, 0
    v_mov_b32 v195, 0
    v_mov_b32 v196, 0
    v_mov_b32 v197, 0
    v_mov_b32 v198, 0
    v_mov_b32 v199, 0
    v_mov_b32 v200, 0
    v_mov_b32 v201, 0
    v_mov_b32 v202, 0
    v_mov_b32 v203, 0
    v_mov_b32 v204, 0
    v_mov_b32 v205, 0
    v_mov_b32 v206, 0
    v_mov_b32 v207, 0
    v_mov_b32 v208, 0
    v_mov_b32 v209, 0
    v_mov_b32 v210, 0
    v_mov_b32 v211, 0
    v_mov_b32 v212, 0
    v_mov_b32 v213, 0
    v_mov_b32 v214, 0
    v_mov_b32 v215, 0
    v_mov_b32 v216, 0
    v_mov_b32 v217, 0
    v_mov_b32 v218, 0
    v_mov_b32 v219, 0
    v_mov_b32 v220, 0
    v_mov_b32 v221, 0
    v_mov_b32 v222, 0
    v_mov_b32 v223, 0
    v_mov_b32 v224, 0
    v_mov_b32 v225, 0
    v_mov_b32 v226, 0
    v_mov_b32 v227, 0
    v_mov_b32 v228, 0
    v_mov_b32 v229, 0
    v_mov_b32 v230, 0
    v_mov_b32 v231, 0
    v_mov_b32 v232, 0
    v_mov_b32 v233, 0
    v_mov_b32 v234, 0
    v_mov_b32 v235, 0
    v_mov_b32 v236, 0
    v_mov_b32 v237, 0
    v_mov_b32 v238, 0
    v_mov_b32 v239, 0
    v_mov_b32 v120, 0
    v_mov_b32 v121, 0
    v_mov_b32 v122, 0
    v_mov_b32 v123, 0
    v_mov_b32 v124, 0
    v_mov_b32 v125, 0
    v_mov_b32 v126, 0
    v_mov_b32 v127, 0
    v_mov_b32 v240, 0
    v_mov_b32 v241, 0
    v_mov_b32 v242, 0
    v_mov_b32 v243, 0
    v_mov_b32 v244, 0
    v_mov_b32 v245, 0
    v_mov_b32 v246, 0
    v_mov_b32 v247, 0
    v_mov_b32 v248, 0
    v_mov_b32 v249, 0
    v_mov_b32 v250, 0
    v_mov_b32 v251, 0
    v_mov_b32 v252, 0
    v_mov_b32 v253, 0
    v_mov_b32 v254, 0
    v_mov_b32 v255, 0
    v_mov_b32 v28, 0
    v_mov_b32 v29, 0
    v_mov_b32 v30, 0
    v_mov_b32 v31, 0
    v_mov_b32 v24, 0x3f803f80
    v_mov_b32 v25, 0x3f803f80
    v_mov_b32 v26, 0x3f803f80
    v_mov_b32 v27, 0x3f803f80
    s_add_u32 m0, s32, 13312
    s_nop 0
    buffer_load_dwordx4 v4, s[12:15], s29 offen  lds
    buffer_load_dwordx4 v5, s[12:15], s29 offen offset:1024  lds
    buffer_load_dwordx4 v6, s[12:15], s29 offen offset:2048  lds
    s_add_u32 s29, s29, s30
    s_cmp_eq_u32 s29, s31
    s_cselect_b32 s29, 0, s29
    v_mov_b32 v14, 0
    v_mov_b32 v15, 0
    s_branch mk_w_nodma1
mk_w_nodma0:
    v_mov_b32 v128, 0
    v_mov_b32 v129, 0
    v_mov_b32 v130, 0
    v_mov_b32 v131, 0
    v_mov_b32 v132, 0
    v_mov_b32 v133, 0
    v_mov_b32 v134, 0
    v_mov_b32 v135, 0
    v_mov_b32 v136, 0
    v_mov_b32 v137, 0
    v_mov_b32 v138, 0
    v_mov_b32 v139, 0
    v_mov_b32 v140, 0
    v_mov_b32 v141, 0
    v_mov_b32 v142, 0
    v_mov_b32 v143, 0
    v_mov_b32 v144, 0
    v_mov_b32 v145, 0
    v_mov_b32 v146, 0
    v_mov_b32 v147, 0
    v_mov_b32 v148, 0
    v_mov_b32 v149, 0
    v_mov_b32 v150, 0
    v_mov_b32 v151, 0
    v_mov_b32 v152, 0
    v_mov_b32 v153, 0
    v_mov_b32 v154, 0
    v_mov_b32 v155, 0
    v_mov_b32 v156, 0
    v_mov_b32 v157, 0
    v_mov_b32 v158, 0
    v_mov_b32 v159, 0
    v_mov_b32 v160, 0
    v_mov_b32 v161, 0
    v_mov_b32 v162, 0
    v_mov_b32 v163, 0
    v_mov_b32 v164, 0
    v_mov_b32 v165, 0
    v_mov_b32 v166, 0
    v_mov_b32 v167, 0
    v_mov_b32 v168, 0
    v_mov_b32 v169, 0
    v_mov_b32 v170, 0
    v_mov_b32 v171, 0
    v_mov_b32 v172, 0
    v_mov_b32 v173, 0
    v_mov_b32 v174, 0
    v_mov_b32 v175, 0
    v_mov_b32 v176, 0
    v_mov_b32 v177, 0
    v_mov_b32 v178, 0
    v_mov_b32 v179, 0
    v_mov_b32 v180, 0
    v_mov_b32 v181, 0
    v_mov_b32 v182, 0
    v_mov_b32 v183, 0
    v_mov_b32 v184, 0
    v_mov_b32 v185, 0
    v_mov_b32 v186, 0
    v_mov_b32 v187, 0
    v_mov_b32 v188, 0
    v_mov_b32 v189, 0
    v_mov_b32 v190, 0
    v_mov_b32 v191, 0
    v_mov_b32 v192, 0
    v_mov_b32 v193, 0
    v_mov_b32 v194, 0
    v_mov_b32 v195, 0
    v_mov_b32 v196, 0
    v_mov_b32 v197, 0
    v_mov_b32 v198, 0
    v_mov_b32 v199, 0
    v_mov_b32 v200, 0
    v_mov_b32 v201, 0
    v_mov_b32 v202, 0
    v_mov_b32 v203, 0
    v_mov_b32 v204, 0
    v_mov_b32 v205, 0
    v_mov_b32 v206, 0
    v_mov_b32 v207, 0
    v_mov_b32 v208, 0
    v_mov_b32 v209, 0
    v_mov_b32 v210, 0
    v_mov_b32 v211, 0
    v_mov_b32 v212, 0
    v_mov_b32 v213, 0
    v_mov_b32 v214, 0
    v_mov_b32 v215, 0
    v_mov_b32 v216, 0
    v_mov_b32 v217, 0
    v_mov_b32 v218, 0
    v_mov_b32 v219, 0
    v_mov_b32 v220, 0
    v_mov_b32 v221, 0
    v_mov_b32 v222, 0
    v_mov_b32 v223, 0
    v_mov_b32 v224, 0
    v_mov_b32 v225, 0
    v_mov_b32 v226, 0
    v_mov_b32 v227, 0
    v_mov_b32 v228, 0
    v_mov_b32 v229, 0
    v_mov_b32 v230, 0
    v_mov_b32 v231, 0
    v_mov_b32 v232, 0
    v_mov_b32 v233, 0
    v_mov_b32 v234, 0
    v_mov_b32 v235, 0
    v_mov_b32 v236, 0
    v_mov_b32 v237, 0
    v_mov_b32 v238, 0
    v_mov_b32 v239, 0
    v_mov_b32 v120, 0
    v_mov_b32 v121, 0
    v_mov_b32 v122, 0
    v_mov_b32 v123, 0
    v_mov_b32 v124, 0
    v_mov_b32 v125, 0
    v_mov_b32 v126, 0
    v_mov_b32 v127, 0
    v_mov_b32 v240, 0
    v_mov_b32 v241, 0
    v_mov_b32 v242, 0
    v_mov_b32 v243, 0
    v_mov_b32 v244, 0
    v_mov_b32 v245, 0
    v_mov_b32 v246, 0
    v_mov_b32 v247, 0
    v_mov_b32 v248, 0
    v_mov_b32 v249, 0
    v_mov_b32 v250, 0
    v_mov_b32 v251, 0
    v_mov_b32 v252, 0
    v_mov_b32 v253, 0
    v_mov_b32 v254, 0
    v_mov_b32 v255, 0
    v_mov_b32 v28, 0
    v_mov_b32 v29, 0
    v_mov_b32 v30, 0
    v_mov_b32 v31, 0
    v_mov_b32 v24, 0x3f803f80
    v_mov_b32 v25, 0x3f803f80
    v_mov_b32 v26, 0x3f803f80
    v_mov_b32 v27, 0x3f803f80
mk_w_nodma1:
    s_add_u32 s4, s60, 50331648
    s_addc_u32 s5, s61, 0
    s_load_dword s25, s[4:5], 0
    s_mov_b32 s8, s60
    s_mov_b32 s9, s61
    s_mov_b32 s10, 0x10000000
    s_mov_b32 s11, 0x00020000
    s_mov_b32 s20, s50
    s_mov_b32 s21, s51
    s_mov_b32 s22, 0x1c00
    s_mov_b32 s23, 0x00020000
    s_mul_i32 s3, s27, 224
    s_mov_b32 m0, 161792
    s_mov_b64 exec, 0x3fff
    buffer_load_dwordx4 v3, s[20:23], s3 offen lds
    s_mov_b64 exec, -1
    s_lshr_b32 s3, s2, 3
    s_and_b32 s3, s3, 7
    s_lshl_b32 s3, s3, 2
    s_add_u32 s3, s3, s62
    s_mul_i32 s3, s3, 1408
    v_min_u32 v16, 10, v0
    v_lshlrev_b32 v16, 7, v16
    v_add_u32 v16, s3, v16
    v_min_u32 v16, mk_code1-mk_code0-4, v16
    global_load_dword v23, v16, s[96:97]
    v_and_b32 v16, 15, v0
    s_lshl_b32 s3, s62, 13
    v_lshlrev_b32 v17, 7, v16
    v_add_u32 v17, s3, v17
    v_bfe_u32 v18, v0, 1, 3
    v_lshrrev_b32 v19, 4, v0
    v_xor_b32 v18, v18, v19
    v_lshl_add_u32 v8, v18, 4, v17
    v_xor_b32 v9, 64, v8
    v_lshrrev_b32 v16, 5, v0
    v_lshlrev_b32 v16, 4, v16
    v_bfe_u32 v17, v0, 4, 1
    v_lshl_add_u32 v16, v17, 2, v16
    v_bfe_u32 v18, v0, 2, 2
    v_add_u32 v16, v16, v18
    v_and_b32 v18, 3, v0
    v_lshlrev_b32 v18, 3, v18
    s_mov_b32 s33, 0
    s_mov_b32 s34, 0
    s_mov_b32 s35, 0
    v_mul_u32_u24 v16, 224, v16
    v_add_u32 v16, v16, v18
    v_add_u32 v10, 104448, v16
    v_mov_b32 v13, v10
    s_and_b32 s3, s26, 1
    s_lshl_b32 s3, s3, 1
    s_lshl_b32 s36, 3, s3
    s_cmp_eq_u32 s24, 5
    s_cselect_b32 s36, s36, 0
    s_cselect_b32 s37, 16, 0
    s_cmp_eq_u32 s24, 7
    s_cbranch_scc1 mk_w_nw0
    s_waitcnt vmcnt(5)
mk_w_nw0:
    s_waitcnt lgkmcnt(0)
    s_add_u32 s25, s25, 1
    s_barrier
    ds_read_b128 v[32:35], v8 offset:0
    ds_read_b128 v[36:39], v8 offset:2048
    ds_read_b128 v[40:43], v8 offset:4096
    ds_read_b128 v[44:47], v8 offset:6144
    ds_read_b64_tr_b16 v[48:49], v13 offset:0
    ds_read_b64_tr_b16 v[50:51], v13 offset:1792
    ds_read_b64_tr_b16 v[52:53], v13 offset:32
    ds_read_b64_tr_b16 v[54:55], v13 offset:1824
    ds_read_b64_tr_b16 v[56:57], v13 offset:64
    ds_read_b64_tr_b16 v[58:59], v13 offset:1856
    ds_read_b64_tr_b16 v[60:61], v13 offset:96
    ds_read_b64_tr_b16 v[62:63], v13 offset:1888
    ds_read_b64_tr_b16 v[64:65], v13 offset:128
    ds_read_b64_tr_b16 v[66:67], v13 offset:1920
    ds_read_b64_tr_b16 v[68:69], v13 offset:160
    ds_read_b64_tr_b16 v[70:71], v13 offset:1952
    ds_read_b64_tr_b16 v[72:73], v13 offset:192
    ds_read_b64_tr_b16 v[74:75], v13 offset:1984
    s_cmp_eq_u32 s24, 7
    s_cbranch_scc1 mk_w7
    s_add_u32 m0, s32, 26624
    s_nop 0
    buffer_load_dwordx4 v4, s[12:15], s29 offen  lds
    buffer_load_dwordx4 v5, s[12:15], s29 offen offset:1024  lds
    buffer_load_dwordx4 v6, s[12:15], s29 offen offset:2048  lds
    s_add_u32 s29, s29, s30
    s_cmp_eq_u32 s29, s31
    s_cselect_b32 s29, 0, s29
    s_waitcnt vmcnt(3) lgkmcnt(0)
    s_barrier
    v_mfma_f32_16x16x32_bf16 v[128:131], v[48:51], v[32:35], v[128:131]
    v_add_u32 v12, s33, v9
    ds_read_b128 v[76:79], v12 offset:0
    v_mfma_f32_16x16x32_bf16 v[132:135], v[48:51], v[36:39], v[132:135]
    ds_read_b128 v[80:83], v12 offset:2048
    ds_read_b128 v[84:87], v12 offset:4096
    v_mfma_f32_16x16x32_bf16 v[136:139], v[48:51], v[40:43], v[136:139]
    ds_read_b128 v[88:91], v12 offset:6144
    v_mfma_f32_16x16x32_bf16 v[140:143], v[48:51], v[44:47], v[140:143]
    ds_read_b64_tr_b16 v[92:93], v13 offset:13312
    v_mfma_f32_16x16x32_bf16 v[144:147], v[52:55], v[32:35], v[144:147]
    ds_read_b64_tr_b16 v[94:95], v13 offset:15104
    v_mfma_f32_16x16x32_bf16 v[148:151], v[52:55], v[36:39], v[148:151]
    ds_read_b64_tr_b16 v[96:97], v13 offset:13344
    v_mfma_f32_16x16x32_bf16 v[152:155], v[52:55], v[40:43], v[152:155]
    ds_read_b64_tr_b16 v[98:99], v13 offset:15136
    v_mfma_f32_16x16x32_bf16 v[156:159], v[52:55], v[44:47], v[156:159]
    ds_read_b64_tr_b16 v[100:101], v13 offset:13376
    v_mfma_f32_16x16x32_bf16 v[160:163], v[56:59], v[32:35], v[160:163]
    ds_read_b64_tr_b16 v[102:103], v13 offset:15168
    v_mfma_f32_16x16x32_bf16 v[164:167], v[56:59], v[36:39], v[164:167]
    ds_read_b64_tr_b16 v[104:105], v13 offset:13408
    v_mfma_f32_16x16x32_bf16 v[168:171], v[56:59], v[40:43], v[168:171]
    ds_read_b64_tr_b16 v[106:107], v13 offset:15200
    v_mfma_f32_16x16x32_bf16 v[172:175], v[56:59], v[44:47], v[172:175]
    ds_read_b64_tr_b16 v[108:109], v13 offset:13440
    v_mfma_f32_16x16x32_bf16 v[176:179], v[60:63], v[32:35], v[176:179]
    ds_read_b64_tr_b16 v[110:111], v13 offset:15232
    v_mfma_f32_16x16x32_bf16 v[180:183], v[60:63], v[36:39], v[180:183]
    ds_read_b64_tr_b16 v[112:113], v13 offset:13472
    v_mfma_f32_16x16x32_bf16 v[184:187], v[60:63], v[40:43], v[184:187]
    ds_read_b64_tr_b16 v[114:115], v13 offset:15264
    v_mfma_f32_16x16x32_bf16 v[188:191], v[60:63], v[44:47], v[188:191]
    ds_read_b64_tr_b16 v[116:117], v13 offset:13504
    v_mfma_f32_16x16x32_bf16 v[192:195], v[64:67], v[32:35], v[192:195]
    ds_read_b64_tr_b16 v[118:119], v13 offset:15296
    v_mfma_f32_16x16x32_bf16 v[196:199], v[64:67], v[36:39], v[196:199]
    v_mfma_f32_16x16x32_bf16 v[200:203], v[64:67], v[40:43], v[200:203]
    v_mfma_f32_16x16x32_bf16 v[204:207], v[64:67], v[44:47], v[204:207]
    v_mfma_f32_16x16x32_bf16 v[208:211], v[68:71], v[32:35], v[208:211]
    v_mfma_f32_16x16x32_bf16 v[212:215], v[68:71], v[36:39], v[212:215]
    v_mfma_f32_16x16x32_bf16 v[216:219], v[68:71], v[40:43], v[216:219]
    v_mfma_f32_16x16x32_bf16 v[220:223], v[68:71], v[44:47], v[220:223]
    v_mfma_f32_16x16x32_bf16 v[224:227], v[72:75], v[32:35], v[224:227]
    v_mfma_f32_16x16x32_bf16 v[228:231], v[72:75], v[36:39], v[228:231]
    v_mfma_f32_16x16x32_bf16 v[232:235], v[72:75], v[40:43], v[232:235]
    v_mfma_f32_16x16x32_bf16 v[236:239], v[72:75], v[44:47], v[236:239]
    s_bitcmp1_b32 s36, s34
    s_cbranch_scc1 mk_wcsp
mk_wcspd:
    s_add_u32 m0, s32, 39936
    s_nop 0
    buffer_load_dwordx4 v4, s[12:15], s29 offen  lds
    buffer_load_dwordx4 v5, s[12:15], s29 offen offset:1024  lds
    buffer_load_dwordx4 v6, s[12:15], s29 offen offset:2048  lds
    s_add_u32 s29, s29, s30
    s_cmp_eq_u32 s29, s31
    s_cselect_b32 s29, 0, s29
    s_add_u32 m0, s32, s35
    s_nop 0
    buffer_load_dwordx4 v4, s[12:15], s29 offen  lds
    buffer_load_dwordx4 v5, s[12:15], s29 offen offset:1024  lds
    buffer_load_dwordx4 v6, s[12:15], s29 offen offset:2048  lds
    s_add_u32 s29, s29, s30
    s_cmp_eq_u32 s29, s31
    s_cselect_b32 s29, 0, s29
    s_branch mk_wloop_s1
    .p2align 6
mk_wloop:
    ds_read_b64_tr_b16 v[96:97], v13 offset:13344
    v_mfma_f32_16x16x32_bf16 v[152:155], v[52:55], v[40:43], v[152:155]
    ds_read_b64_tr_b16 v[98:99], v13 offset:15136
    v_mfma_f32_16x16x32_bf16 v[156:159], v[52:55], v[44:47], v[156:159]
    ds_read_b64_tr_b16 v[100:101], v13 offset:13376
    v_mfma_f32_16x16x32_bf16 v[160:163], v[56:59], v[32:35], v[160:163]
    ds_read_b64_tr_b16 v[102:103], v13 offset:15168
    v_mfma_f32_16x16x32_bf16 v[164:167], v[56:59], v[36:39], v[164:167]
    ds_read_b64_tr_b16 v[104:105], v13 offset:13408
    v_mfma_f32_16x16x32_bf16 v[168:171], v[56:59], v[40:43], v[168:171]
    ds_read_b64_tr_b16 v[106:107], v13 offset:15200
    v_mfma_f32_16x16x32_bf16 v[172:175], v[56:59], v[44:47], v[172:175]
    ds_read_b64_tr_b16 v[108:109], v13 offset:13440
    v_mfma_f32_16x16x32_bf16 v[176:179], v[60:63], v[32:35], v[176:179]
    ds_read_b64_tr_b16 v[110:111], v13 offset:15232
    v_mfma_f32_16x16x32_bf16 v[180:183], v[60:63], v[36:39], v[180:183]
    ds_read_b64_tr_b16 v[112:113], v13 offset:13472
    v_mfma_f32_16x16x32_bf16 v[184:187], v[60:63], v[40:43], v[184:187]
    ds_read_b64_tr_b16 v[114:115], v13 offset:15264
    v_mfma_f32_16x16x32_bf16 v[188:191], v[60:63], v[44:47], v[188:191]
    ds_read_b64_tr_b16 v[116:117], v13 offset:13504
    v_mfma_f32_16x16x32_bf16 v[192:195], v[64:67], v[32:35], v[192:195]
    ds_read_b64_tr_b16 v[118:119], v13 offset:15296
    v_mfma_f32_16x16x32_bf16 v[196:199], v[64:67], v[36:39], v[196:199]
    s_add_u32 m0, s32, s35
    s_nop 0
    buffer_load_dwordx4 v4, s[12:15], s29 offen  lds
    v_mfma_f32_16x16x32_bf16 v[200:203], v[64:67], v[40:43], v[200:203]
    buffer_load_dwordx4 v5, s[12:15], s29 offen offset:1024  lds
    v_mfma_f32_16x16x32_bf16 v[204:207], v[64:67], v[44:47], v[204:207]
    buffer_load_dwordx4 v6, s[12:15], s29 offen offset:2048  lds
    v_mfma_f32_16x16x32_bf16 v[208:211], v[68:71], v[32:35], v[208:211]
    s_add_u32 s29, s29, s30
    s_cmp_eq_u32 s29, s31
    s_cselect_b32 s29, 0, s29
    v_mfma_f32_16x16x32_bf16 v[212:215], v[68:71], v[36:39], v[212:215]
    s_bitcmp1_b32 s36, s34
    s_cbranch_scc1 mk_wcs0
mk_wcs0d:
    v_mfma_f32_16x16x32_bf16 v[216:219], v[68:71], v[40:43], v[216:219]
    v_mfma_f32_16x16x32_bf16 v[220:223], v[68:71], v[44:47], v[220:223]
    v_mfma_f32_16x16x32_bf16 v[224:227], v[72:75], v[32:35], v[224:227]
    v_mfma_f32_16x16x32_bf16 v[228:231], v[72:75], v[36:39], v[228:231]
    v_mfma_f32_16x16x32_bf16 v[232:235], v[72:75], v[40:43], v[232:235]
    v_mfma_f32_16x16x32_bf16 v[236:239], v[72:75], v[44:47], v[236:239]
mk_wloop_s1:
    s_waitcnt vmcnt(6) lgkmcnt(0)
    s_barrier
    v_mfma_f32_16x16x32_bf16 v[128:131], v[92:95], v[76:79], v[128:131]
    s_add_u32 s33, s33, 32768
    s_cmp_eq_u32 s33, 98304
    s_cselect_b32 s33, 0, s33
    s_add_u32 s7, s35, 13312
    s_xor_b32 s35, s35, 26624
    v_add_u32 v12, s33, v8
    v_add_u32 v13, s35, v10
    ds_read_b128 v[32:35], v12 offset:0
    v_mfma_f32_16x16x32_bf16 v[132:135], v[92:95], v[80:83], v[132:135]
    ds_read_b128 v[36:39], v12 offset:2048
    ds_read_b128 v[40:43], v12 offset:4096
    v_mfma_f32_16x16x32_bf16 v[136:139], v[92:95], v[84:87], v[136:139]
    ds_read_b128 v[44:47], v12 offset:6144
    v_mfma_f32_16x16x32_bf16 v[140:143], v[92:95], v[88:91], v[140:143]
    ds_read_b64_tr_b16 v[48:49], v13 offset:0
    v_mfma_f32_16x16x32_bf16 v[144:147], v[96:99], v[76:79], v[144:147]
    ds_read_b64_tr_b16 v[50:51], v13 offset:1792
    v_mfma_f32_16x16x32_bf16 v[148:151], v[96:99], v[80:83], v[148:151]
    ds_read_b64_tr_b16 v[52:53], v13 offset:32
    v_mfma_f32_16x16x32_bf16 v[152:155], v[96:99], v[84:87], v[152:155]
    ds_read_b64_tr_b16 v[54:55], v13 offset:1824
    v_mfma_f32_16x16x32_bf16 v[156:159], v[96:99], v[88:91], v[156:159]
    ds_read_b64_tr_b16 v[56:57], v13 offset:64
    v_mfma_f32_16x16x32_bf16 v[160:163], v[100:103], v[76:79], v[160:163]
    ds_read_b64_tr_b16 v[58:59], v13 offset:1856
    v_mfma_f32_16x16x32_bf16 v[164:167], v[100:103], v[80:83], v[164:167]
    ds_read_b64_tr_b16 v[60:61], v13 offset:96
    v_mfma_f32_16x16x32_bf16 v[168:171], v[100:103], v[84:87], v[168:171]
    ds_read_b64_tr_b16 v[62:63], v13 offset:1888
    v_mfma_f32_16x16x32_bf16 v[172:175], v[100:103], v[88:91], v[172:175]
    ds_read_b64_tr_b16 v[64:65], v13 offset:128
    v_mfma_f32_16x16x32_bf16 v[176:179], v[104:107], v[76:79], v[176:179]
    ds_read_b64_tr_b16 v[66:67], v13 offset:1920
    v_mfma_f32_16x16x32_bf16 v[180:183], v[104:107], v[80:83], v[180:183]
    ds_read_b64_tr_b16 v[68:69], v13 offset:160
    v_mfma_f32_16x16x32_bf16 v[184:187], v[104:107], v[84:87], v[184:187]
    ds_read_b64_tr_b16 v[70:71], v13 offset:1952
    v_mfma_f32_16x16x32_bf16 v[188:191], v[104:107], v[88:91], v[188:191]
    ds_read_b64_tr_b16 v[72:73], v13 offset:192
    v_mfma_f32_16x16x32_bf16 v[192:195], v[108:111], v[76:79], v[192:195]
    ds_read_b64_tr_b16 v[74:75], v13 offset:1984
    v_mfma_f32_16x16x32_bf16 v[196:199], v[108:111], v[80:83], v[196:199]
    s_add_u32 m0, s32, s7
    s_nop 0
    buffer_load_dwordx4 v4, s[12:15], s29 offen  lds
    v_mfma_f32_16x16x32_bf16 v[200:203], v[108:111], v[84:87], v[200:203]
    buffer_load_dwordx4 v5, s[12:15], s29 offen offset:1024  lds
    v_mfma_f32_16x16x32_bf16 v[204:207], v[108:111], v[88:91], v[204:207]
    buffer_load_dwordx4 v6, s[12:15], s29 offen offset:2048  lds
    v_mfma_f32_16x16x32_bf16 v[208:211], v[112:115], v[76:79], v[208:211]
    s_add_u32 s29, s29, s30
    s_cmp_eq_u32 s29, s31
    s_cselect_b32 s29, 0, s29
    s_cmp_eq_u32 s34, 13
    s_cselect_b32 s29, 0x40000000, s29
    v_mfma_f32_16x16x32_bf16 v[212:215], v[112:115], v[80:83], v[212:215]
    s_bitcmp1_b32 s36, s34
    s_cbranch_scc1 mk_wcs1
mk_wcs1d:
    v_mfma_f32_16x16x32_bf16 v[216:219], v[112:115], v[84:87], v[216:219]
    s_bitcmp1_b32 s37, s34
    s_cbranch_scc1 mk_wsp
mk_wspd:
    v_mfma_f32_16x16x32_bf16 v[220:223], v[112:115], v[88:91], v[220:223]
    v_mfma_f32_16x16x32_bf16 v[224:227], v[116:119], v[76:79], v[224:227]
    v_mfma_f32_16x16x32_bf16 v[228:231], v[116:119], v[80:83], v[228:231]
    v_mfma_f32_16x16x32_bf16 v[232:235], v[116:119], v[84:87], v[232:235]
    v_mfma_f32_16x16x32_bf16 v[236:239], v[116:119], v[88:91], v[236:239]
    s_add_u32 s34, s34, 1
    s_cmp_eq_u32 s34, 16
    s_cbranch_scc1 mk_wloop_x
    s_waitcnt vmcnt(6) lgkmcnt(0)
    s_barrier
    v_mfma_f32_16x16x32_bf16 v[128:131], v[48:51], v[32:35], v[128:131]
    v_add_u32 v12, s33, v9
    ds_read_b128 v[76:79], v12 offset:0
    v_mfma_f32_16x16x32_bf16 v[132:135], v[48:51], v[36:39], v[132:135]
    ds_read_b128 v[80:83], v12 offset:2048
    ds_read_b128 v[84:87], v12 offset:4096
    v_mfma_f32_16x16x32_bf16 v[136:139], v[48:51], v[40:43], v[136:139]
    ds_read_b128 v[88:91], v12 offset:6144
    v_mfma_f32_16x16x32_bf16 v[140:143], v[48:51], v[44:47], v[140:143]
    ds_read_b64_tr_b16 v[92:93], v13 offset:13312
    v_mfma_f32_16x16x32_bf16 v[144:147], v[52:55], v[32:35], v[144:147]
    ds_read_b64_tr_b16 v[94:95], v13 offset:15104
    v_mfma_f32_16x16x32_bf16 v[148:151], v[52:55], v[36:39], v[148:151]
    s_branch mk_wloop
mk_wcsp:
    v_mfma_f32_16x16x32_bf16 v[120:123], v[48:51], v[24:27], v[120:123]
    v_mfma_f32_16x16x32_bf16 v[124:127], v[52:55], v[24:27], v[124:127]
    v_mfma_f32_16x16x32_bf16 v[240:243], v[56:59], v[24:27], v[240:243]
    v_mfma_f32_16x16x32_bf16 v[244:247], v[60:63], v[24:27], v[244:247]
    v_mfma_f32_16x16x32_bf16 v[248:251], v[64:67], v[24:27], v[248:251]
    v_mfma_f32_16x16x32_bf16 v[252:255], v[68:71], v[24:27], v[252:255]
    v_mfma_f32_16x16x32_bf16 v[28:31], v[72:75], v[24:27], v[28:31]
    s_branch mk_wcspd
mk_wcs0:
    v_mfma_f32_16x16x32_bf16 v[120:123], v[48:51], v[24:27], v[120:123]
    v_mfma_f32_16x16x32_bf16 v[124:127], v[52:55], v[24:27], v[124:127]
    v_mfma_f32_16x16x32_bf16 v[240:243], v[56:59], v[24:27], v[240:243]
    v_mfma_f32_16x16x32_bf16 v[244:247], v[60:63], v[24:27], v[244:247]
    v_mfma_f32_16x16x32_bf16 v[248:251], v[64:67], v[24:27], v[248:251]
    v_mfma_f32_16x16x32_bf16 v[252:255], v[68:71], v[24:27], v[252:255]
    v_mfma_f32_16x16x32_bf16 v[28:31], v[72:75], v[24:27], v[28:31]
    s_branch mk_wcs0d
mk_wcs1:
    v_mfma_f32_16x16x32_bf16 v[120:123], v[92:95], v[24:27], v[120:123]
    v_mfma_f32_16x16x32_bf16 v[124:127], v[96:99], v[24:27], v[124:127]
    v_mfma_f32_16x16x32_bf16 v[240:243], v[100:103], v[24:27], v[240:243]
    v_mfma_f32_16x16x32_bf16 v[244:247], v[104:107], v[24:27], v[244:247]
    v_mfma_f32_16x16x32_bf16 v[248:251], v[108:111], v[24:27], v[248:251]
    v_mfma_f32_16x16x32_bf16 v[252:255], v[112:115], v[24:27], v[252:255]
    v_mfma_f32_16x16x32_bf16 v[28:31], v[116:119], v[24:27], v[28:31]
    s_branch mk_wcs1d
mk_wsp:
    s_lshl_b32 s3, s27, 3
    s_add_u32 s3, s3, s26
    s_lshl_b32 s3, s3, 10
    s_add_u32 s3, s3, 50463104
    v_and_b32 v1, 48, v0
    v_and_b32 v2, 15, v0
    v_lshl_add_u32 v1, v2, 6, v1
    v_cmp_eq_u32 vcc, 1, v2
    s_nop 1
    v_cndmask_b32 v120, v120, v124, vcc
    v_cndmask_b32 v121, v121, v125, vcc
    v_cndmask_b32 v122, v122, v126, vcc
    v_cndmask_b32 v123, v123, v127, vcc
    v_cmp_eq_u32 vcc, 2, v2
    s_nop 1
    v_cndmask_b32 v120, v120, v240, vcc
    v_cndmask_b32 v121, v121, v241, vcc
    v_cndmask_b32 v122, v122, v242, vcc
    v_cndmask_b32 v123, v123, v243, vcc
    v_cmp_eq_u32 vcc, 3, v2
    s_nop 1
    v_cndmask_b32 v120, v120, v244, vcc
    v_cndmask_b32 v121, v121, v245, vcc
    v_cndmask_b32 v122, v122, v246, vcc
    v_cndmask_b32 v123, v123, v247, vcc
    v_cmp_eq_u32 vcc, 4, v2
    s_nop 1
    v_cndmask_b32 v120, v120, v248, vcc
    v_cndmask_b32 v121, v121, v249, vcc
    v_cndmask_b32 v122, v122, v250, vcc
    v_cndmask_b32 v123, v123, v251, vcc
    v_cmp_eq_u32 vcc, 5, v2
    s_nop 1
    v_cndmask_b32 v120, v120, v252, vcc
    v_cndmask_b32 v121, v121, v253, vcc
    v_cndmask_b32 v122, v122, v254, vcc
    v_cndmask_b32 v123, v123, v255, vcc
    v_cmp_eq_u32 vcc, 6, v2
    s_nop 1
    v_cndmask_b32 v120, v120, v28, vcc
    v_cndmask_b32 v121, v121, v29, vcc
    v_cndmask_b32 v122, v122, v30, vcc
    v_cndmask_b32 v123, v123, v31, vcc
    s_mov_b32 exec_lo, 0x7f007f
    s_mov_b32 exec_hi, 0x7f007f
    buffer_store_dwordx4 v[120:123], v1, s[8:11], s3 offen sc1
    s_mov_b64 exec, -1
    s_branch mk_wspd
mk_w7:
    v_lshrrev_b32 v4, 3, v0
    v_lshlrev_b32 v4, 11, v4
    v_bfe_u32 v5, v0, 4, 2
    v_lshlrev_b32 v5, 1, v5
    v_and_b32 v6, 7, v0
    v_xor_b32 v5, v5, v6
    v_lshl_add_u32 v4, v5, 4, v4
    v_add_u32 v5, 15360, v4
    v_add_u32 v6, 30720, v4
    v_add_u32 v7, 46080, v4
    v_lshrrev_b32 v16, 5, v0
    v_lshlrev_b32 v16, 4, v16
    v_bfe_u32 v17, v0, 4, 1
    v_lshl_add_u32 v16, v17, 2, v16
    v_bfe_u32 v17, v0, 2, 2
    v_add_u32 v16, v16, v17
    v_lshlrev_b32 v16, 7, v16
    v_bfe_u32 v17, v0, 3, 2
    v_lshl_add_u32 v16, v17, 5, v16
    v_and_b32 v17, 3, v0
    v_lshl_add_u32 v16, v17, 3, v16
    v_add_u32 v16, 151552, v16
    v_xor_b32 v17, 32, v16
    v_xor_b32 v18, 64, v16
    v_xor_b32 v19, 0x60, v16
    s_mul_i32 s32, s26, 28
    s_add_u32 s32, s32, s27
    s_cmp_gt_u32 s27, 7
    s_cselect_b32 s3, 2, 0
    s_sub_u32 s32, s32, s3
    s_cmp_gt_u32 s27, 23
    s_cselect_b32 s3, 2, 0
    s_sub_u32 s32, s32, s3
    s_mov_b32 s30, 151552
    s_mov_b32 s12, s52
    s_mov_b32 s13, s53
    s_mov_b32 s14, 0x700000
    s_mov_b32 s15, 0x00020000
    s_lshr_b32 s4, s32, 4
    s_and_b32 s5, s32, 15
    s_mul_i32 s28, s5, 144
    s_add_u32 s28, s28, s4
    s_lshl_b32 s28, s28, 12
    s_add_u32 s28, s28, 67108864
    s_lshl_b32 s29, s4, 16
    s_lshl_b32 s5, s5, 7
    s_add_u32 s29, s29, s5
    s_mov_b32 s31, s29
    s_mov_b32 s36, 4092
    s_cmp_lt_u32 s4, 4
    s_cselect_b32 s36, 8188, s36
    s_and_b32 s3, s27, 14
    s_cmp_eq_u32 s3, 6
    s_cselect_b32 s36, 0, s36
    s_lshl_b32 s37, s36, 2
    s_waitcnt lgkmcnt(0)
    s_barrier
    v_mfma_f32_16x16x32_bf16 v[128:131], v[48:51], v[32:35], v[128:131]
    v_add_u32 v12, s33, v9
    ds_read_b128 v[76:79], v12 offset:0
    v_mfma_f32_16x16x32_bf16 v[132:135], v[48:51], v[36:39], v[132:135]
    ds_read_b128 v[80:83], v12 offset:2048
    ds_read_b128 v[84:87], v12 offset:4096
    v_mfma_f32_16x16x32_bf16 v[136:139], v[48:51], v[40:43], v[136:139]
    ds_read_b128 v[88:91], v12 offset:6144
    ds_read_b64_tr_b16 v[92:93], v13 offset:13312
    v_mfma_f32_16x16x32_bf16 v[140:143], v[48:51], v[44:47], v[140:143]
    ds_read_b64_tr_b16 v[94:95], v13 offset:15104
    ds_read_b64_tr_b16 v[96:97], v13 offset:13344
    v_mfma_f32_16x16x32_bf16 v[144:147], v[52:55], v[32:35], v[144:147]
    ds_read_b64_tr_b16 v[98:99], v13 offset:15136
    ds_read_b64_tr_b16 v[100:101], v13 offset:13376
    v_mfma_f32_16x16x32_bf16 v[148:151], v[52:55], v[36:39], v[148:151]
    .p2align 6
mk_w7loop:
    ds_read_b64_tr_b16 v[102:103], v13 offset:15168
    ds_read_b64_tr_b16 v[104:105], v13 offset:13408
    v_mfma_f32_16x16x32_bf16 v[152:155], v[52:55], v[40:43], v[152:155]
    ds_read_b64_tr_b16 v[106:107], v13 offset:15200
    v_mfma_f32_16x16x32_bf16 v[156:159], v[52:55], v[44:47], v[156:159]
    ds_read_b64_tr_b16 v[108:109], v13 offset:13440
    v_mfma_f32_16x16x32_bf16 v[160:163], v[56:59], v[32:35], v[160:163]
    ds_read_b64_tr_b16 v[110:111], v13 offset:15232
    v_mfma_f32_16x16x32_bf16 v[164:167], v[56:59], v[36:39], v[164:167]
    ds_read_b64_tr_b16 v[112:113], v13 offset:13472
    v_mfma_f32_16x16x32_bf16 v[168:171], v[56:59], v[40:43], v[168:171]
    ds_read_b64_tr_b16 v[114:115], v13 offset:15264
    v_mfma_f32_16x16x32_bf16 v[172:175], v[56:59], v[44:47], v[172:175]
    ds_read_b64_tr_b16 v[116:117], v13 offset:13504
    v_mfma_f32_16x16x32_bf16 v[176:179], v[60:63], v[32:35], v[176:179]
    ds_read_b64_tr_b16 v[118:119], v13 offset:15296
    v_mfma_f32_16x16x32_bf16 v[180:183], v[60:63], v[36:39], v[180:183]
    s_bitcmp0_b32 s37, s34
    s_cbranch_scc1 mk_w7nw
    s_waitcnt vmcnt(4)
    ds_read_b64_tr_b16 v[240:241], v16 offset:0
    ds_read_b64_tr_b16 v[242:243], v16 offset:1024
    ds_read_b64_tr_b16 v[244:245], v17 offset:0
    ds_read_b64_tr_b16 v[246:247], v17 offset:1024
    ds_read_b64_tr_b16 v[248:249], v18 offset:0
    ds_read_b64_tr_b16 v[250:251], v18 offset:1024
    ds_read_b64_tr_b16 v[252:253], v19 offset:0
    ds_read_b64_tr_b16 v[254:255], v19 offset:1024
mk_w7nw:
    v_mfma_f32_16x16x32_bf16 v[184:187], v[60:63], v[40:43], v[184:187]
    v_mfma_f32_16x16x32_bf16 v[188:191], v[60:63], v[44:47], v[188:191]
    v_mfma_f32_16x16x32_bf16 v[192:195], v[64:67], v[32:35], v[192:195]
    v_mfma_f32_16x16x32_bf16 v[196:199], v[64:67], v[36:39], v[196:199]
    v_mfma_f32_16x16x32_bf16 v[200:203], v[64:67], v[40:43], v[200:203]
    v_mfma_f32_16x16x32_bf16 v[204:207], v[64:67], v[44:47], v[204:207]
    v_mfma_f32_16x16x32_bf16 v[208:211], v[68:71], v[32:35], v[208:211]
    v_mfma_f32_16x16x32_bf16 v[212:215], v[68:71], v[36:39], v[212:215]
    v_mfma_f32_16x16x32_bf16 v[216:219], v[68:71], v[40:43], v[216:219]
    v_mfma_f32_16x16x32_bf16 v[220:223], v[68:71], v[44:47], v[220:223]
    v_mfma_f32_16x16x32_bf16 v[224:227], v[72:75], v[32:35], v[224:227]
    v_mfma_f32_16x16x32_bf16 v[228:231], v[72:75], v[36:39], v[228:231]
    v_mfma_f32_16x16x32_bf16 v[232:235], v[72:75], v[40:43], v[232:235]
    v_mfma_f32_16x16x32_bf16 v[236:239], v[72:75], v[44:47], v[236:239]
    s_waitcnt lgkmcnt(0)
    s_barrier
    v_mfma_f32_16x16x32_bf16 v[128:131], v[92:95], v[76:79], v[128:131]
    s_add_u32 s33, s33, 32768
    s_cmp_eq_u32 s33, 98304
    s_cselect_b32 s33, 0, s33
    s_xor_b32 s35, s35, 26624
    v_add_u32 v12, s33, v8
    v_add_u32 v13, s35, v10
    s_bitcmp0_b32 s37, s34
    s_cbranch_scc1 mk_w7ns
    buffer_store_dwordx4 v[240:243], v3, s[8:11], s28 offen offset:0 sc1
    buffer_store_dwordx4 v[244:247], v3, s[8:11], s28 offen offset:1024 sc1
    buffer_store_dwordx4 v[248:251], v3, s[8:11], s28 offen offset:2048 sc1
    buffer_store_dwordx4 v[252:255], v3, s[8:11], s28 offen offset:3072 sc1
    s_add_u32 s28, s28, 57344
mk_w7ns:
    v_mfma_f32_16x16x32_bf16 v[132:135], v[92:95], v[80:83], v[132:135]
    s_cmp_eq_u32 s34, 10
    s_cbranch_scc1 mk_w7sw
mk_w7swd:
    s_bitcmp0_b32 s36, s34
    s_mov_b32 m0, s30
    s_cbranch_scc1 mk_w7_skip
    buffer_load_dwordx4 v4, s[12:15], s29 offen offset:0 nt lds
    buffer_load_dwordx4 v5, s[12:15], s29 offen offset:1024 nt lds
    buffer_load_dwordx4 v6, s[12:15], s29 offen offset:2048 nt lds
    buffer_load_dwordx4 v7, s[12:15], s29 offen offset:3072 nt lds
    s_add_u32 s29, s29, 917504
mk_w7_skip:
    s_xor_b32 s30, s30, 0x3000
    v_xor_b32 v16, 0x3000, v16
    v_xor_b32 v17, 0x3000, v17
    v_xor_b32 v18, 0x3000, v18
    v_xor_b32 v19, 0x3000, v19
    v_mfma_f32_16x16x32_bf16 v[136:139], v[92:95], v[84:87], v[136:139]
    ds_read_b128 v[32:35], v12 offset:0
    ds_read_b128 v[36:39], v12 offset:2048
    v_mfma_f32_16x16x32_bf16 v[140:143], v[92:95], v[88:91], v[140:143]
    ds_read_b128 v[40:43], v12 offset:4096
    ds_read_b128 v[44:47], v12 offset:6144
    v_mfma_f32_16x16x32_bf16 v[144:147], v[96:99], v[76:79], v[144:147]
    ds_read_b64_tr_b16 v[48:49], v13 offset:0
    ds_read_b64_tr_b16 v[50:51], v13 offset:1792
    v_mfma_f32_16x16x32_bf16 v[148:151], v[96:99], v[80:83], v[148:151]
    ds_read_b64_tr_b16 v[52:53], v13 offset:32
    ds_read_b64_tr_b16 v[54:55], v13 offset:1824
    v_mfma_f32_16x16x32_bf16 v[152:155], v[96:99], v[84:87], v[152:155]
    ds_read_b64_tr_b16 v[56:57], v13 offset:64
    v_mfma_f32_16x16x32_bf16 v[156:159], v[96:99], v[88:91], v[156:159]
    ds_read_b64_tr_b16 v[58:59], v13 offset:1856
    v_mfma_f32_16x16x32_bf16 v[160:163], v[100:103], v[76:79], v[160:163]
    ds_read_b64_tr_b16 v[60:61], v13 offset:96
    v_mfma_f32_16x16x32_bf16 v[164:167], v[100:103], v[80:83], v[164:167]
    ds_read_b64_tr_b16 v[62:63], v13 offset:1888
    v_mfma_f32_16x16x32_bf16 v[168:171], v[100:103], v[84:87], v[168:171]
    ds_read_b64_tr_b16 v[64:65], v13 offset:128
    v_mfma_f32_16x16x32_bf16 v[172:175], v[100:103], v[88:91], v[172:175]
    ds_read_b64_tr_b16 v[66:67], v13 offset:1920
    v_mfma_f32_16x16x32_bf16 v[176:179], v[104:107], v[76:79], v[176:179]
    ds_read_b64_tr_b16 v[68:69], v13 offset:160
    v_mfma_f32_16x16x32_bf16 v[180:183], v[104:107], v[80:83], v[180:183]
    ds_read_b64_tr_b16 v[70:71], v13 offset:1952
    v_mfma_f32_16x16x32_bf16 v[184:187], v[104:107], v[84:87], v[184:187]
    ds_read_b64_tr_b16 v[72:73], v13 offset:192
    v_mfma_f32_16x16x32_bf16 v[188:191], v[104:107], v[88:91], v[188:191]
    ds_read_b64_tr_b16 v[74:75], v13 offset:1984
    v_mfma_f32_16x16x32_bf16 v[192:195], v[108:111], v[76:79], v[192:195]
    v_mfma_f32_16x16x32_bf16 v[196:199], v[108:111], v[80:83], v[196:199]
    v_mfma_f32_16x16x32_bf16 v[200:203], v[108:111], v[84:87], v[200:203]
    v_mfma_f32_16x16x32_bf16 v[204:207], v[108:111], v[88:91], v[204:207]
    v_mfma_f32_16x16x32_bf16 v[208:211], v[112:115], v[76:79], v[208:211]
    v_mfma_f32_16x16x32_bf16 v[212:215], v[112:115], v[80:83], v[212:215]
    v_mfma_f32_16x16x32_bf16 v[216:219], v[112:115], v[84:87], v[216:219]
    v_mfma_f32_16x16x32_bf16 v[220:223], v[112:115], v[88:91], v[220:223]
    v_mfma_f32_16x16x32_bf16 v[224:227], v[116:119], v[76:79], v[224:227]
    v_mfma_f32_16x16x32_bf16 v[228:231], v[116:119], v[80:83], v[228:231]
    v_mfma_f32_16x16x32_bf16 v[232:235], v[116:119], v[84:87], v[232:235]
    v_mfma_f32_16x16x32_bf16 v[236:239], v[116:119], v[88:91], v[236:239]
    s_add_u32 s34, s34, 1
    s_cmp_eq_u32 s34, 16
    s_cbranch_scc1 mk_w7loop_x
    s_waitcnt lgkmcnt(0)
    s_barrier
    v_mfma_f32_16x16x32_bf16 v[128:131], v[48:51], v[32:35], v[128:131]
    v_add_u32 v12, s33, v9
    ds_read_b128 v[76:79], v12 offset:0
    v_mfma_f32_16x16x32_bf16 v[132:135], v[48:51], v[36:39], v[132:135]
    ds_read_b128 v[80:83], v12 offset:2048
    ds_read_b128 v[84:87], v12 offset:4096
    v_mfma_f32_16x16x32_bf16 v[136:139], v[48:51], v[40:43], v[136:139]
    ds_read_b128 v[88:91], v12 offset:6144
    ds_read_b64_tr_b16 v[92:93], v13 offset:13312
    v_mfma_f32_16x16x32_bf16 v[140:143], v[48:51], v[44:47], v[140:143]
    ds_read_b64_tr_b16 v[94:95], v13 offset:15104
    ds_read_b64_tr_b16 v[96:97], v13 offset:13344
    v_mfma_f32_16x16x32_bf16 v[144:147], v[52:55], v[32:35], v[144:147]
    ds_read_b64_tr_b16 v[98:99], v13 offset:15136
    ds_read_b64_tr_b16 v[100:101], v13 offset:13376
    v_mfma_f32_16x16x32_bf16 v[148:151], v[52:55], v[36:39], v[148:151]
    s_branch mk_w7loop
mk_w7sw:
    s_mov_b32 s12, s44
    s_mov_b32 s13, s45
    s_mov_b32 s14, 0x200000
    s_mov_b32 s15, 0x00020000
    s_mov_b32 s29, s31
    s_branch mk_w7swd
mk_w7loop_x:
    s_lshl_b32 s3, s2, 2
    s_add_u32 s3, s3, 50339840
    s_waitcnt vmcnt(0)
    v_mov_b32 v1, s25
    v_mov_b32 v2, 0
    s_mov_b64 exec, 1
    buffer_store_dword v1, v2, s[8:11], s3 offen sc1
    s_mov_b64 exec, -1
    s_waitcnt lgkmcnt(0)
    s_branch mk_wloop_y
mk_wloop_x:
    s_waitcnt vmcnt(0) lgkmcnt(0)
mk_wloop_y:
    s_barrier
    s_setprio 1
    v_and_b32 v4, 15, v0
    v_lshlrev_b32 v4, 3, v4
    s_lshl_b32 s3, s62, 9
    s_add_u32 s3, s3, 159744
    v_add_u32 v4, s3, v4
    v_and_b32 v6, 48, v0
    v_add_u32 v5, 151936, v6
    v_lshrrev_b32 v6, 1, v6
    v_add_u32 v6, 161792, v6
    ds_read_b128 v[64:67], v5 offset:0
    ds_read_b128 v[68:71], v5 offset:64
    ds_read_b128 v[72:75], v5 offset:128
    ds_read_b128 v[76:79], v5 offset:192
    ds_read_b128 v[80:83], v5 offset:256
    ds_read_b128 v[84:87], v5 offset:320
    ds_read_b128 v[88:91], v5 offset:384
    ds_read_b64 v[16:17], v4 offset:0
    ds_read_b64 v[18:19], v4 offset:128
    ds_read_b64 v[20:21], v4 offset:256
    ds_read_b64 v[22:23], v4 offset:384
    ds_read_b64 v[92:93], v6 offset:0
    ds_read_b64 v[94:95], v6 offset:32
    ds_read_b64 v[96:97], v6 offset:64
    ds_read_b64 v[98:99], v6 offset:96
    ds_read_b64 v[100:101], v6 offset:128
    ds_read_b64 v[102:103], v6 offset:160
    ds_read_b64 v[104:105], v6 offset:192
    v_bfe_u32 v7, v0, 4, 1
    v_lshlrev_b32 v7, 5, v7
    v_lshrrev_b32 v8, 5, v0
    v_lshl_add_u32 v7, v8, 4, v7
    v_and_b32 v8, 15, v0
    v_add_u32 v7, v7, v8
    v_lshlrev_b32 v2, 4, v7
    s_lshl_b32 s3, s26, 3
    s_lshl_b32 s4, s62, 1
    s_add_u32 s3, s3, s4
    s_mul_i32 s3, s3, 294912
    s_mul_i32 s4, s27, 7168
    s_add_u32 s3, s3, s4
    s_add_u32 s3, s3, 16842752
    v_add_u32 v2, s3, v2
    s_mov_b32 s36, 0
    s_mov_b32 s37, 294912
    s_mov_b32 s4, 0xc0135761
    s_mov_b32 s6, 0xbdd2d3e8
    s_mov_b32 s7, s6
    v_mov_b32 v8, s4
    v_mov_b32 v9, s4
    s_waitcnt lgkmcnt(0)
    v_lshlrev_b32 v108, 16, v92
    v_and_b32 v109, 0xffff0000, v92
    v_lshlrev_b32 v110, 16, v93
    v_and_b32 v111, 0xffff0000, v93
    v_pk_fma_f32 v[32:33], v[16:17], v[64:65], v[108:109] op_sel:[1,0,0] op_sel_hi:[1,1,1]
    v_pk_fma_f32 v[34:35], v[16:17], v[66:67], v[110:111] op_sel:[1,0,0] op_sel_hi:[1,1,1]
    v_pk_fma_f32 v[128:129], v[16:17], v[128:129], v[32:33] op_sel:[0,0,0] op_sel_hi:[0,1,1]
    v_pk_fma_f32 v[130:131], v[16:17], v[130:131], v[34:35] op_sel:[0,0,0] op_sel_hi:[0,1,1]
    v_pk_fma_f32 v[36:37], v[18:19], v[64:65], v[108:109] op_sel:[1,0,0] op_sel_hi:[1,1,1]
    v_pk_fma_f32 v[38:39], v[18:19], v[66:67], v[110:111] op_sel:[1,0,0] op_sel_hi:[1,1,1]
    v_pk_fma_f32 v[132:133], v[18:19], v[132:133], v[36:37] op_sel:[0,0,0] op_sel_hi:[0,1,1]
    v_pk_fma_f32 v[134:135], v[18:19], v[134:135], v[38:39] op_sel:[0,0,0] op_sel_hi:[0,1,1]
    v_pk_mul_f32 v[32:33], v[128:129], v[128:129]
    v_pk_mul_f32 v[34:35], v[130:131], v[130:131]
    v_pk_mul_f32 v[36:37], v[132:133], v[132:133]
    v_pk_mul_f32 v[38:39], v[134:135], v[134:135]
    v_pk_fma_f32 v[32:33], v[32:33], s[6:7], v[8:9]
    v_pk_fma_f32 v[34:35], v[34:35], s[6:7], v[8:9]
    v_pk_fma_f32 v[36:37], v[36:37], s[6:7], v[8:9]
    v_pk_fma_f32 v[38:39], v[38:39], s[6:7], v[8:9]
    v_pk_mul_f32 v[32:33], v[32:33], v[128:129]
    v_pk_mul_f32 v[34:35], v[34:35], v[130:131]
    v_pk_mul_f32 v[36:37], v[36:37], v[132:133]
    v_pk_mul_f32 v[38:39], v[38:39], v[134:135]
    v_exp_f32 v32, v32
    v_pk_fma_f32 v[40:41], v[20:21], v[64:65], v[108:109] op_sel:[1,0,0] op_sel_hi:[1,1,1]
    v_exp_f32 v33, v33
    v_pk_fma_f32 v[42:43], v[20:21], v[66:67], v[110:111] op_sel:[1,0,0] op_sel_hi:[1,1,1]
    v_exp_f32 v34, v34
    v_pk_fma_f32 v[136:137], v[20:21], v[136:137], v[40:41] op_sel:[0,0,0] op_sel_hi:[0,1,1]
    v_exp_f32 v35, v35
    v_pk_fma_f32 v[138:139], v[20:21], v[138:139], v[42:43] op_sel:[0,0,0] op_sel_hi:[0,1,1]
    v_pk_fma_f32 v[44:45], v[22:23], v[64:65], v[108:109] op_sel:[1,0,0] op_sel_hi:[1,1,1]
    v_exp_f32 v36, v36
    v_pk_fma_f32 v[46:47], v[22:23], v[66:67], v[110:111] op_sel:[1,0,0] op_sel_hi:[1,1,1]
    v_exp_f32 v37, v37
    v_pk_fma_f32 v[140:141], v[22:23], v[140:141], v[44:45] op_sel:[0,0,0] op_sel_hi:[0,1,1]
    v_exp_f32 v38, v38
    v_pk_fma_f32 v[142:143], v[22:23], v[142:143], v[46:47] op_sel:[0,0,0] op_sel_hi:[0,1,1]
    v_exp_f32 v39, v39
    v_pk_mul_f32 v[40:41], v[136:137], v[136:137]
    v_pk_mul_f32 v[42:43], v[138:139], v[138:139]
    v_pk_add_f32 v[32:33], v[32:33], 1.0 op_sel_hi:[1,0]
    v_pk_add_f32 v[34:35], v[34:35], 1.0 op_sel_hi:[1,0]
    v_pk_add_f32 v[36:37], v[36:37], 1.0 op_sel_hi:[1,0]
    v_pk_add_f32 v[38:39], v[38:39], 1.0 op_sel_hi:[1,0]
    v_rcp_f32 v32, v32
    v_pk_mul_f32 v[44:45], v[140:141], v[140:141]
    v_rcp_f32 v33, v33
    v_pk_mul_f32 v[46:47], v[142:143], v[142:143]
    v_rcp_f32 v34, v34
    v_pk_fma_f32 v[40:41], v[40:41], s[6:7], v[8:9]
    v_rcp_f32 v35, v35
    v_pk_fma_f32 v[42:43], v[42:43], s[6:7], v[8:9]
    v_pk_fma_f32 v[44:45], v[44:45], s[6:7], v[8:9]
    v_rcp_f32 v36, v36
    v_pk_fma_f32 v[46:47], v[46:47], s[6:7], v[8:9]
    v_rcp_f32 v37, v37
    v_pk_mul_f32 v[40:41], v[40:41], v[136:137]
    v_rcp_f32 v38, v38
    v_pk_mul_f32 v[42:43], v[42:43], v[138:139]
    v_rcp_f32 v39, v39
    v_pk_mul_f32 v[44:45], v[44:45], v[140:141]
    v_pk_mul_f32 v[46:47], v[46:47], v[142:143]
    v_exp_f32 v40, v40
    v_pk_mul_f32 v[32:33], v[32:33], v[128:129]
    v_pk_mul_f32 v[34:35], v[34:35], v[130:131]
    v_exp_f32 v41, v41
    v_pk_mul_f32 v[36:37], v[36:37], v[132:133]
    v_pk_mul_f32 v[38:39], v[38:39], v[134:135]
    v_exp_f32 v42, v42
    v_cvt_pk_bf16_f32 v56, v32, v33
    v_cvt_pk_bf16_f32 v57, v34, v35
    v_exp_f32 v43, v43
    v_cvt_pk_bf16_f32 v58, v36, v37
    v_cvt_pk_bf16_f32 v59, v38, v39
    v_exp_f32 v44, v44
    v_lshlrev_b32 v112, 16, v94
    v_and_b32 v113, 0xffff0000, v94
    v_exp_f32 v45, v45
    v_lshlrev_b32 v114, 16, v95
    v_and_b32 v115, 0xffff0000, v95
    v_exp_f32 v46, v46
    v_pk_fma_f32 v[48:49], v[16:17], v[68:69], v[112:113] op_sel:[1,0,0] op_sel_hi:[1,1,1]
    v_pk_fma_f32 v[50:51], v[16:17], v[70:71], v[114:115] op_sel:[1,0,0] op_sel_hi:[1,1,1]
    v_exp_f32 v47, v47
    v_permlane32_swap_b32 v56, v58
    v_permlane32_swap_b32 v57, v59
    buffer_store_dwordx4 v[56:59], v2, s[8:11], s36 offen offset:0 sc1
    v_pk_add_f32 v[40:41], v[40:41], 1.0 op_sel_hi:[1,0]
    v_pk_add_f32 v[42:43], v[42:43], 1.0 op_sel_hi:[1,0]
    v_pk_add_f32 v[44:45], v[44:45], 1.0 op_sel_hi:[1,0]
    v_pk_add_f32 v[46:47], v[46:47], 1.0 op_sel_hi:[1,0]
    v_rcp_f32 v40, v40
    v_pk_fma_f32 v[144:145], v[16:17], v[144:145], v[48:49] op_sel:[0,0,0] op_sel_hi:[0,1,1]
    v_pk_fma_f32 v[146:147], v[16:17], v[146:147], v[50:51] op_sel:[0,0,0] op_sel_hi:[0,1,1]
    v_rcp_f32 v41, v41
    v_pk_fma_f32 v[52:53], v[18:19], v[68:69], v[112:113] op_sel:[1,0,0] op_sel_hi:[1,1,1]
    v_pk_fma_f32 v[54:55], v[18:19], v[70:71], v[114:115] op_sel:[1,0,0] op_sel_hi:[1,1,1]
    v_rcp_f32 v42, v42
    v_pk_fma_f32 v[148:149], v[18:19], v[148:149], v[52:53] op_sel:[0,0,0] op_sel_hi:[0,1,1]
    v_pk_fma_f32 v[150:151], v[18:19], v[150:151], v[54:55] op_sel:[0,0,0] op_sel_hi:[0,1,1]
    v_rcp_f32 v43, v43
    v_pk_mul_f32 v[48:49], v[144:145], v[144:145]
    v_pk_mul_f32 v[50:51], v[146:147], v[146:147]
    v_pk_mul_f32 v[52:53], v[148:149], v[148:149]
    v_rcp_f32 v44, v44
    v_pk_mul_f32 v[54:55], v[150:151], v[150:151]
    v_pk_fma_f32 v[48:49], v[48:49], s[6:7], v[8:9]
    v_rcp_f32 v45, v45
    v_pk_fma_f32 v[50:51], v[50:51], s[6:7], v[8:9]
    v_pk_fma_f32 v[52:53], v[52:53], s[6:7], v[8:9]
    v_rcp_f32 v46, v46
    v_pk_fma_f32 v[54:55], v[54:55], s[6:7], v[8:9]
    v_pk_mul_f32 v[48:49], v[48:49], v[144:145]
    v_rcp_f32 v47, v47
    v_pk_mul_f32 v[50:51], v[50:51], v[146:147]
    v_pk_mul_f32 v[52:53], v[52:53], v[148:149]
    v_pk_mul_f32 v[54:55], v[54:55], v[150:151]
    v_exp_f32 v48, v48
    v_pk_mul_f32 v[40:41], v[40:41], v[136:137]
    v_exp_f32 v49, v49
    v_pk_mul_f32 v[42:43], v[42:43], v[138:139]
    v_pk_mul_f32 v[44:45], v[44:45], v[140:141]
    v_exp_f32 v50, v50
    v_pk_mul_f32 v[46:47], v[46:47], v[142:143]
    v_cvt_pk_bf16_f32 v60, v40, v41
    v_exp_f32 v51, v51
    v_cvt_pk_bf16_f32 v61, v42, v43
    v_cvt_pk_bf16_f32 v62, v44, v45
    v_exp_f32 v52, v52
    v_cvt_pk_bf16_f32 v63, v46, v47
    v_pk_fma_f32 v[32:33], v[20:21], v[68:69], v[112:113] op_sel:[1,0,0] op_sel_hi:[1,1,1]
    v_exp_f32 v53, v53
    v_pk_fma_f32 v[34:35], v[20:21], v[70:71], v[114:115] op_sel:[1,0,0] op_sel_hi:[1,1,1]
    v_pk_fma_f32 v[152:153], v[20:21], v[152:153], v[32:33] op_sel:[0,0,0] op_sel_hi:[0,1,1]
    v_exp_f32 v54, v54
    v_pk_fma_f32 v[154:155], v[20:21], v[154:155], v[34:35] op_sel:[0,0,0] op_sel_hi:[0,1,1]
    v_permlane32_swap_b32 v60, v62
    v_exp_f32 v55, v55
    v_permlane32_swap_b32 v61, v63
    buffer_store_dwordx4 v[60:63], v2, s[8:11], s37 offen offset:0 sc1
    v_pk_add_f32 v[48:49], v[48:49], 1.0 op_sel_hi:[1,0]
    v_pk_add_f32 v[50:51], v[50:51], 1.0 op_sel_hi:[1,0]
    v_pk_add_f32 v[52:53], v[52:53], 1.0 op_sel_hi:[1,0]
    v_pk_add_f32 v[54:55], v[54:55], 1.0 op_sel_hi:[1,0]
    v_rcp_f32 v48, v48
    v_pk_fma_f32 v[36:37], v[22:23], v[68:69], v[112:113] op_sel:[1,0,0] op_sel_hi:[1,1,1]
    v_pk_fma_f32 v[38:39], v[22:23], v[70:71], v[114:115] op_sel:[1,0,0] op_sel_hi:[1,1,1]
    v_rcp_f32 v49, v49
    v_pk_fma_f32 v[156:157], v[22:23], v[156:157], v[36:37] op_sel:[0,0,0] op_sel_hi:[0,1,1]
    v_pk_fma_f32 v[158:159], v[22:23], v[158:159], v[38:39] op_sel:[0,0,0] op_sel_hi:[0,1,1]
    v_rcp_f32 v50, v50
    v_pk_mul_f32 v[32:33], v[152:153], v[152:153]
    v_pk_mul_f32 v[34:35], v[154:155], v[154:155]
    v_rcp_f32 v51, v51
    v_pk_mul_f32 v[36:37], v[156:157], v[156:157]
    v_pk_mul_f32 v[38:39], v[158:159], v[158:159]
    v_rcp_f32 v52, v52
    v_pk_fma_f32 v[32:33], v[32:33], s[6:7], v[8:9]
    v_pk_fma_f32 v[34:35], v[34:35], s[6:7], v[8:9]
    v_rcp_f32 v53, v53
    v_pk_fma_f32 v[36:37], v[36:37], s[6:7], v[8:9]
    v_pk_fma_f32 v[38:39], v[38:39], s[6:7], v[8:9]
    v_rcp_f32 v54, v54
    v_pk_mul_f32 v[32:33], v[32:33], v[152:153]
    v_pk_mul_f32 v[34:35], v[34:35], v[154:155]
    v_rcp_f32 v55, v55
    v_pk_mul_f32 v[36:37], v[36:37], v[156:157]
    v_pk_mul_f32 v[38:39], v[38:39], v[158:159]
    v_exp_f32 v32, v32
    v_pk_mul_f32 v[48:49], v[48:49], v[144:145]
    v_pk_mul_f32 v[50:51], v[50:51], v[146:147]
    v_exp_f32 v33, v33
    v_pk_mul_f32 v[52:53], v[52:53], v[148:149]
    v_pk_mul_f32 v[54:55], v[54:55], v[150:151]
    v_exp_f32 v34, v34
    v_cvt_pk_bf16_f32 v56, v48, v49
    v_cvt_pk_bf16_f32 v57, v50, v51
    v_exp_f32 v35, v35
    v_cvt_pk_bf16_f32 v58, v52, v53
    v_cvt_pk_bf16_f32 v59, v54, v55
    v_exp_f32 v36, v36
    v_lshlrev_b32 v108, 16, v96
    v_and_b32 v109, 0xffff0000, v96
    v_exp_f32 v37, v37
    v_lshlrev_b32 v110, 16, v97
    v_and_b32 v111, 0xffff0000, v97
    v_exp_f32 v38, v38
    v_pk_fma_f32 v[40:41], v[16:17], v[72:73], v[108:109] op_sel:[1,0,0] op_sel_hi:[1,1,1]
    v_pk_fma_f32 v[42:43], v[16:17], v[74:75], v[110:111] op_sel:[1,0,0] op_sel_hi:[1,1,1]
    v_exp_f32 v39, v39
    v_permlane32_swap_b32 v56, v58
    v_permlane32_swap_b32 v57, v59
    buffer_store_dwordx4 v[56:59], v2, s[8:11], s36 offen offset:1024 sc1
    v_pk_add_f32 v[32:33], v[32:33], 1.0 op_sel_hi:[1,0]
    v_pk_add_f32 v[34:35], v[34:35], 1.0 op_sel_hi:[1,0]
    v_pk_add_f32 v[36:37], v[36:37], 1.0 op_sel_hi:[1,0]
    v_pk_add_f32 v[38:39], v[38:39], 1.0 op_sel_hi:[1,0]
    v_rcp_f32 v32, v32
    v_pk_fma_f32 v[160:161], v[16:17], v[160:161], v[40:41] op_sel:[0,0,0] op_sel_hi:[0,1,1]
    v_pk_fma_f32 v[162:163], v[16:17], v[162:163], v[42:43] op_sel:[0,0,0] op_sel_hi:[0,1,1]
    v_rcp_f32 v33, v33
    v_pk_fma_f32 v[44:45], v[18:19], v[72:73], v[108:109] op_sel:[1,0,0] op_sel_hi:[1,1,1]
    v_pk_fma_f32 v[46:47], v[18:19], v[74:75], v[110:111] op_sel:[1,0,0] op_sel_hi:[1,1,1]
    v_rcp_f32 v34, v34
    v_pk_fma_f32 v[164:165], v[18:19], v[164:165], v[44:45] op_sel:[0,0,0] op_sel_hi:[0,1,1]
    v_pk_fma_f32 v[166:167], v[18:19], v[166:167], v[46:47] op_sel:[0,0,0] op_sel_hi:[0,1,1]
    v_rcp_f32 v35, v35
    v_pk_mul_f32 v[40:41], v[160:161], v[160:161]
    v_pk_mul_f32 v[42:43], v[162:163], v[162:163]
    v_pk_mul_f32 v[44:45], v[164:165], v[164:165]
    v_rcp_f32 v36, v36
    v_pk_mul_f32 v[46:47], v[166:167], v[166:167]
    v_pk_fma_f32 v[40:41], v[40:41], s[6:7], v[8:9]
    v_rcp_f32 v37, v37
    v_pk_fma_f32 v[42:43], v[42:43], s[6:7], v[8:9]
    v_pk_fma_f32 v[44:45], v[44:45], s[6:7], v[8:9]
    v_rcp_f32 v38, v38
    v_pk_fma_f32 v[46:47], v[46:47], s[6:7], v[8:9]
    v_pk_mul_f32 v[40:41], v[40:41], v[160:161]
    v_rcp_f32 v39, v39
    v_pk_mul_f32 v[42:43], v[42:43], v[162:163]
    v_pk_mul_f32 v[44:45], v[44:45], v[164:165]
    v_pk_mul_f32 v[46:47], v[46:47], v[166:167]
    v_exp_f32 v40, v40
    v_pk_mul_f32 v[32:33], v[32:33], v[152:153]
    v_exp_f32 v41, v41
    v_pk_mul_f32 v[34:35], v[34:35], v[154:155]
    v_pk_mul_f32 v[36:37], v[36:37], v[156:157]
    v_exp_f32 v42, v42
    v_pk_mul_f32 v[38:39], v[38:39], v[158:159]
    v_cvt_pk_bf16_f32 v60, v32, v33
    v_exp_f32 v43, v43
    v_cvt_pk_bf16_f32 v61, v34, v35
    v_cvt_pk_bf16_f32 v62, v36, v37
    v_exp_f32 v44, v44
    v_cvt_pk_bf16_f32 v63, v38, v39
    v_pk_fma_f32 v[48:49], v[20:21], v[72:73], v[108:109] op_sel:[1,0,0] op_sel_hi:[1,1,1]
    v_exp_f32 v45, v45
    v_pk_fma_f32 v[50:51], v[20:21], v[74:75], v[110:111] op_sel:[1,0,0] op_sel_hi:[1,1,1]
    v_pk_fma_f32 v[168:169], v[20:21], v[168:169], v[48:49] op_sel:[0,0,0] op_sel_hi:[0,1,1]
    v_exp_f32 v46, v46
    v_pk_fma_f32 v[170:171], v[20:21], v[170:171], v[50:51] op_sel:[0,0,0] op_sel_hi:[0,1,1]
    v_permlane32_swap_b32 v60, v62
    v_exp_f32 v47, v47
    v_permlane32_swap_b32 v61, v63
    buffer_store_dwordx4 v[60:63], v2, s[8:11], s37 offen offset:1024 sc1
    v_pk_add_f32 v[40:41], v[40:41], 1.0 op_sel_hi:[1,0]
    v_pk_add_f32 v[42:43], v[42:43], 1.0 op_sel_hi:[1,0]
    v_pk_add_f32 v[44:45], v[44:45], 1.0 op_sel_hi:[1,0]
    v_pk_add_f32 v[46:47], v[46:47], 1.0 op_sel_hi:[1,0]
    v_rcp_f32 v40, v40
    v_pk_fma_f32 v[52:53], v[22:23], v[72:73], v[108:109] op_sel:[1,0,0] op_sel_hi:[1,1,1]
    v_pk_fma_f32 v[54:55], v[22:23], v[74:75], v[110:111] op_sel:[1,0,0] op_sel_hi:[1,1,1]
    v_rcp_f32 v41, v41
    v_pk_fma_f32 v[172:173], v[22:23], v[172:173], v[52:53] op_sel:[0,0,0] op_sel_hi:[0,1,1]
    v_pk_fma_f32 v[174:175], v[22:23], v[174:175], v[54:55] op_sel:[0,0,0] op_sel_hi:[0,1,1]
    v_rcp_f32 v42, v42
    v_pk_mul_f32 v[48:49], v[168:169], v[168:169]
    v_pk_mul_f32 v[50:51], v[170:171], v[170:171]
    v_rcp_f32 v43, v43
    v_pk_mul_f32 v[52:53], v[172:173], v[172:173]
    v_pk_mul_f32 v[54:55], v[174:175], v[174:175]
    v_rcp_f32 v44, v44
    v_pk_fma_f32 v[48:49], v[48:49], s[6:7], v[8:9]
    v_pk_fma_f32 v[50:51], v[50:51], s[6:7], v[8:9]
    v_rcp_f32 v45, v45
    v_pk_fma_f32 v[52:53], v[52:53], s[6:7], v[8:9]
    v_pk_fma_f32 v[54:55], v[54:55], s[6:7], v[8:9]
    v_rcp_f32 v46, v46
    v_pk_mul_f32 v[48:49], v[48:49], v[168:169]
    v_pk_mul_f32 v[50:51], v[50:51], v[170:171]
    v_rcp_f32 v47, v47
    v_pk_mul_f32 v[52:53], v[52:53], v[172:173]
    v_pk_mul_f32 v[54:55], v[54:55], v[174:175]
    v_exp_f32 v48, v48
    v_pk_mul_f32 v[40:41], v[40:41], v[160:161]
    v_pk_mul_f32 v[42:43], v[42:43], v[162:163]
    v_exp_f32 v49, v49
    v_pk_mul_f32 v[44:45], v[44:45], v[164:165]
    v_pk_mul_f32 v[46:47], v[46:47], v[166:167]
    v_exp_f32 v50, v50
    v_cvt_pk_bf16_f32 v56, v40, v41
    v_cvt_pk_bf16_f32 v57, v42, v43
    v_exp_f32 v51, v51
    v_cvt_pk_bf16_f32 v58, v44, v45
    v_cvt_pk_bf16_f32 v59, v46, v47
    v_exp_f32 v52, v52
    v_lshlrev_b32 v112, 16, v98
    v_and_b32 v113, 0xffff0000, v98
    v_exp_f32 v53, v53
    v_lshlrev_b32 v114, 16, v99
    v_and_b32 v115, 0xffff0000, v99
    v_exp_f32 v54, v54
    v_pk_fma_f32 v[32:33], v[16:17], v[76:77], v[112:113] op_sel:[1,0,0] op_sel_hi:[1,1,1]
    v_pk_fma_f32 v[34:35], v[16:17], v[78:79], v[114:115] op_sel:[1,0,0] op_sel_hi:[1,1,1]
    v_exp_f32 v55, v55
    v_permlane32_swap_b32 v56, v58
    v_permlane32_swap_b32 v57, v59
    buffer_store_dwordx4 v[56:59], v2, s[8:11], s36 offen offset:2048 sc1
    v_pk_add_f32 v[48:49], v[48:49], 1.0 op_sel_hi:[1,0]
    v_pk_add_f32 v[50:51], v[50:51], 1.0 op_sel_hi:[1,0]
    v_pk_add_f32 v[52:53], v[52:53], 1.0 op_sel_hi:[1,0]
    v_pk_add_f32 v[54:55], v[54:55], 1.0 op_sel_hi:[1,0]
    v_rcp_f32 v48, v48
    v_pk_fma_f32 v[176:177], v[16:17], v[176:177], v[32:33] op_sel:[0,0,0] op_sel_hi:[0,1,1]
    v_pk_fma_f32 v[178:179], v[16:17], v[178:179], v[34:35] op_sel:[0,0,0] op_sel_hi:[0,1,1]
    v_rcp_f32 v49, v49
    v_pk_fma_f32 v[36:37], v[18:19], v[76:77], v[112:113] op_sel:[1,0,0] op_sel_hi:[1,1,1]
    v_pk_fma_f32 v[38:39], v[18:19], v[78:79], v[114:115] op_sel:[1,0,0] op_sel_hi:[1,1,1]
    v_rcp_f32 v50, v50
    v_pk_fma_f32 v[180:181], v[18:19], v[180:181], v[36:37] op_sel:[0,0,0] op_sel_hi:[0,1,1]
    v_pk_fma_f32 v[182:183], v[18:19], v[182:183], v[38:39] op_sel:[0,0,0] op_sel_hi:[0,1,1]
    v_rcp_f32 v51, v51
    v_pk_mul_f32 v[32:33], v[176:177], v[176:177]
    v_pk_mul_f32 v[34:35], v[178:179], v[178:179]
    v_pk_mul_f32 v[36:37], v[180:181], v[180:181]
    v_rcp_f32 v52, v52
    v_pk_mul_f32 v[38:39], v[182:183], v[182:183]
    v_pk_fma_f32 v[32:33], v[32:33], s[6:7], v[8:9]
    v_rcp_f32 v53, v53
    v_pk_fma_f32 v[34:35], v[34:35], s[6:7], v[8:9]
    v_pk_fma_f32 v[36:37], v[36:37], s[6:7], v[8:9]
    v_rcp_f32 v54, v54
    v_pk_fma_f32 v[38:39], v[38:39], s[6:7], v[8:9]
    v_pk_mul_f32 v[32:33], v[32:33], v[176:177]
    v_rcp_f32 v55, v55
    v_pk_mul_f32 v[34:35], v[34:35], v[178:179]
    v_pk_mul_f32 v[36:37], v[36:37], v[180:181]
    v_pk_mul_f32 v[38:39], v[38:39], v[182:183]
    v_exp_f32 v32, v32
    v_pk_mul_f32 v[48:49], v[48:49], v[168:169]
    v_exp_f32 v33, v33
    v_pk_mul_f32 v[50:51], v[50:51], v[170:171]
    v_pk_mul_f32 v[52:53], v[52:53], v[172:173]
    v_exp_f32 v34, v34
    v_pk_mul_f32 v[54:55], v[54:55], v[174:175]
    v_cvt_pk_bf16_f32 v60, v48, v49
    v_exp_f32 v35, v35
    v_cvt_pk_bf16_f32 v61, v50, v51
    v_cvt_pk_bf16_f32 v62, v52, v53
    v_exp_f32 v36, v36
    v_cvt_pk_bf16_f32 v63, v54, v55
    v_pk_fma_f32 v[40:41], v[20:21], v[76:77], v[112:113] op_sel:[1,0,0] op_sel_hi:[1,1,1]
    v_exp_f32 v37, v37
    v_pk_fma_f32 v[42:43], v[20:21], v[78:79], v[114:115] op_sel:[1,0,0] op_sel_hi:[1,1,1]
    v_pk_fma_f32 v[184:185], v[20:21], v[184:185], v[40:41] op_sel:[0,0,0] op_sel_hi:[0,1,1]
    v_exp_f32 v38, v38
    v_pk_fma_f32 v[186:187], v[20:21], v[186:187], v[42:43] op_sel:[0,0,0] op_sel_hi:[0,1,1]
    v_permlane32_swap_b32 v60, v62
    v_exp_f32 v39, v39
    v_permlane32_swap_b32 v61, v63
    buffer_store_dwordx4 v[60:63], v2, s[8:11], s37 offen offset:2048 sc1
    v_pk_add_f32 v[32:33], v[32:33], 1.0 op_sel_hi:[1,0]
    v_pk_add_f32 v[34:35], v[34:35], 1.0 op_sel_hi:[1,0]
    v_pk_add_f32 v[36:37], v[36:37], 1.0 op_sel_hi:[1,0]
    v_pk_add_f32 v[38:39], v[38:39], 1.0 op_sel_hi:[1,0]
    v_rcp_f32 v32, v32
    v_pk_fma_f32 v[44:45], v[22:23], v[76:77], v[112:113] op_sel:[1,0,0] op_sel_hi:[1,1,1]
    v_pk_fma_f32 v[46:47], v[22:23], v[78:79], v[114:115] op_sel:[1,0,0] op_sel_hi:[1,1,1]
    v_rcp_f32 v33, v33
    v_pk_fma_f32 v[188:189], v[22:23], v[188:189], v[44:45] op_sel:[0,0,0] op_sel_hi:[0,1,1]
    v_pk_fma_f32 v[190:191], v[22:23], v[190:191], v[46:47] op_sel:[0,0,0] op_sel_hi:[0,1,1]
    v_rcp_f32 v34, v34
    v_pk_mul_f32 v[40:41], v[184:185], v[184:185]
    v_pk_mul_f32 v[42:43], v[186:187], v[186:187]
    v_rcp_f32 v35, v35
    v_pk_mul_f32 v[44:45], v[188:189], v[188:189]
    v_pk_mul_f32 v[46:47], v[190:191], v[190:191]
    v_rcp_f32 v36, v36
    v_pk_fma_f32 v[40:41], v[40:41], s[6:7], v[8:9]
    v_pk_fma_f32 v[42:43], v[42:43], s[6:7], v[8:9]
    v_rcp_f32 v37, v37
    v_pk_fma_f32 v[44:45], v[44:45], s[6:7], v[8:9]
    v_pk_fma_f32 v[46:47], v[46:47], s[6:7], v[8:9]
    v_rcp_f32 v38, v38
    v_pk_mul_f32 v[40:41], v[40:41], v[184:185]
    v_pk_mul_f32 v[42:43], v[42:43], v[186:187]
    v_rcp_f32 v39, v39
    v_pk_mul_f32 v[44:45], v[44:45], v[188:189]
    v_pk_mul_f32 v[46:47], v[46:47], v[190:191]
    v_exp_f32 v40, v40
    v_pk_mul_f32 v[32:33], v[32:33], v[176:177]
    v_pk_mul_f32 v[34:35], v[34:35], v[178:179]
    v_exp_f32 v41, v41
    v_pk_mul_f32 v[36:37], v[36:37], v[180:181]
    v_pk_mul_f32 v[38:39], v[38:39], v[182:183]
    v_exp_f32 v42, v42
    v_cvt_pk_bf16_f32 v56, v32, v33
    v_cvt_pk_bf16_f32 v57, v34, v35
    v_exp_f32 v43, v43
    v_cvt_pk_bf16_f32 v58, v36, v37
    v_cvt_pk_bf16_f32 v59, v38, v39
    v_exp_f32 v44, v44
    v_lshlrev_b32 v108, 16, v100
    v_and_b32 v109, 0xffff0000, v100
    v_exp_f32 v45, v45
    v_lshlrev_b32 v110, 16, v101
    v_and_b32 v111, 0xffff0000, v101
    v_exp_f32 v46, v46
    v_pk_fma_f32 v[48:49], v[16:17], v[80:81], v[108:109] op_sel:[1,0,0] op_sel_hi:[1,1,1]
    v_pk_fma_f32 v[50:51], v[16:17], v[82:83], v[110:111] op_sel:[1,0,0] op_sel_hi:[1,1,1]
    v_exp_f32 v47, v47
    v_permlane32_swap_b32 v56, v58
    v_permlane32_swap_b32 v57, v59
    buffer_store_dwordx4 v[56:59], v2, s[8:11], s36 offen offset:3072 sc1
    v_pk_add_f32 v[40:41], v[40:41], 1.0 op_sel_hi:[1,0]
    v_pk_add_f32 v[42:43], v[42:43], 1.0 op_sel_hi:[1,0]
    v_pk_add_f32 v[44:45], v[44:45], 1.0 op_sel_hi:[1,0]
    v_pk_add_f32 v[46:47], v[46:47], 1.0 op_sel_hi:[1,0]
    v_rcp_f32 v40, v40
    v_pk_fma_f32 v[192:193], v[16:17], v[192:193], v[48:49] op_sel:[0,0,0] op_sel_hi:[0,1,1]
    v_pk_fma_f32 v[194:195], v[16:17], v[194:195], v[50:51] op_sel:[0,0,0] op_sel_hi:[0,1,1]
    v_rcp_f32 v41, v41
    v_pk_fma_f32 v[52:53], v[18:19], v[80:81], v[108:109] op_sel:[1,0,0] op_sel_hi:[1,1,1]
    v_pk_fma_f32 v[54:55], v[18:19], v[82:83], v[110:111] op_sel:[1,0,0] op_sel_hi:[1,1,1]
    v_rcp_f32 v42, v42
    v_pk_fma_f32 v[196:197], v[18:19], v[196:197], v[52:53] op_sel:[0,0,0] op_sel_hi:[0,1,1]
    v_pk_fma_f32 v[198:199], v[18:19], v[198:199], v[54:55] op_sel:[0,0,0] op_sel_hi:[0,1,1]
    v_rcp_f32 v43, v43
    v_pk_mul_f32 v[48:49], v[192:193], v[192:193]
    v_pk_mul_f32 v[50:51], v[194:195], v[194:195]
    v_pk_mul_f32 v[52:53], v[196:197], v[196:197]
    v_rcp_f32 v44, v44
    v_pk_mul_f32 v[54:55], v[198:199], v[198:199]
    v_pk_fma_f32 v[48:49], v[48:49], s[6:7], v[8:9]
    v_rcp_f32 v45, v45
    v_pk_fma_f32 v[50:51], v[50:51], s[6:7], v[8:9]
    v_pk_fma_f32 v[52:53], v[52:53], s[6:7], v[8:9]
    v_rcp_f32 v46, v46
    v_pk_fma_f32 v[54:55], v[54:55], s[6:7], v[8:9]
    v_pk_mul_f32 v[48:49], v[48:49], v[192:193]
    v_rcp_f32 v47, v47
    v_pk_mul_f32 v[50:51], v[50:51], v[194:195]
    v_pk_mul_f32 v[52:53], v[52:53], v[196:197]
    v_pk_mul_f32 v[54:55], v[54:55], v[198:199]
    v_exp_f32 v48, v48
    v_pk_mul_f32 v[40:41], v[40:41], v[184:185]
    v_exp_f32 v49, v49
    v_pk_mul_f32 v[42:43], v[42:43], v[186:187]
    v_pk_mul_f32 v[44:45], v[44:45], v[188:189]
    v_exp_f32 v50, v50
    v_pk_mul_f32 v[46:47], v[46:47], v[190:191]
    v_cvt_pk_bf16_f32 v60, v40, v41
    v_exp_f32 v51, v51
    v_cvt_pk_bf16_f32 v61, v42, v43
    v_cvt_pk_bf16_f32 v62, v44, v45
    v_exp_f32 v52, v52
    v_cvt_pk_bf16_f32 v63, v46, v47
    v_pk_fma_f32 v[32:33], v[20:21], v[80:81], v[108:109] op_sel:[1,0,0] op_sel_hi:[1,1,1]
    v_exp_f32 v53, v53
    v_pk_fma_f32 v[34:35], v[20:21], v[82:83], v[110:111] op_sel:[1,0,0] op_sel_hi:[1,1,1]
    v_pk_fma_f32 v[200:201], v[20:21], v[200:201], v[32:33] op_sel:[0,0,0] op_sel_hi:[0,1,1]
    v_exp_f32 v54, v54
    v_pk_fma_f32 v[202:203], v[20:21], v[202:203], v[34:35] op_sel:[0,0,0] op_sel_hi:[0,1,1]
    v_permlane32_swap_b32 v60, v62
    v_exp_f32 v55, v55
    v_permlane32_swap_b32 v61, v63
    buffer_store_dwordx4 v[60:63], v2, s[8:11], s37 offen offset:3072 sc1
    v_pk_add_f32 v[48:49], v[48:49], 1.0 op_sel_hi:[1,0]
    v_pk_add_f32 v[50:51], v[50:51], 1.0 op_sel_hi:[1,0]
    v_pk_add_f32 v[52:53], v[52:53], 1.0 op_sel_hi:[1,0]
    v_pk_add_f32 v[54:55], v[54:55], 1.0 op_sel_hi:[1,0]
    v_rcp_f32 v48, v48
    v_pk_fma_f32 v[36:37], v[22:23], v[80:81], v[108:109] op_sel:[1,0,0] op_sel_hi:[1,1,1]
    v_pk_fma_f32 v[38:39], v[22:23], v[82:83], v[110:111] op_sel:[1,0,0] op_sel_hi:[1,1,1]
    v_rcp_f32 v49, v49
    v_pk_fma_f32 v[204:205], v[22:23], v[204:205], v[36:37] op_sel:[0,0,0] op_sel_hi:[0,1,1]
    v_pk_fma_f32 v[206:207], v[22:23], v[206:207], v[38:39] op_sel:[0,0,0] op_sel_hi:[0,1,1]
    v_rcp_f32 v50, v50
    v_pk_mul_f32 v[32:33], v[200:201], v[200:201]
    v_pk_mul_f32 v[34:35], v[202:203], v[202:203]
    v_rcp_f32 v51, v51
    v_pk_mul_f32 v[36:37], v[204:205], v[204:205]
    v_pk_mul_f32 v[38:39], v[206:207], v[206:207]
    v_rcp_f32 v52, v52
    v_pk_fma_f32 v[32:33], v[32:33], s[6:7], v[8:9]
    v_pk_fma_f32 v[34:35], v[34:35], s[6:7], v[8:9]
    v_rcp_f32 v53, v53
    v_pk_fma_f32 v[36:37], v[36:37], s[6:7], v[8:9]
    v_pk_fma_f32 v[38:39], v[38:39], s[6:7], v[8:9]
    v_rcp_f32 v54, v54
    v_pk_mul_f32 v[32:33], v[32:33], v[200:201]
    v_pk_mul_f32 v[34:35], v[34:35], v[202:203]
    v_rcp_f32 v55, v55
    v_pk_mul_f32 v[36:37], v[36:37], v[204:205]
    v_pk_mul_f32 v[38:39], v[38:39], v[206:207]
    v_exp_f32 v32, v32
    v_pk_mul_f32 v[48:49], v[48:49], v[192:193]
    v_pk_mul_f32 v[50:51], v[50:51], v[194:195]
    v_exp_f32 v33, v33
    v_pk_mul_f32 v[52:53], v[52:53], v[196:197]
    v_pk_mul_f32 v[54:55], v[54:55], v[198:199]
    v_exp_f32 v34, v34
    v_cvt_pk_bf16_f32 v56, v48, v49
    v_cvt_pk_bf16_f32 v57, v50, v51
    v_exp_f32 v35, v35
    v_cvt_pk_bf16_f32 v58, v52, v53
    v_cvt_pk_bf16_f32 v59, v54, v55
    v_lshlrev_b32 v112, 16, v102
    v_exp_f32 v36, v36
    v_and_b32 v113, 0xffff0000, v102
    v_lshlrev_b32 v114, 16, v103
    v_exp_f32 v37, v37
    v_and_b32 v115, 0xffff0000, v103
    v_pk_fma_f32 v[40:41], v[16:17], v[84:85], v[112:113] op_sel:[1,0,0] op_sel_hi:[1,1,1]
    v_exp_f32 v38, v38
    v_permlane32_swap_b32 v56, v58
    v_permlane32_swap_b32 v57, v59
    v_exp_f32 v39, v39
    s_add_u32 s36, s36, 4096
    s_add_u32 s37, s37, 4096
    buffer_store_dwordx4 v[56:59], v2, s[8:11], s36 offen offset:0 sc1
    v_pk_add_f32 v[32:33], v[32:33], 1.0 op_sel_hi:[1,0]
    v_pk_add_f32 v[34:35], v[34:35], 1.0 op_sel_hi:[1,0]
    v_pk_add_f32 v[36:37], v[36:37], 1.0 op_sel_hi:[1,0]
    v_pk_add_f32 v[38:39], v[38:39], 1.0 op_sel_hi:[1,0]
    v_rcp_f32 v32, v32
    v_pk_fma_f32 v[42:43], v[16:17], v[86:87], v[114:115] op_sel:[1,0,0] op_sel_hi:[1,1,1]
    v_pk_fma_f32 v[208:209], v[16:17], v[208:209], v[40:41] op_sel:[0,0,0] op_sel_hi:[0,1,1]
    v_rcp_f32 v33, v33
    v_pk_fma_f32 v[210:211], v[16:17], v[210:211], v[42:43] op_sel:[0,0,0] op_sel_hi:[0,1,1]
    v_pk_fma_f32 v[44:45], v[18:19], v[84:85], v[112:113] op_sel:[1,0,0] op_sel_hi:[1,1,1]
    v_rcp_f32 v34, v34
    v_pk_fma_f32 v[46:47], v[18:19], v[86:87], v[114:115] op_sel:[1,0,0] op_sel_hi:[1,1,1]
    v_pk_fma_f32 v[212:213], v[18:19], v[212:213], v[44:45] op_sel:[0,0,0] op_sel_hi:[0,1,1]
    v_pk_fma_f32 v[214:215], v[18:19], v[214:215], v[46:47] op_sel:[0,0,0] op_sel_hi:[0,1,1]
    v_rcp_f32 v35, v35
    v_pk_mul_f32 v[40:41], v[208:209], v[208:209]
    v_pk_mul_f32 v[42:43], v[210:211], v[210:211]
    v_rcp_f32 v36, v36
    v_pk_mul_f32 v[44:45], v[212:213], v[212:213]
    v_pk_mul_f32 v[46:47], v[214:215], v[214:215]
    v_rcp_f32 v37, v37
    v_pk_fma_f32 v[40:41], v[40:41], s[6:7], v[8:9]
    v_pk_fma_f32 v[42:43], v[42:43], s[6:7], v[8:9]
    v_pk_fma_f32 v[44:45], v[44:45], s[6:7], v[8:9]
    v_rcp_f32 v38, v38
    v_pk_fma_f32 v[46:47], v[46:47], s[6:7], v[8:9]
    v_pk_mul_f32 v[40:41], v[40:41], v[208:209]
    v_rcp_f32 v39, v39
    v_pk_mul_f32 v[42:43], v[42:43], v[210:211]
    v_pk_mul_f32 v[44:45], v[44:45], v[212:213]
    v_pk_mul_f32 v[46:47], v[46:47], v[214:215]
    v_exp_f32 v40, v40
    v_pk_mul_f32 v[32:33], v[32:33], v[200:201]
    v_exp_f32 v41, v41
    v_pk_mul_f32 v[34:35], v[34:35], v[202:203]
    v_pk_mul_f32 v[36:37], v[36:37], v[204:205]
    v_exp_f32 v42, v42
    v_pk_mul_f32 v[38:39], v[38:39], v[206:207]
    v_cvt_pk_bf16_f32 v60, v32, v33
    v_exp_f32 v43, v43
    v_cvt_pk_bf16_f32 v61, v34, v35
    v_cvt_pk_bf16_f32 v62, v36, v37
    v_exp_f32 v44, v44
    v_cvt_pk_bf16_f32 v63, v38, v39
    v_pk_fma_f32 v[48:49], v[20:21], v[84:85], v[112:113] op_sel:[1,0,0] op_sel_hi:[1,1,1]
    v_exp_f32 v45, v45
    v_pk_fma_f32 v[50:51], v[20:21], v[86:87], v[114:115] op_sel:[1,0,0] op_sel_hi:[1,1,1]
    v_pk_fma_f32 v[216:217], v[20:21], v[216:217], v[48:49] op_sel:[0,0,0] op_sel_hi:[0,1,1]
    v_exp_f32 v46, v46
    v_pk_fma_f32 v[218:219], v[20:21], v[218:219], v[50:51] op_sel:[0,0,0] op_sel_hi:[0,1,1]
    v_permlane32_swap_b32 v60, v62
    v_exp_f32 v47, v47
    v_permlane32_swap_b32 v61, v63
    buffer_store_dwordx4 v[60:63], v2, s[8:11], s37 offen offset:0 sc1
    v_pk_add_f32 v[40:41], v[40:41], 1.0 op_sel_hi:[1,0]
    v_pk_add_f32 v[42:43], v[42:43], 1.0 op_sel_hi:[1,0]
    v_pk_add_f32 v[44:45], v[44:45], 1.0 op_sel_hi:[1,0]
    v_pk_add_f32 v[46:47], v[46:47], 1.0 op_sel_hi:[1,0]
    v_rcp_f32 v40, v40
    v_pk_fma_f32 v[52:53], v[22:23], v[84:85], v[112:113] op_sel:[1,0,0] op_sel_hi:[1,1,1]
    v_pk_fma_f32 v[54:55], v[22:23], v[86:87], v[114:115] op_sel:[1,0,0] op_sel_hi:[1,1,1]
    v_rcp_f32 v41, v41
    v_pk_fma_f32 v[220:221], v[22:23], v[220:221], v[52:53] op_sel:[0,0,0] op_sel_hi:[0,1,1]
    v_pk_fma_f32 v[222:223], v[22:23], v[222:223], v[54:55] op_sel:[0,0,0] op_sel_hi:[0,1,1]
    v_rcp_f32 v42, v42
    v_pk_mul_f32 v[48:49], v[216:217], v[216:217]
    v_pk_mul_f32 v[50:51], v[218:219], v[218:219]
    v_rcp_f32 v43, v43
    v_pk_mul_f32 v[52:53], v[220:221], v[220:221]
    v_pk_mul_f32 v[54:55], v[222:223], v[222:223]
    v_rcp_f32 v44, v44
    v_pk_fma_f32 v[48:49], v[48:49], s[6:7], v[8:9]
    v_pk_fma_f32 v[50:51], v[50:51], s[6:7], v[8:9]
    v_rcp_f32 v45, v45
    v_pk_fma_f32 v[52:53], v[52:53], s[6:7], v[8:9]
    v_pk_fma_f32 v[54:55], v[54:55], s[6:7], v[8:9]
    v_rcp_f32 v46, v46
    v_pk_mul_f32 v[48:49], v[48:49], v[216:217]
    v_pk_mul_f32 v[50:51], v[50:51], v[218:219]
    v_rcp_f32 v47, v47
    v_pk_mul_f32 v[52:53], v[52:53], v[220:221]
    v_pk_mul_f32 v[54:55], v[54:55], v[222:223]
    v_exp_f32 v48, v48
    v_pk_mul_f32 v[40:41], v[40:41], v[208:209]
    v_pk_mul_f32 v[42:43], v[42:43], v[210:211]
    v_exp_f32 v49, v49
    v_pk_mul_f32 v[44:45], v[44:45], v[212:213]
    v_pk_mul_f32 v[46:47], v[46:47], v[214:215]
    v_exp_f32 v50, v50
    v_cvt_pk_bf16_f32 v56, v40, v41
    v_cvt_pk_bf16_f32 v57, v42, v43
    v_exp_f32 v51, v51
    v_cvt_pk_bf16_f32 v58, v44, v45
    v_cvt_pk_bf16_f32 v59, v46, v47
    v_exp_f32 v52, v52
    v_lshlrev_b32 v108, 16, v104
    v_and_b32 v109, 0xffff0000, v104
    v_exp_f32 v53, v53
    v_lshlrev_b32 v110, 16, v105
    v_and_b32 v111, 0xffff0000, v105
    v_exp_f32 v54, v54
    v_pk_fma_f32 v[32:33], v[16:17], v[88:89], v[108:109] op_sel:[1,0,0] op_sel_hi:[1,1,1]
    v_pk_fma_f32 v[34:35], v[16:17], v[90:91], v[110:111] op_sel:[1,0,0] op_sel_hi:[1,1,1]
    v_exp_f32 v55, v55
    v_permlane32_swap_b32 v56, v58
    v_permlane32_swap_b32 v57, v59
    buffer_store_dwordx4 v[56:59], v2, s[8:11], s36 offen offset:1024 sc1
    v_pk_add_f32 v[48:49], v[48:49], 1.0 op_sel_hi:[1,0]
    v_pk_add_f32 v[50:51], v[50:51], 1.0 op_sel_hi:[1,0]
    v_pk_add_f32 v[52:53], v[52:53], 1.0 op_sel_hi:[1,0]
    v_pk_add_f32 v[54:55], v[54:55], 1.0 op_sel_hi:[1,0]
    v_rcp_f32 v48, v48
    v_pk_fma_f32 v[224:225], v[16:17], v[224:225], v[32:33] op_sel:[0,0,0] op_sel_hi:[0,1,1]
    v_pk_fma_f32 v[226:227], v[16:17], v[226:227], v[34:35] op_sel:[0,0,0] op_sel_hi:[0,1,1]
    v_rcp_f32 v49, v49
    v_pk_fma_f32 v[36:37], v[18:19], v[88:89], v[108:109] op_sel:[1,0,0] op_sel_hi:[1,1,1]
    v_pk_fma_f32 v[38:39], v[18:19], v[90:91], v[110:111] op_sel:[1,0,0] op_sel_hi:[1,1,1]
    v_rcp_f32 v50, v50
    v_pk_fma_f32 v[228:229], v[18:19], v[228:229], v[36:37] op_sel:[0,0,0] op_sel_hi:[0,1,1]
    v_pk_fma_f32 v[230:231], v[18:19], v[230:231], v[38:39] op_sel:[0,0,0] op_sel_hi:[0,1,1]
    v_rcp_f32 v51, v51
    v_pk_mul_f32 v[32:33], v[224:225], v[224:225]
    v_pk_mul_f32 v[34:35], v[226:227], v[226:227]
    v_pk_mul_f32 v[36:37], v[228:229], v[228:229]
    v_rcp_f32 v52, v52
    v_pk_mul_f32 v[38:39], v[230:231], v[230:231]
    v_pk_fma_f32 v[32:33], v[32:33], s[6:7], v[8:9]
    v_rcp_f32 v53, v53
    v_pk_fma_f32 v[34:35], v[34:35], s[6:7], v[8:9]
    v_pk_fma_f32 v[36:37], v[36:37], s[6:7], v[8:9]
    v_rcp_f32 v54, v54
    v_pk_fma_f32 v[38:39], v[38:39], s[6:7], v[8:9]
    v_pk_mul_f32 v[32:33], v[32:33], v[224:225]
    v_rcp_f32 v55, v55
    v_pk_mul_f32 v[34:35], v[34:35], v[226:227]
    v_pk_mul_f32 v[36:37], v[36:37], v[228:229]
    v_pk_mul_f32 v[38:39], v[38:39], v[230:231]
    v_exp_f32 v32, v32
    v_pk_mul_f32 v[48:49], v[48:49], v[216:217]
    v_exp_f32 v33, v33
    v_pk_mul_f32 v[50:51], v[50:51], v[218:219]
    v_pk_mul_f32 v[52:53], v[52:53], v[220:221]
    v_exp_f32 v34, v34
    v_pk_mul_f32 v[54:55], v[54:55], v[222:223]
    v_cvt_pk_bf16_f32 v60, v48, v49
    v_exp_f32 v35, v35
    v_cvt_pk_bf16_f32 v61, v50, v51
    v_cvt_pk_bf16_f32 v62, v52, v53
    v_exp_f32 v36, v36
    v_cvt_pk_bf16_f32 v63, v54, v55
    v_pk_fma_f32 v[40:41], v[20:21], v[88:89], v[108:109] op_sel:[1,0,0] op_sel_hi:[1,1,1]
    v_exp_f32 v37, v37
    v_pk_fma_f32 v[42:43], v[20:21], v[90:91], v[110:111] op_sel:[1,0,0] op_sel_hi:[1,1,1]
    v_pk_fma_f32 v[232:233], v[20:21], v[232:233], v[40:41] op_sel:[0,0,0] op_sel_hi:[0,1,1]
    v_exp_f32 v38, v38
    v_pk_fma_f32 v[234:235], v[20:21], v[234:235], v[42:43] op_sel:[0,0,0] op_sel_hi:[0,1,1]
    v_permlane32_swap_b32 v60, v62
    v_exp_f32 v39, v39
    v_permlane32_swap_b32 v61, v63
    buffer_store_dwordx4 v[60:63], v2, s[8:11], s37 offen offset:1024 sc1
    v_pk_add_f32 v[32:33], v[32:33], 1.0 op_sel_hi:[1,0]
    v_pk_add_f32 v[34:35], v[34:35], 1.0 op_sel_hi:[1,0]
    v_pk_add_f32 v[36:37], v[36:37], 1.0 op_sel_hi:[1,0]
    v_pk_add_f32 v[38:39], v[38:39], 1.0 op_sel_hi:[1,0]
    v_rcp_f32 v32, v32
    v_pk_fma_f32 v[44:45], v[22:23], v[88:89], v[108:109] op_sel:[1,0,0] op_sel_hi:[1,1,1]
    v_pk_fma_f32 v[46:47], v[22:23], v[90:91], v[110:111] op_sel:[1,0,0] op_sel_hi:[1,1,1]
    v_rcp_f32 v33, v33
    v_pk_fma_f32 v[236:237], v[22:23], v[236:237], v[44:45] op_sel:[0,0,0] op_sel_hi:[0,1,1]
    v_pk_fma_f32 v[238:239], v[22:23], v[238:239], v[46:47] op_sel:[0,0,0] op_sel_hi:[0,1,1]
    v_rcp_f32 v34, v34
    v_pk_mul_f32 v[40:41], v[232:233], v[232:233]
    v_pk_mul_f32 v[42:43], v[234:235], v[234:235]
    v_rcp_f32 v35, v35
    v_pk_mul_f32 v[44:45], v[236:237], v[236:237]
    v_pk_mul_f32 v[46:47], v[238:239], v[238:239]
    v_rcp_f32 v36, v36
    v_pk_fma_f32 v[40:41], v[40:41], s[6:7], v[8:9]
    v_pk_fma_f32 v[42:43], v[42:43], s[6:7], v[8:9]
    v_rcp_f32 v37, v37
    v_pk_fma_f32 v[44:45], v[44:45], s[6:7], v[8:9]
    v_pk_fma_f32 v[46:47], v[46:47], s[6:7], v[8:9]
    v_rcp_f32 v38, v38
    v_pk_mul_f32 v[40:41], v[40:41], v[232:233]
    v_pk_mul_f32 v[42:43], v[42:43], v[234:235]
    v_rcp_f32 v39, v39
    v_pk_mul_f32 v[44:45], v[44:45], v[236:237]
    v_pk_mul_f32 v[46:47], v[46:47], v[238:239]
    v_mov_b32 v14, 163072
    v_mov_b32 v15, 1
    s_mov_b64 exec, 1
    ds_add_u32 v14, v15
    s_mov_b64 exec, -1
    v_exp_f32 v40, v40
    v_pk_mul_f32 v[32:33], v[32:33], v[224:225]
    v_exp_f32 v41, v41
    v_pk_mul_f32 v[34:35], v[34:35], v[226:227]
    v_pk_mul_f32 v[36:37], v[36:37], v[228:229]
    v_exp_f32 v42, v42
    v_pk_mul_f32 v[38:39], v[38:39], v[230:231]
    v_exp_f32 v43, v43
    v_cvt_pk_bf16_f32 v56, v32, v33
    v_cvt_pk_bf16_f32 v57, v34, v35
    v_exp_f32 v44, v44
    v_cvt_pk_bf16_f32 v58, v36, v37
    v_exp_f32 v45, v45
    v_cvt_pk_bf16_f32 v59, v38, v39
    s_nop 1
    v_exp_f32 v46, v46
    v_permlane32_swap_b32 v56, v58
    v_exp_f32 v47, v47
    v_permlane32_swap_b32 v57, v59
    buffer_store_dwordx4 v[56:59], v2, s[8:11], s36 offen offset:2048 sc1
    v_pk_add_f32 v[40:41], v[40:41], 1.0 op_sel_hi:[1,0]
    v_pk_add_f32 v[42:43], v[42:43], 1.0 op_sel_hi:[1,0]
    v_pk_add_f32 v[44:45], v[44:45], 1.0 op_sel_hi:[1,0]
    v_pk_add_f32 v[46:47], v[46:47], 1.0 op_sel_hi:[1,0]
    v_rcp_f32 v40, v40
    v_rcp_f32 v41, v41
    v_rcp_f32 v42, v42
    v_rcp_f32 v43, v43
    v_rcp_f32 v44, v44
    v_rcp_f32 v45, v45
    v_rcp_f32 v46, v46
    v_rcp_f32 v47, v47
    s_nop 0
    v_pk_mul_f32 v[40:41], v[40:41], v[232:233]
    v_pk_mul_f32 v[42:43], v[42:43], v[234:235]
    v_pk_mul_f32 v[44:45], v[44:45], v[236:237]
    v_pk_mul_f32 v[46:47], v[46:47], v[238:239]
    v_cvt_pk_bf16_f32 v60, v40, v41
    v_cvt_pk_bf16_f32 v61, v42, v43
    v_cvt_pk_bf16_f32 v62, v44, v45
    v_cvt_pk_bf16_f32 v63, v46, v47
    s_nop 1
    v_permlane32_swap_b32 v60, v62
    v_permlane32_swap_b32 v61, v63
    buffer_store_dwordx4 v[60:63], v2, s[8:11], s37 offen offset:2048 sc1
    s_lshl_b32 s3, s26, 2
    s_add_u32 s3, s3, s62
    s_lshl_b32 s3, s3, 5
    s_add_u32 s3, s3, s27
    s_lshl_b32 s3, s3, 7
    s_add_u32 s39, s3, 51642368
    s_waitcnt vmcnt(0)
    v_mov_b32 v14, s25
    v_mov_b32 v15, 0
    s_mov_b64 exec, 1
    buffer_store_dword v14, v15, s[8:11], s39 offen sc1
    s_mov_b64 exec, -1
    s_setprio 0
    s_and_b32 s3, s2, 7
    s_lshr_b32 s5, s2, 3
    s_lshr_b32 s36, s3, 1
    s_lshl_b32 s36, s36, 2
    s_and_b32 s4, s5, 3
    s_add_u32 s36, s36, s4
    s_and_b32 s37, s3, 1
    s_lshl_b32 s37, s37, 3
    s_lshr_b32 s4, s5, 2
    s_add_u32 s37, s37, s4
    s_mul_i32 s38, s36, 1179648
    s_mov_b32 s4, s62
    s_lshl_b32 s4, s4, 11
    s_add_u32 s38, s38, s4
    s_add_u32 s38, s38, 16777216
    s_add_u32 s28, s38, 65536
    s_mul_i32 s29, s37, 589824
    s_lshl_b32 s4, s62, 12
    s_add_u32 s29, s29, s4
    s_add_u32 s29, s29, 67108864
    v_lshrrev_b32 v4, 4, v0
    v_lshlrev_b32 v4, 9, v4
    v_and_b32 v5, 15, v0
    v_lshl_add_u32 v4, v5, 4, v4
    v_add_u32 v5, 294912, v4
    v_add_u32 v6, 589824, v4
    v_add_u32 v7, 884736, v4
    v_lshlrev_b32 v12, 7, v0
    s_lshl_b32 s33, s36, 13
    v_mov_b32 v128, 0
    v_mov_b32 v129, 0
    v_mov_b32 v130, 0
    v_mov_b32 v131, 0
    v_mov_b32 v132, 0
    v_mov_b32 v133, 0
    v_mov_b32 v134, 0
    v_mov_b32 v135, 0
    v_mov_b32 v136, 0
    v_mov_b32 v137, 0
    v_mov_b32 v138, 0
    v_mov_b32 v139, 0
    v_mov_b32 v140, 0
    v_mov_b32 v141, 0
    v_mov_b32 v142, 0
    v_mov_b32 v143, 0
    v_mov_b32 v144, 0
    v_mov_b32 v145, 0
    v_mov_b32 v146, 0
    v_mov_b32 v147, 0
    v_mov_b32 v148, 0
    v_mov_b32 v149, 0
    v_mov_b32 v150, 0
    v_mov_b32 v151, 0
    v_mov_b32 v152, 0
    v_mov_b32 v153, 0
    v_mov_b32 v154, 0
    v_mov_b32 v155, 0
    v_mov_b32 v156, 0
    v_mov_b32 v157, 0
    v_mov_b32 v158, 0
    v_mov_b32 v159, 0
    v_mov_b32 v160, 0
    v_mov_b32 v161, 0
    v_mov_b32 v162, 0
    v_mov_b32 v163, 0
    v_mov_b32 v164, 0
    v_mov_b32 v165, 0
    v_mov_b32 v166, 0
    v_mov_b32 v167, 0
    v_mov_b32 v168, 0
    v_mov_b32 v169, 0
    v_mov_b32 v170, 0
    v_mov_b32 v171, 0
    v_mov_b32 v172, 0
    v_mov_b32 v173, 0
    v_mov_b32 v174, 0
    v_mov_b32 v175, 0
    v_mov_b32 v176, 0
    v_mov_b32 v177, 0
    v_mov_b32 v178, 0
    v_mov_b32 v179, 0
    v_mov_b32 v180, 0
    v_mov_b32 v181, 0
    v_mov_b32 v182, 0
    v_mov_b32 v183, 0
    v_mov_b32 v184, 0
    v_mov_b32 v185, 0
    v_mov_b32 v186, 0
    v_mov_b32 v187, 0
    v_mov_b32 v188, 0
    v_mov_b32 v189, 0
    v_mov_b32 v190, 0
    v_mov_b32 v191, 0
    v_mov_b32 v192, 0
    v_mov_b32 v193, 0
    v_mov_b32 v194, 0
    v_mov_b32 v195, 0
    v_mov_b32 v196, 0
    v_mov_b32 v197, 0
    v_mov_b32 v198, 0
    v_mov_b32 v199, 0
    v_mov_b32 v200, 0
    v_mov_b32 v201, 0
    v_mov_b32 v202, 0
    v_mov_b32 v203, 0
    v_mov_b32 v204, 0
    v_mov_b32 v205, 0
    v_mov_b32 v206, 0
    v_mov_b32 v207, 0
    v_mov_b32 v208, 0
    v_mov_b32 v209, 0
    v_mov_b32 v210, 0
    v_mov_b32 v211, 0
    v_mov_b32 v212, 0
    v_mov_b32 v213, 0
    v_mov_b32 v214, 0
    v_mov_b32 v215, 0
    v_mov_b32 v216, 0
    v_mov_b32 v217, 0
    v_mov_b32 v218, 0
    v_mov_b32 v219, 0
    v_mov_b32 v220, 0
    v_mov_b32 v221, 0
    v_mov_b32 v222, 0
    v_mov_b32 v223, 0
    v_mov_b32 v224, 0
    v_mov_b32 v225, 0
    v_mov_b32 v226, 0
    v_mov_b32 v227, 0
    v_mov_b32 v228, 0
    v_mov_b32 v229, 0
    v_mov_b32 v230, 0
    v_mov_b32 v231, 0
    v_mov_b32 v232, 0
    v_mov_b32 v233, 0
    v_mov_b32 v234, 0
    v_mov_b32 v235, 0
    v_mov_b32 v236, 0
    v_mov_b32 v237, 0
    v_mov_b32 v238, 0
    v_mov_b32 v239, 0
    v_mov_b32 v240, 0
    v_mov_b32 v241, 0
    v_mov_b32 v242, 0
    v_mov_b32 v243, 0
    v_mov_b32 v244, 0
    v_mov_b32 v245, 0
    v_mov_b32 v246, 0
    v_mov_b32 v247, 0
    v_mov_b32 v248, 0
    v_mov_b32 v249, 0
    v_mov_b32 v250, 0
    v_mov_b32 v251, 0
    v_mov_b32 v252, 0
    v_mov_b32 v253, 0
    v_mov_b32 v254, 0
    v_mov_b32 v255, 0
    v_mov_b32 v14, 163072
    s_cmp_lg_u32 s62, 0
    s_cbranch_scc1 mk_hw
    s_add_u32 s3, s33, 51642368
    s_mov_b32 s4, 200000
mk_poll2:
    buffer_load_dword v13, v12, s[8:11], s3 offen sc1
    s_waitcnt vmcnt(0)
    v_cmp_ne_u32 vcc, s25, v13
    s_cbranch_vccz mk_polld2
    s_sleep 4
    s_sub_u32 s4, s4, 1
    s_cmp_lg_u32 s4, 0
    s_cbranch_scc1 mk_poll2
mk_polld2:
    s_mov_b32 s4, 200000
    s_mov_b32 s3, 50339840
mk_pollw:
    buffer_load_dwordx4 v[16:19], v3, s[8:11], s3 offen sc1
    v_mov_b32 v13, s25
    s_waitcnt vmcnt(0)
    v_xor_b32 v16, v13, v16
    v_xor_b32 v17, v13, v17
    v_xor_b32 v18, v13, v18
    v_xor_b32 v19, v13, v19
    v_or3_b32 v16, v16, v17, v18
    v_or_b32 v16, v16, v19
    v_cmp_ne_u32 vcc, 0, v16
    s_cbranch_vccz mk_pollwd
    s_sleep 2
    s_sub_u32 s4, s4, 1
    s_cmp_lg_u32 s4, 0
    s_cbranch_scc1 mk_pollw
mk_pollwd:
    v_mov_b32 v13, 64
    ds_write_b32 v14, v13 offset:4
    s_branch mk_hwd
mk_hw:
    s_mov_b32 s4, 800000
mk_hw1:
    ds_read_b32 v13, v14 offset:4
    s_waitcnt lgkmcnt(0)
    v_cmp_ne_u32 vcc, 64, v13
    s_cbranch_vccz mk_hwd
    s_sleep 4
    s_sub_u32 s4, s4, 1
    s_cmp_lg_u32 s4, 0
    s_cbranch_scc1 mk_hw1
mk_hwd:
    buffer_load_dwordx4 v[16:19], v3, s[8:11], s29 offen offset:0 sc1
    buffer_load_dwordx4 v[20:23], v3, s[8:11], s29 offen offset:1024 sc1
    buffer_load_dwordx4 v[24:27], v3, s[8:11], s29 offen offset:2048 sc1
    buffer_load_dwordx4 v[28:31], v3, s[8:11], s29 offen offset:3072 sc1
    s_add_u32 s29, s29, 16384
    buffer_load_dwordx4 v[64:67], v4, s[8:11], s28 offen offset:0 sc1
    buffer_load_dwordx4 v[68:71], v4, s[8:11], s28 offen offset:256 sc1
    buffer_load_dwordx4 v[72:75], v5, s[8:11], s28 offen offset:0 sc1
    buffer_load_dwordx4 v[76:79], v5, s[8:11], s28 offen offset:256 sc1
    buffer_load_dwordx4 v[80:83], v6, s[8:11], s28 offen offset:0 sc1
    buffer_load_dwordx4 v[84:87], v6, s[8:11], s28 offen offset:256 sc1
    buffer_load_dwordx4 v[88:91], v7, s[8:11], s28 offen offset:0 sc1
    buffer_load_dwordx4 v[92:95], v7, s[8:11], s28 offen offset:256 sc1
    s_add_u32 s28, s28, 8192
    buffer_load_dwordx4 v[32:35], v3, s[8:11], s29 offen offset:0 sc1
    buffer_load_dwordx4 v[36:39], v3, s[8:11], s29 offen offset:1024 sc1
    buffer_load_dwordx4 v[40:43], v3, s[8:11], s29 offen offset:2048 sc1
    buffer_load_dwordx4 v[44:47], v3, s[8:11], s29 offen offset:3072 sc1
    s_add_u32 s29, s29, 16384
    buffer_load_dwordx4 v[96:99], v4, s[8:11], s28 offen offset:0 sc1
    buffer_load_dwordx4 v[100:103], v4, s[8:11], s28 offen offset:256 sc1
    buffer_load_dwordx4 v[104:107], v5, s[8:11], s28 offen offset:0 sc1
    buffer_load_dwordx4 v[108:111], v5, s[8:11], s28 offen offset:256 sc1
    buffer_load_dwordx4 v[112:115], v6, s[8:11], s28 offen offset:0 sc1
    buffer_load_dwordx4 v[116:119], v6, s[8:11], s28 offen offset:256 sc1
    buffer_load_dwordx4 v[120:123], v7, s[8:11], s28 offen offset:0 sc1
    buffer_load_dwordx4 v[124:127], v7, s[8:11], s28 offen offset:256 sc1
    s_add_u32 s28, s28, 8192
    s_mov_b32 s34, 0
    s_waitcnt vmcnt(0)
    .p2align 6
mk_gloop:
    s_waitcnt vmcnt(21)
    v_mfma_f32_16x16x32_bf16 v[128:131], v[16:19], v[64:67], v[128:131]
    buffer_load_dwordx4 v[48:51], v3, s[8:11], s29 offen offset:0 sc1
    v_mfma_f32_16x16x32_bf16 v[132:135], v[20:23], v[64:67], v[132:135]
    s_waitcnt vmcnt(21)
    v_mfma_f32_16x16x32_bf16 v[136:139], v[24:27], v[64:67], v[136:139]
    buffer_load_dwordx4 v[52:55], v3, s[8:11], s29 offen offset:1024 sc1
    s_waitcnt vmcnt(21)
    v_mfma_f32_16x16x32_bf16 v[140:143], v[28:31], v[64:67], v[140:143]
    buffer_load_dwordx4 v[64:67], v4, s[8:11], s28 offen offset:0 sc1
    s_waitcnt vmcnt(21)
    v_mfma_f32_16x16x32_bf16 v[144:147], v[16:19], v[68:71], v[144:147]
    buffer_load_dwordx4 v[56:59], v3, s[8:11], s29 offen offset:2048 sc1
    v_mfma_f32_16x16x32_bf16 v[148:151], v[20:23], v[68:71], v[148:151]
    v_mfma_f32_16x16x32_bf16 v[152:155], v[24:27], v[68:71], v[152:155]
    buffer_load_dwordx4 v[60:63], v3, s[8:11], s29 offen offset:3072 sc1
    s_add_u32 s29, s29, 16384
    v_mfma_f32_16x16x32_bf16 v[156:159], v[28:31], v[68:71], v[156:159]
    buffer_load_dwordx4 v[68:71], v4, s[8:11], s28 offen offset:256 sc1
    s_waitcnt vmcnt(23)
    v_mfma_f32_16x16x32_bf16 v[160:163], v[16:19], v[72:75], v[160:163]
    v_mfma_f32_16x16x32_bf16 v[164:167], v[20:23], v[72:75], v[164:167]
    v_mfma_f32_16x16x32_bf16 v[168:171], v[24:27], v[72:75], v[168:171]
    v_mfma_f32_16x16x32_bf16 v[172:175], v[28:31], v[72:75], v[172:175]
    buffer_load_dwordx4 v[72:75], v5, s[8:11], s28 offen offset:0 sc1
    s_waitcnt vmcnt(23)
    v_mfma_f32_16x16x32_bf16 v[176:179], v[16:19], v[76:79], v[176:179]
    v_mfma_f32_16x16x32_bf16 v[180:183], v[20:23], v[76:79], v[180:183]
    v_mfma_f32_16x16x32_bf16 v[184:187], v[24:27], v[76:79], v[184:187]
    v_mfma_f32_16x16x32_bf16 v[188:191], v[28:31], v[76:79], v[188:191]
    buffer_load_dwordx4 v[76:79], v5, s[8:11], s28 offen offset:256 sc1
    s_waitcnt vmcnt(23)
    v_mfma_f32_16x16x32_bf16 v[192:195], v[16:19], v[80:83], v[192:195]
    v_mfma_f32_16x16x32_bf16 v[196:199], v[20:23], v[80:83], v[196:199]
    v_mfma_f32_16x16x32_bf16 v[200:203], v[24:27], v[80:83], v[200:203]
    v_mfma_f32_16x16x32_bf16 v[204:207], v[28:31], v[80:83], v[204:207]
    buffer_load_dwordx4 v[80:83], v6, s[8:11], s28 offen offset:0 sc1
    s_waitcnt vmcnt(23)
    v_mfma_f32_16x16x32_bf16 v[208:211], v[16:19], v[84:87], v[208:211]
    v_mfma_f32_16x16x32_bf16 v[212:215], v[20:23], v[84:87], v[212:215]
    v_mfma_f32_16x16x32_bf16 v[216:219], v[24:27], v[84:87], v[216:219]
    v_mfma_f32_16x16x32_bf16 v[220:223], v[28:31], v[84:87], v[220:223]
    buffer_load_dwordx4 v[84:87], v6, s[8:11], s28 offen offset:256 sc1
    s_waitcnt vmcnt(23)
    v_mfma_f32_16x16x32_bf16 v[224:227], v[16:19], v[88:91], v[224:227]
    v_mfma_f32_16x16x32_bf16 v[228:231], v[20:23], v[88:91], v[228:231]
    v_mfma_f32_16x16x32_bf16 v[232:235], v[24:27], v[88:91], v[232:235]
    v_mfma_f32_16x16x32_bf16 v[236:239], v[28:31], v[88:91], v[236:239]
    buffer_load_dwordx4 v[88:91], v7, s[8:11], s28 offen offset:0 sc1
    s_waitcnt vmcnt(23)
    v_mfma_f32_16x16x32_bf16 v[240:243], v[16:19], v[92:95], v[240:243]
    v_mfma_f32_16x16x32_bf16 v[244:247], v[20:23], v[92:95], v[244:247]
    v_mfma_f32_16x16x32_bf16 v[248:251], v[24:27], v[92:95], v[248:251]
    v_mfma_f32_16x16x32_bf16 v[252:255], v[28:31], v[92:95], v[252:255]
    buffer_load_dwordx4 v[92:95], v7, s[8:11], s28 offen offset:256 sc1
    s_add_u32 s28, s28, 8192
    s_waitcnt vmcnt(21)
    v_mfma_f32_16x16x32_bf16 v[128:131], v[32:35], v[96:99], v[128:131]
    buffer_load_dwordx4 v[16:19], v3, s[8:11], s29 offen offset:0 sc1
    v_mfma_f32_16x16x32_bf16 v[132:135], v[36:39], v[96:99], v[132:135]
    s_waitcnt vmcnt(21)
    v_mfma_f32_16x16x32_bf16 v[136:139], v[40:43], v[96:99], v[136:139]
    buffer_load_dwordx4 v[20:23], v3, s[8:11], s29 offen offset:1024 sc1
    s_waitcnt vmcnt(21)
    v_mfma_f32_16x16x32_bf16 v[140:143], v[44:47], v[96:99], v[140:143]
    buffer_load_dwordx4 v[96:99], v4, s[8:11], s28 offen offset:0 sc1
    s_waitcnt vmcnt(21)
    v_mfma_f32_16x16x32_bf16 v[144:147], v[32:35], v[100:103], v[144:147]
    buffer_load_dwordx4 v[24:27], v3, s[8:11], s29 offen offset:2048 sc1
    v_mfma_f32_16x16x32_bf16 v[148:151], v[36:39], v[100:103], v[148:151]
    v_mfma_f32_16x16x32_bf16 v[152:155], v[40:43], v[100:103], v[152:155]
    buffer_load_dwordx4 v[28:31], v3, s[8:11], s29 offen offset:3072 sc1
    s_add_u32 s29, s29, 16384
    v_mfma_f32_16x16x32_bf16 v[156:159], v[44:47], v[100:103], v[156:159]
    buffer_load_dwordx4 v[100:103], v4, s[8:11], s28 offen offset:256 sc1
    s_waitcnt vmcnt(23)
    v_mfma_f32_16x16x32_bf16 v[160:163], v[32:35], v[104:107], v[160:163]
    v_mfma_f32_16x16x32_bf16 v[164:167], v[36:39], v[104:107], v[164:167]
    v_mfma_f32_16x16x32_bf16 v[168:171], v[40:43], v[104:107], v[168:171]
    v_mfma_f32_16x16x32_bf16 v[172:175], v[44:47], v[104:107], v[172:175]
    buffer_load_dwordx4 v[104:107], v5, s[8:11], s28 offen offset:0 sc1
    s_waitcnt vmcnt(23)
    v_mfma_f32_16x16x32_bf16 v[176:179], v[32:35], v[108:111], v[176:179]
    v_mfma_f32_16x16x32_bf16 v[180:183], v[36:39], v[108:111], v[180:183]
    v_mfma_f32_16x16x32_bf16 v[184:187], v[40:43], v[108:111], v[184:187]
    v_mfma_f32_16x16x32_bf16 v[188:191], v[44:47], v[108:111], v[188:191]
    buffer_load_dwordx4 v[108:111], v5, s[8:11], s28 offen offset:256 sc1
    s_waitcnt vmcnt(23)
    v_mfma_f32_16x16x32_bf16 v[192:195], v[32:35], v[112:115], v[192:195]
    v_mfma_f32_16x16x32_bf16 v[196:199], v[36:39], v[112:115], v[196:199]
    v_mfma_f32_16x16x32_bf16 v[200:203], v[40:43], v[112:115], v[200:203]
    v_mfma_f32_16x16x32_bf16 v[204:207], v[44:47], v[112:115], v[204:207]
    buffer_load_dwordx4 v[112:115], v6, s[8:11], s28 offen offset:0 sc1
    s_waitcnt vmcnt(23)
    v_mfma_f32_16x16x32_bf16 v[208:211], v[32:35], v[116:119], v[208:211]
    v_mfma_f32_16x16x32_bf16 v[212:215], v[36:39], v[116:119], v[212:215]
    v_mfma_f32_16x16x32_bf16 v[216:219], v[40:43], v[116:119], v[216:219]
    v_mfma_f32_16x16x32_bf16 v[220:223], v[44:47], v[116:119], v[220:223]
    buffer_load_dwordx4 v[116:119], v6, s[8:11], s28 offen offset:256 sc1
    s_waitcnt vmcnt(23)
    v_mfma_f32_16x16x32_bf16 v[224:227], v[32:35], v[120:123], v[224:227]
    v_mfma_f32_16x16x32_bf16 v[228:231], v[36:39], v[120:123], v[228:231]
    v_mfma_f32_16x16x32_bf16 v[232:235], v[40:43], v[120:123], v[232:235]
    v_mfma_f32_16x16x32_bf16 v[236:239], v[44:47], v[120:123], v[236:239]
    buffer_load_dwordx4 v[120:123], v7, s[8:11], s28 offen offset:0 sc1
    s_waitcnt vmcnt(23)
    v_mfma_f32_16x16x32_bf16 v[240:243], v[32:35], v[124:127], v[240:243]
    v_mfma_f32_16x16x32_bf16 v[244:247], v[36:39], v[124:127], v[244:247]
    v_mfma_f32_16x16x32_bf16 v[248:251], v[40:43], v[124:127], v[248:251]
    v_mfma_f32_16x16x32_bf16 v[252:255], v[44:47], v[124:127], v[252:255]
    buffer_load_dwordx4 v[124:127], v7, s[8:11], s28 offen offset:256 sc1
    s_add_u32 s28, s28, 8192
    s_waitcnt vmcnt(21)
    v_mfma_f32_16x16x32_bf16 v[128:131], v[48:51], v[64:67], v[128:131]
    buffer_load_dwordx4 v[32:35], v3, s[8:11], s29 offen offset:0 sc1
    v_mfma_f32_16x16x32_bf16 v[132:135], v[52:55], v[64:67], v[132:135]
    s_waitcnt vmcnt(21)
    v_mfma_f32_16x16x32_bf16 v[136:139], v[56:59], v[64:67], v[136:139]
    buffer_load_dwordx4 v[36:39], v3, s[8:11], s29 offen offset:1024 sc1
    s_waitcnt vmcnt(21)
    v_mfma_f32_16x16x32_bf16 v[140:143], v[60:63], v[64:67], v[140:143]
    buffer_load_dwordx4 v[64:67], v4, s[8:11], s28 offen offset:0 sc1
    s_waitcnt vmcnt(21)
    v_mfma_f32_16x16x32_bf16 v[144:147], v[48:51], v[68:71], v[144:147]
    buffer_load_dwordx4 v[40:43], v3, s[8:11], s29 offen offset:2048 sc1
    v_mfma_f32_16x16x32_bf16 v[148:151], v[52:55], v[68:71], v[148:151]
    v_mfma_f32_16x16x32_bf16 v[152:155], v[56:59], v[68:71], v[152:155]
    buffer_load_dwordx4 v[44:47], v3, s[8:11], s29 offen offset:3072 sc1
    s_add_u32 s29, s29, 16384
    v_mfma_f32_16x16x32_bf16 v[156:159], v[60:63], v[68:71], v[156:159]
    buffer_load_dwordx4 v[68:71], v4, s[8:11], s28 offen offset:256 sc1
    s_waitcnt vmcnt(23)
    v_mfma_f32_16x16x32_bf16 v[160:163], v[48:51], v[72:75], v[160:163]
    v_mfma_f32_16x16x32_bf16 v[164:167], v[52:55], v[72:75], v[164:167]
    v_mfma_f32_16x16x32_bf16 v[168:171], v[56:59], v[72:75], v[168:171]
    v_mfma_f32_16x16x32_bf16 v[172:175], v[60:63], v[72:75], v[172:175]
    buffer_load_dwordx4 v[72:75], v5, s[8:11], s28 offen offset:0 sc1
    s_waitcnt vmcnt(23)
    v_mfma_f32_16x16x32_bf16 v[176:179], v[48:51], v[76:79], v[176:179]
    v_mfma_f32_16x16x32_bf16 v[180:183], v[52:55], v[76:79], v[180:183]
    v_mfma_f32_16x16x32_bf16 v[184:187], v[56:59], v[76:79], v[184:187]
    v_mfma_f32_16x16x32_bf16 v[188:191], v[60:63], v[76:79], v[188:191]
    buffer_load_dwordx4 v[76:79], v5, s[8:11], s28 offen offset:256 sc1
    s_waitcnt vmcnt(23)
    v_mfma_f32_16x16x32_bf16 v[192:195], v[48:51], v[80:83], v[192:195]
    v_mfma_f32_16x16x32_bf16 v[196:199], v[52:55], v[80:83], v[196:199]
    v_mfma_f32_16x16x32_bf16 v[200:203], v[56:59], v[80:83], v[200:203]
    v_mfma_f32_16x16x32_bf16 v[204:207], v[60:63], v[80:83], v[204:207]
    buffer_load_dwordx4 v[80:83], v6, s[8:11], s28 offen offset:0 sc1
    s_waitcnt vmcnt(23)
    v_mfma_f32_16x16x32_bf16 v[208:211], v[48:51], v[84:87], v[208:211]
    v_mfma_f32_16x16x32_bf16 v[212:215], v[52:55], v[84:87], v[212:215]
    v_mfma_f32_16x16x32_bf16 v[216:219], v[56:59], v[84:87], v[216:219]
    v_mfma_f32_16x16x32_bf16 v[220:223], v[60:63], v[84:87], v[220:223]
    buffer_load_dwordx4 v[84:87], v6, s[8:11], s28 offen offset:256 sc1
    s_waitcnt vmcnt(23)
    v_mfma_f32_16x16x32_bf16 v[224:227], v[48:51], v[88:91], v[224:227]
    v_mfma_f32_16x16x32_bf16 v[228:231], v[52:55], v[88:91], v[228:231]
    v_mfma_f32_16x16x32_bf16 v[232:235], v[56:59], v[88:91], v[232:235]
    v_mfma_f32_16x16x32_bf16 v[236:239], v[60:63], v[88:91], v[236:239]
    buffer_load_dwordx4 v[88:91], v7, s[8:11], s28 offen offset:0 sc1
    s_waitcnt vmcnt(23)
    v_mfma_f32_16x16x32_bf16 v[240:243], v[48:51], v[92:95], v[240:243]
    v_mfma_f32_16x16x32_bf16 v[244:247], v[52:55], v[92:95], v[244:247]
    v_mfma_f32_16x16x32_bf16 v[248:251], v[56:59], v[92:95], v[248:251]
    v_mfma_f32_16x16x32_bf16 v[252:255], v[60:63], v[92:95], v[252:255]
    buffer_load_dwordx4 v[92:95], v7, s[8:11], s28 offen offset:256 sc1
    s_add_u32 s28, s28, 8192
    s_waitcnt vmcnt(21)
    v_mfma_f32_16x16x32_bf16 v[128:131], v[16:19], v[96:99], v[128:131]
    buffer_load_dwordx4 v[48:51], v3, s[8:11], s29 offen offset:0 sc1
    v_mfma_f32_16x16x32_bf16 v[132:135], v[20:23], v[96:99], v[132:135]
    s_waitcnt vmcnt(21)
    v_mfma_f32_16x16x32_bf16 v[136:139], v[24:27], v[96:99], v[136:139]
    buffer_load_dwordx4 v[52:55], v3, s[8:11], s29 offen offset:1024 sc1
    s_waitcnt vmcnt(21)
    v_mfma_f32_16x16x32_bf16 v[140:143], v[28:31], v[96:99], v[140:143]
    buffer_load_dwordx4 v[96:99], v4, s[8:11], s28 offen offset:0 sc1
    s_waitcnt vmcnt(21)
    v_mfma_f32_16x16x32_bf16 v[144:147], v[16:19], v[100:103], v[144:147]
    buffer_load_dwordx4 v[56:59], v3, s[8:11], s29 offen offset:2048 sc1
    v_mfma_f32_16x16x32_bf16 v[148:151], v[20:23], v[100:103], v[148:151]
    v_mfma_f32_16x16x32_bf16 v[152:155], v[24:27], v[100:103], v[152:155]
    buffer_load_dwordx4 v[60:63], v3, s[8:11], s29 offen offset:3072 sc1
    s_add_u32 s29, s29, 16384
    v_mfma_f32_16x16x32_bf16 v[156:159], v[28:31], v[100:103], v[156:159]
    buffer_load_dwordx4 v[100:103], v4, s[8:11], s28 offen offset:256 sc1
    s_waitcnt vmcnt(23)
    v_mfma_f32_16x16x32_bf16 v[160:163], v[16:19], v[104:107], v[160:163]
    v_mfma_f32_16x16x32_bf16 v[164:167], v[20:23], v[104:107], v[164:167]
    v_mfma_f32_16x16x32_bf16 v[168:171], v[24:27], v[104:107], v[168:171]
    v_mfma_f32_16x16x32_bf16 v[172:175], v[28:31], v[104:107], v[172:175]
    buffer_load_dwordx4 v[104:107], v5, s[8:11], s28 offen offset:0 sc1
    s_waitcnt vmcnt(23)
    v_mfma_f32_16x16x32_bf16 v[176:179], v[16:19], v[108:111], v[176:179]
    v_mfma_f32_16x16x32_bf16 v[180:183], v[20:23], v[108:111], v[180:183]
    v_mfma_f32_16x16x32_bf16 v[184:187], v[24:27], v[108:111], v[184:187]
    v_mfma_f32_16x16x32_bf16 v[188:191], v[28:31], v[108:111], v[188:191]
    buffer_load_dwordx4 v[108:111], v5, s[8:11], s28 offen offset:256 sc1
    s_waitcnt vmcnt(23)
    v_mfma_f32_16x16x32_bf16 v[192:195], v[16:19], v[112:115], v[192:195]
    v_mfma_f32_16x16x32_bf16 v[196:199], v[20:23], v[112:115], v[196:199]
    v_mfma_f32_16x16x32_bf16 v[200:203], v[24:27], v[112:115], v[200:203]
    v_mfma_f32_16x16x32_bf16 v[204:207], v[28:31], v[112:115], v[204:207]
    buffer_load_dwordx4 v[112:115], v6, s[8:11], s28 offen offset:0 sc1
    s_waitcnt vmcnt(23)
    v_mfma_f32_16x16x32_bf16 v[208:211], v[16:19], v[116:119], v[208:211]
    v_mfma_f32_16x16x32_bf16 v[212:215], v[20:23], v[116:119], v[212:215]
    v_mfma_f32_16x16x32_bf16 v[216:219], v[24:27], v[116:119], v[216:219]
    v_mfma_f32_16x16x32_bf16 v[220:223], v[28:31], v[116:119], v[220:223]
    buffer_load_dwordx4 v[116:119], v6, s[8:11], s28 offen offset:256 sc1
    s_waitcnt vmcnt(23)
    v_mfma_f32_16x16x32_bf16 v[224:227], v[16:19], v[120:123], v[224:227]
    v_mfma_f32_16x16x32_bf16 v[228:231], v[20:23], v[120:123], v[228:231]
    v_mfma_f32_16x16x32_bf16 v[232:235], v[24:27], v[120:123], v[232:235]
    v_mfma_f32_16x16x32_bf16 v[236:239], v[28:31], v[120:123], v[236:239]
    buffer_load_dwordx4 v[120:123], v7, s[8:11], s28 offen offset:0 sc1
    s_waitcnt vmcnt(23)
    v_mfma_f32_16x16x32_bf16 v[240:243], v[16:19], v[124:127], v[240:243]
    v_mfma_f32_16x16x32_bf16 v[244:247], v[20:23], v[124:127], v[244:247]
    v_mfma_f32_16x16x32_bf16 v[248:251], v[24:27], v[124:127], v[248:251]
    v_mfma_f32_16x16x32_bf16 v[252:255], v[28:31], v[124:127], v[252:255]
    buffer_load_dwordx4 v[124:127], v7, s[8:11], s28 offen offset:256 sc1
    s_add_u32 s28, s28, 8192
    s_waitcnt vmcnt(21)
    v_mfma_f32_16x16x32_bf16 v[128:131], v[32:35], v[64:67], v[128:131]
    buffer_load_dwordx4 v[16:19], v3, s[8:11], s29 offen offset:0 sc1
    v_mfma_f32_16x16x32_bf16 v[132:135], v[36:39], v[64:67], v[132:135]
    s_waitcnt vmcnt(21)
    v_mfma_f32_16x16x32_bf16 v[136:139], v[40:43], v[64:67], v[136:139]
    buffer_load_dwordx4 v[20:23], v3, s[8:11], s29 offen offset:1024 sc1
    s_waitcnt vmcnt(21)
    v_mfma_f32_16x16x32_bf16 v[140:143], v[44:47], v[64:67], v[140:143]
    buffer_load_dwordx4 v[64:67], v4, s[8:11], s28 offen offset:0 sc1
    s_waitcnt vmcnt(21)
    v_mfma_f32_16x16x32_bf16 v[144:147], v[32:35], v[68:71], v[144:147]
    buffer_load_dwordx4 v[24:27], v3, s[8:11], s29 offen offset:2048 sc1
    v_mfma_f32_16x16x32_bf16 v[148:151], v[36:39], v[68:71], v[148:151]
    v_mfma_f32_16x16x32_bf16 v[152:155], v[40:43], v[68:71], v[152:155]
    buffer_load_dwordx4 v[28:31], v3, s[8:11], s29 offen offset:3072 sc1
    s_add_u32 s29, s29, 16384
    v_mfma_f32_16x16x32_bf16 v[156:159], v[44:47], v[68:71], v[156:159]
    buffer_load_dwordx4 v[68:71], v4, s[8:11], s28 offen offset:256 sc1
    s_waitcnt vmcnt(23)
    v_mfma_f32_16x16x32_bf16 v[160:163], v[32:35], v[72:75], v[160:163]
    v_mfma_f32_16x16x32_bf16 v[164:167], v[36:39], v[72:75], v[164:167]
    v_mfma_f32_16x16x32_bf16 v[168:171], v[40:43], v[72:75], v[168:171]
    v_mfma_f32_16x16x32_bf16 v[172:175], v[44:47], v[72:75], v[172:175]
    buffer_load_dwordx4 v[72:75], v5, s[8:11], s28 offen offset:0 sc1
    s_waitcnt vmcnt(23)
    v_mfma_f32_16x16x32_bf16 v[176:179], v[32:35], v[76:79], v[176:179]
    v_mfma_f32_16x16x32_bf16 v[180:183], v[36:39], v[76:79], v[180:183]
    v_mfma_f32_16x16x32_bf16 v[184:187], v[40:43], v[76:79], v[184:187]
    v_mfma_f32_16x16x32_bf16 v[188:191], v[44:47], v[76:79], v[188:191]
    buffer_load_dwordx4 v[76:79], v5, s[8:11], s28 offen offset:256 sc1
    s_waitcnt vmcnt(23)
    v_mfma_f32_16x16x32_bf16 v[192:195], v[32:35], v[80:83], v[192:195]
    v_mfma_f32_16x16x32_bf16 v[196:199], v[36:39], v[80:83], v[196:199]
    v_mfma_f32_16x16x32_bf16 v[200:203], v[40:43], v[80:83], v[200:203]
    v_mfma_f32_16x16x32_bf16 v[204:207], v[44:47], v[80:83], v[204:207]
    buffer_load_dwordx4 v[80:83], v6, s[8:11], s28 offen offset:0 sc1
    s_waitcnt vmcnt(23)
    v_mfma_f32_16x16x32_bf16 v[208:211], v[32:35], v[84:87], v[208:211]
    v_mfma_f32_16x16x32_bf16 v[212:215], v[36:39], v[84:87], v[212:215]
    v_mfma_f32_16x16x32_bf16 v[216:219], v[40:43], v[84:87], v[216:219]
    v_mfma_f32_16x16x32_bf16 v[220:223], v[44:47], v[84:87], v[220:223]
    buffer_load_dwordx4 v[84:87], v6, s[8:11], s28 offen offset:256 sc1
    s_waitcnt vmcnt(23)
    v_mfma_f32_16x16x32_bf16 v[224:227], v[32:35], v[88:91], v[224:227]
    v_mfma_f32_16x16x32_bf16 v[228:231], v[36:39], v[88:91], v[228:231]
    v_mfma_f32_16x16x32_bf16 v[232:235], v[40:43], v[88:91], v[232:235]
    v_mfma_f32_16x16x32_bf16 v[236:239], v[44:47], v[88:91], v[236:239]
    buffer_load_dwordx4 v[88:91], v7, s[8:11], s28 offen offset:0 sc1
    s_waitcnt vmcnt(23)
    v_mfma_f32_16x16x32_bf16 v[240:243], v[32:35], v[92:95], v[240:243]
    v_mfma_f32_16x16x32_bf16 v[244:247], v[36:39], v[92:95], v[244:247]
    v_mfma_f32_16x16x32_bf16 v[248:251], v[40:43], v[92:95], v[248:251]
    v_mfma_f32_16x16x32_bf16 v[252:255], v[44:47], v[92:95], v[252:255]
    buffer_load_dwordx4 v[92:95], v7, s[8:11], s28 offen offset:256 sc1
    s_add_u32 s28, s28, 8192
    s_waitcnt vmcnt(21)
    v_mfma_f32_16x16x32_bf16 v[128:131], v[48:51], v[96:99], v[128:131]
    buffer_load_dwordx4 v[32:35], v3, s[8:11], s29 offen offset:0 sc1
    v_mfma_f32_16x16x32_bf16 v[132:135], v[52:55], v[96:99], v[132:135]
    s_waitcnt vmcnt(21)
    v_mfma_f32_16x16x32_bf16 v[136:139], v[56:59], v[96:99], v[136:139]
    buffer_load_dwordx4 v[36:39], v3, s[8:11], s29 offen offset:1024 sc1
    s_waitcnt vmcnt(21)
    v_mfma_f32_16x16x32_bf16 v[140:143], v[60:63], v[96:99], v[140:143]
    buffer_load_dwordx4 v[96:99], v4, s[8:11], s28 offen offset:0 sc1
    s_waitcnt vmcnt(21)
    v_mfma_f32_16x16x32_bf16 v[144:147], v[48:51], v[100:103], v[144:147]
    buffer_load_dwordx4 v[40:43], v3, s[8:11], s29 offen offset:2048 sc1
    v_mfma_f32_16x16x32_bf16 v[148:151], v[52:55], v[100:103], v[148:151]
    v_mfma_f32_16x16x32_bf16 v[152:155], v[56:59], v[100:103], v[152:155]
    buffer_load_dwordx4 v[44:47], v3, s[8:11], s29 offen offset:3072 sc1
    s_add_u32 s29, s29, 16384
    v_mfma_f32_16x16x32_bf16 v[156:159], v[60:63], v[100:103], v[156:159]
    buffer_load_dwordx4 v[100:103], v4, s[8:11], s28 offen offset:256 sc1
    s_waitcnt vmcnt(23)
    v_mfma_f32_16x16x32_bf16 v[160:163], v[48:51], v[104:107], v[160:163]
    v_mfma_f32_16x16x32_bf16 v[164:167], v[52:55], v[104:107], v[164:167]
    v_mfma_f32_16x16x32_bf16 v[168:171], v[56:59], v[104:107], v[168:171]
    v_mfma_f32_16x16x32_bf16 v[172:175], v[60:63], v[104:107], v[172:175]
    buffer_load_dwordx4 v[104:107], v5, s[8:11], s28 offen offset:0 sc1
    s_waitcnt vmcnt(23)
    v_mfma_f32_16x16x32_bf16 v[176:179], v[48:51], v[108:111], v[176:179]
    v_mfma_f32_16x16x32_bf16 v[180:183], v[52:55], v[108:111], v[180:183]
    v_mfma_f32_16x16x32_bf16 v[184:187], v[56:59], v[108:111], v[184:187]
    v_mfma_f32_16x16x32_bf16 v[188:191], v[60:63], v[108:111], v[188:191]
    buffer_load_dwordx4 v[108:111], v5, s[8:11], s28 offen offset:256 sc1
    s_waitcnt vmcnt(23)
    v_mfma_f32_16x16x32_bf16 v[192:195], v[48:51], v[112:115], v[192:195]
    v_mfma_f32_16x16x32_bf16 v[196:199], v[52:55], v[112:115], v[196:199]
    v_mfma_f32_16x16x32_bf16 v[200:203], v[56:59], v[112:115], v[200:203]
    v_mfma_f32_16x16x32_bf16 v[204:207], v[60:63], v[112:115], v[204:207]
    buffer_load_dwordx4 v[112:115], v6, s[8:11], s28 offen offset:0 sc1
    s_waitcnt vmcnt(23)
    v_mfma_f32_16x16x32_bf16 v[208:211], v[48:51], v[116:119], v[208:211]
    v_mfma_f32_16x16x32_bf16 v[212:215], v[52:55], v[116:119], v[212:215]
    v_mfma_f32_16x16x32_bf16 v[216:219], v[56:59], v[116:119], v[216:219]
    v_mfma_f32_16x16x32_bf16 v[220:223], v[60:63], v[116:119], v[220:223]
    buffer_load_dwordx4 v[116:119], v6, s[8:11], s28 offen offset:256 sc1
    s_waitcnt vmcnt(23)
    v_mfma_f32_16x16x32_bf16 v[224:227], v[48:51], v[120:123], v[224:227]
    v_mfma_f32_16x16x32_bf16 v[228:231], v[52:55], v[120:123], v[228:231]
    v_mfma_f32_16x16x32_bf16 v[232:235], v[56:59], v[120:123], v[232:235]
    v_mfma_f32_16x16x32_bf16 v[236:239], v[60:63], v[120:123], v[236:239]
    buffer_load_dwordx4 v[120:123], v7, s[8:11], s28 offen offset:0 sc1
    s_waitcnt vmcnt(23)
    v_mfma_f32_16x16x32_bf16 v[240:243], v[48:51], v[124:127], v[240:243]
    v_mfma_f32_16x16x32_bf16 v[244:247], v[52:55], v[124:127], v[244:247]
    v_mfma_f32_16x16x32_bf16 v[248:251], v[56:59], v[124:127], v[248:251]
    v_mfma_f32_16x16x32_bf16 v[252:255], v[60:63], v[124:127], v[252:255]
    buffer_load_dwordx4 v[124:127], v7, s[8:11], s28 offen offset:256 sc1
    s_add_u32 s28, s28, 8192
    s_add_u32 s34, s34, 1
    s_cmp_lg_u32 s34, 4
    s_cbranch_scc1 mk_gloop
    s_mul_i32 s5, s62, 20480
    s_add_u32 s5, s5, 73728
    v_add_u32 v8, s5, v3
    s_add_u32 s4, s29, 81920
    s_add_u32 m0, s5, 0
    s_nop 0
    buffer_load_dwordx4 v3, s[8:11], s4 offen offset:0 sc1 lds
    buffer_load_dwordx4 v3, s[8:11], s4 offen offset:1024 sc1 lds
    buffer_load_dwordx4 v3, s[8:11], s4 offen offset:2048 sc1 lds
    buffer_load_dwordx4 v3, s[8:11], s4 offen offset:3072 sc1 lds
    s_add_u32 s4, s4, 16384
    s_add_u32 m0, s5, 4096
    s_nop 0
    buffer_load_dwordx4 v3, s[8:11], s4 offen offset:0 sc1 lds
    buffer_load_dwordx4 v3, s[8:11], s4 offen offset:1024 sc1 lds
    buffer_load_dwordx4 v3, s[8:11], s4 offen offset:2048 sc1 lds
    buffer_load_dwordx4 v3, s[8:11], s4 offen offset:3072 sc1 lds
    s_add_u32 s4, s4, 16384
    s_add_u32 m0, s5, 8192
    s_nop 0
    buffer_load_dwordx4 v3, s[8:11], s4 offen offset:0 sc1 lds
    buffer_load_dwordx4 v3, s[8:11], s4 offen offset:1024 sc1 lds
    buffer_load_dwordx4 v3, s[8:11], s4 offen offset:2048 sc1 lds
    buffer_load_dwordx4 v3, s[8:11], s4 offen offset:3072 sc1 lds
    s_add_u32 s4, s4, 16384
    s_add_u32 m0, s5, 12288
    s_nop 0
    buffer_load_dwordx4 v3, s[8:11], s4 offen offset:0 sc1 lds
    buffer_load_dwordx4 v3, s[8:11], s4 offen offset:1024 sc1 lds
    buffer_load_dwordx4 v3, s[8:11], s4 offen offset:2048 sc1 lds
    buffer_load_dwordx4 v3, s[8:11], s4 offen offset:3072 sc1 lds
    s_add_u32 s4, s4, 16384
    s_add_u32 m0, s5, 16384
    s_nop 0
    buffer_load_dwordx4 v3, s[8:11], s4 offen offset:0 sc1 lds
    buffer_load_dwordx4 v3, s[8:11], s4 offen offset:1024 sc1 lds
    buffer_load_dwordx4 v3, s[8:11], s4 offen offset:2048 sc1 lds
    buffer_load_dwordx4 v3, s[8:11], s4 offen offset:3072 sc1 lds
    s_add_u32 s4, s4, 16384
    v_and_b32 v9, 3, v0
    v_lshlrev_b32 v9, 8, v9
    v_add_u32 v9, 162048, v9
    s_mov_b32 s4, 800000
mk_gw:
    ds_read_b32 v10, v9
    s_waitcnt lgkmcnt(0)
    v_cmp_gt_u32 vcc, 1000, v10
    s_cbranch_vccz mk_gwd
    s_sleep 2
    s_sub_u32 s4, s4, 1
    s_cmp_lg_u32 s4, 0
    s_cbranch_scc1 mk_gw
mk_gwd:
    s_waitcnt vmcnt(41)
    v_mfma_f32_16x16x32_bf16 v[128:131], v[16:19], v[64:67], v[128:131]
    buffer_load_dwordx4 v[48:51], v3, s[8:11], s29 offen offset:0 sc1
    v_mfma_f32_16x16x32_bf16 v[132:135], v[20:23], v[64:67], v[132:135]
    s_waitcnt vmcnt(41)
    v_mfma_f32_16x16x32_bf16 v[136:139], v[24:27], v[64:67], v[136:139]
    buffer_load_dwordx4 v[52:55], v3, s[8:11], s29 offen offset:1024 sc1
    s_waitcnt vmcnt(41)
    v_mfma_f32_16x16x32_bf16 v[140:143], v[28:31], v[64:67], v[140:143]
    buffer_load_dwordx4 v[64:67], v4, s[8:11], s28 offen offset:0 sc1
    s_waitcnt vmcnt(41)
    v_mfma_f32_16x16x32_bf16 v[144:147], v[16:19], v[68:71], v[144:147]
    buffer_load_dwordx4 v[56:59], v3, s[8:11], s29 offen offset:2048 sc1
    v_mfma_f32_16x16x32_bf16 v[148:151], v[20:23], v[68:71], v[148:151]
    v_mfma_f32_16x16x32_bf16 v[152:155], v[24:27], v[68:71], v[152:155]
    buffer_load_dwordx4 v[60:63], v3, s[8:11], s29 offen offset:3072 sc1
    s_add_u32 s29, s29, 16384
    v_mfma_f32_16x16x32_bf16 v[156:159], v[28:31], v[68:71], v[156:159]
    buffer_load_dwordx4 v[68:71], v4, s[8:11], s28 offen offset:256 sc1
    s_waitcnt vmcnt(43)
    v_mfma_f32_16x16x32_bf16 v[160:163], v[16:19], v[72:75], v[160:163]
    v_mfma_f32_16x16x32_bf16 v[164:167], v[20:23], v[72:75], v[164:167]
    v_mfma_f32_16x16x32_bf16 v[168:171], v[24:27], v[72:75], v[168:171]
    v_mfma_f32_16x16x32_bf16 v[172:175], v[28:31], v[72:75], v[172:175]
    buffer_load_dwordx4 v[72:75], v5, s[8:11], s28 offen offset:0 sc1
    s_waitcnt vmcnt(43)
    v_mfma_f32_16x16x32_bf16 v[176:179], v[16:19], v[76:79], v[176:179]
    v_mfma_f32_16x16x32_bf16 v[180:183], v[20:23], v[76:79], v[180:183]
    v_mfma_f32_16x16x32_bf16 v[184:187], v[24:27], v[76:79], v[184:187]
    v_mfma_f32_16x16x32_bf16 v[188:191], v[28:31], v[76:79], v[188:191]
    buffer_load_dwordx4 v[76:79], v5, s[8:11], s28 offen offset:256 sc1
    s_waitcnt vmcnt(43)
    v_mfma_f32_16x16x32_bf16 v[192:195], v[16:19], v[80:83], v[192:195]
    v_mfma_f32_16x16x32_bf16 v[196:199], v[20:23], v[80:83], v[196:199]
    v_mfma_f32_16x16x32_bf16 v[200:203], v[24:27], v[80:83], v[200:203]
    v_mfma_f32_16x16x32_bf16 v[204:207], v[28:31], v[80:83], v[204:207]
    buffer_load_dwordx4 v[80:83], v6, s[8:11], s28 offen offset:0 sc1
    s_waitcnt vmcnt(43)
    v_mfma_f32_16x16x32_bf16 v[208:211], v[16:19], v[84:87], v[208:211]
    v_mfma_f32_16x16x32_bf16 v[212:215], v[20:23], v[84:87], v[212:215]
    v_mfma_f32_16x16x32_bf16 v[216:219], v[24:27], v[84:87], v[216:219]
    v_mfma_f32_16x16x32_bf16 v[220:223], v[28:31], v[84:87], v[220:223]
    buffer_load_dwordx4 v[84:87], v6, s[8:11], s28 offen offset:256 sc1
    s_waitcnt vmcnt(43)
    v_mfma_f32_16x16x32_bf16 v[224:227], v[16:19], v[88:91], v[224:227]
    v_mfma_f32_16x16x32_bf16 v[228:231], v[20:23], v[88:91], v[228:231]
    v_mfma_f32_16x16x32_bf16 v[232:235], v[24:27], v[88:91], v[232:235]
    v_mfma_f32_16x16x32_bf16 v[236:239], v[28:31], v[88:91], v[236:239]
    buffer_load_dwordx4 v[88:91], v7, s[8:11], s28 offen offset:0 sc1
    s_waitcnt vmcnt(43)
    v_mfma_f32_16x16x32_bf16 v[240:243], v[16:19], v[92:95], v[240:243]
    v_mfma_f32_16x16x32_bf16 v[244:247], v[20:23], v[92:95], v[244:247]
    v_mfma_f32_16x16x32_bf16 v[248:251], v[24:27], v[92:95], v[248:251]
    v_mfma_f32_16x16x32_bf16 v[252:255], v[28:31], v[92:95], v[252:255]
    buffer_load_dwordx4 v[92:95], v7, s[8:11], s28 offen offset:256 sc1
    s_add_u32 s28, s28, 8192
    s_waitcnt vmcnt(41)
    v_mfma_f32_16x16x32_bf16 v[128:131], v[32:35], v[96:99], v[128:131]
    buffer_load_dwordx4 v[16:19], v3, s[8:11], s29 offen offset:0 sc1
    v_mfma_f32_16x16x32_bf16 v[132:135], v[36:39], v[96:99], v[132:135]
    s_waitcnt vmcnt(41)
    v_mfma_f32_16x16x32_bf16 v[136:139], v[40:43], v[96:99], v[136:139]
    buffer_load_dwordx4 v[20:23], v3, s[8:11], s29 offen offset:1024 sc1
    s_waitcnt vmcnt(41)
    v_mfma_f32_16x16x32_bf16 v[140:143], v[44:47], v[96:99], v[140:143]
    buffer_load_dwordx4 v[96:99], v4, s[8:11], s28 offen offset:0 sc1
    s_waitcnt vmcnt(41)
    v_mfma_f32_16x16x32_bf16 v[144:147], v[32:35], v[100:103], v[144:147]
    buffer_load_dwordx4 v[24:27], v3, s[8:11], s29 offen offset:2048 sc1
    v_mfma_f32_16x16x32_bf16 v[148:151], v[36:39], v[100:103], v[148:151]
    v_mfma_f32_16x16x32_bf16 v[152:155], v[40:43], v[100:103], v[152:155]
    buffer_load_dwordx4 v[28:31], v3, s[8:11], s29 offen offset:3072 sc1
    s_add_u32 s29, s29, 16384
    v_mfma_f32_16x16x32_bf16 v[156:159], v[44:47], v[100:103], v[156:159]
    buffer_load_dwordx4 v[100:103], v4, s[8:11], s28 offen offset:256 sc1
    s_waitcnt vmcnt(43)
    v_mfma_f32_16x16x32_bf16 v[160:163], v[32:35], v[104:107], v[160:163]
    v_mfma_f32_16x16x32_bf16 v[164:167], v[36:39], v[104:107], v[164:167]
    v_mfma_f32_16x16x32_bf16 v[168:171], v[40:43], v[104:107], v[168:171]
    v_mfma_f32_16x16x32_bf16 v[172:175], v[44:47], v[104:107], v[172:175]
    buffer_load_dwordx4 v[104:107], v5, s[8:11], s28 offen offset:0 sc1
    s_waitcnt vmcnt(43)
    v_mfma_f32_16x16x32_bf16 v[176:179], v[32:35], v[108:111], v[176:179]
    v_mfma_f32_16x16x32_bf16 v[180:183], v[36:39], v[108:111], v[180:183]
    v_mfma_f32_16x16x32_bf16 v[184:187], v[40:43], v[108:111], v[184:187]
    v_mfma_f32_16x16x32_bf16 v[188:191], v[44:47], v[108:111], v[188:191]
    buffer_load_dwordx4 v[108:111], v5, s[8:11], s28 offen offset:256 sc1
    s_waitcnt vmcnt(43)
    v_mfma_f32_16x16x32_bf16 v[192:195], v[32:35], v[112:115], v[192:195]
    v_mfma_f32_16x16x32_bf16 v[196:199], v[36:39], v[112:115], v[196:199]
    v_mfma_f32_16x16x32_bf16 v[200:203], v[40:43], v[112:115], v[200:203]
    v_mfma_f32_16x16x32_bf16 v[204:207], v[44:47], v[112:115], v[204:207]
    buffer_load_dwordx4 v[112:115], v6, s[8:11], s28 offen offset:0 sc1
    s_waitcnt vmcnt(43)
    v_mfma_f32_16x16x32_bf16 v[208:211], v[32:35], v[116:119], v[208:211]
    v_mfma_f32_16x16x32_bf16 v[212:215], v[36:39], v[116:119], v[212:215]
    v_mfma_f32_16x16x32_bf16 v[216:219], v[40:43], v[116:119], v[216:219]
    v_mfma_f32_16x16x32_bf16 v[220:223], v[44:47], v[116:119], v[220:223]
    buffer_load_dwordx4 v[116:119], v6, s[8:11], s28 offen offset:256 sc1
    s_waitcnt vmcnt(43)
    v_mfma_f32_16x16x32_bf16 v[224:227], v[32:35], v[120:123], v[224:227]
    v_mfma_f32_16x16x32_bf16 v[228:231], v[36:39], v[120:123], v[228:231]
    v_mfma_f32_16x16x32_bf16 v[232:235], v[40:43], v[120:123], v[232:235]
    v_mfma_f32_16x16x32_bf16 v[236:239], v[44:47], v[120:123], v[236:239]
    buffer_load_dwordx4 v[120:123], v7, s[8:11], s28 offen offset:0 sc1
    s_waitcnt vmcnt(43)
    v_mfma_f32_16x16x32_bf16 v[240:243], v[32:35], v[124:127], v[240:243]
    v_mfma_f32_16x16x32_bf16 v[244:247], v[36:39], v[124:127], v[244:247]
    v_mfma_f32_16x16x32_bf16 v[248:251], v[40:43], v[124:127], v[248:251]
    v_mfma_f32_16x16x32_bf16 v[252:255], v[44:47], v[124:127], v[252:255]
    buffer_load_dwordx4 v[124:127], v7, s[8:11], s28 offen offset:256 sc1
    s_add_u32 s28, s28, 8192
    s_waitcnt vmcnt(21)
    v_mfma_f32_16x16x32_bf16 v[128:131], v[48:51], v[64:67], v[128:131]
    buffer_load_dwordx4 v[32:35], v3, s[8:11], s29 offen offset:0 sc1
    v_mfma_f32_16x16x32_bf16 v[132:135], v[52:55], v[64:67], v[132:135]
    s_waitcnt vmcnt(21)
    v_mfma_f32_16x16x32_bf16 v[136:139], v[56:59], v[64:67], v[136:139]
    buffer_load_dwordx4 v[36:39], v3, s[8:11], s29 offen offset:1024 sc1
    s_waitcnt vmcnt(21)
    v_mfma_f32_16x16x32_bf16 v[140:143], v[60:63], v[64:67], v[140:143]
    s_waitcnt vmcnt(20)
    v_mfma_f32_16x16x32_bf16 v[144:147], v[48:51], v[68:71], v[144:147]
    buffer_load_dwordx4 v[40:43], v3, s[8:11], s29 offen offset:2048 sc1
    v_mfma_f32_16x16x32_bf16 v[148:151], v[52:55], v[68:71], v[148:151]
    v_mfma_f32_16x16x32_bf16 v[152:155], v[56:59], v[68:71], v[152:155]
    buffer_load_dwordx4 v[44:47], v3, s[8:11], s29 offen offset:3072 sc1
    s_add_u32 s29, s29, 16384
    v_mfma_f32_16x16x32_bf16 v[156:159], v[60:63], v[68:71], v[156:159]
    s_waitcnt vmcnt(21)
    v_mfma_f32_16x16x32_bf16 v[160:163], v[48:51], v[72:75], v[160:163]
    v_mfma_f32_16x16x32_bf16 v[164:167], v[52:55], v[72:75], v[164:167]
    v_mfma_f32_16x16x32_bf16 v[168:171], v[56:59], v[72:75], v[168:171]
    v_mfma_f32_16x16x32_bf16 v[172:175], v[60:63], v[72:75], v[172:175]
    s_waitcnt vmcnt(20)
    v_mfma_f32_16x16x32_bf16 v[176:179], v[48:51], v[76:79], v[176:179]
    v_mfma_f32_16x16x32_bf16 v[180:183], v[52:55], v[76:79], v[180:183]
    v_mfma_f32_16x16x32_bf16 v[184:187], v[56:59], v[76:79], v[184:187]
    v_mfma_f32_16x16x32_bf16 v[188:191], v[60:63], v[76:79], v[188:191]
    s_waitcnt vmcnt(19)
    v_mfma_f32_16x16x32_bf16 v[192:195], v[48:51], v[80:83], v[192:195]
    v_mfma_f32_16x16x32_bf16 v[196:199], v[52:55], v[80:83], v[196:199]
    v_mfma_f32_16x16x32_bf16 v[200:203], v[56:59], v[80:83], v[200:203]
    v_mfma_f32_16x16x32_bf16 v[204:207], v[60:63], v[80:83], v[204:207]
    s_waitcnt vmcnt(18)
    v_mfma_f32_16x16x32_bf16 v[208:211], v[48:51], v[84:87], v[208:211]
    v_mfma_f32_16x16x32_bf16 v[212:215], v[52:55], v[84:87], v[212:215]
    v_mfma_f32_16x16x32_bf16 v[216:219], v[56:59], v[84:87], v[216:219]
    v_mfma_f32_16x16x32_bf16 v[220:223], v[60:63], v[84:87], v[220:223]
    s_waitcnt vmcnt(17)
    v_mfma_f32_16x16x32_bf16 v[224:227], v[48:51], v[88:91], v[224:227]
    v_mfma_f32_16x16x32_bf16 v[228:231], v[52:55], v[88:91], v[228:231]
    v_mfma_f32_16x16x32_bf16 v[232:235], v[56:59], v[88:91], v[232:235]
    v_mfma_f32_16x16x32_bf16 v[236:239], v[60:63], v[88:91], v[236:239]
    s_waitcnt vmcnt(16)
    v_mfma_f32_16x16x32_bf16 v[240:243], v[48:51], v[92:95], v[240:243]
    v_mfma_f32_16x16x32_bf16 v[244:247], v[52:55], v[92:95], v[244:247]
    v_mfma_f32_16x16x32_bf16 v[248:251], v[56:59], v[92:95], v[248:251]
    v_mfma_f32_16x16x32_bf16 v[252:255], v[60:63], v[92:95], v[252:255]
    s_waitcnt vmcnt(13)
    v_mfma_f32_16x16x32_bf16 v[128:131], v[16:19], v[96:99], v[128:131]
    buffer_load_dwordx4 v[48:51], v3, s[8:11], s29 offen offset:0 sc1
    v_mfma_f32_16x16x32_bf16 v[132:135], v[20:23], v[96:99], v[132:135]
    s_waitcnt vmcnt(13)
    v_mfma_f32_16x16x32_bf16 v[136:139], v[24:27], v[96:99], v[136:139]
    buffer_load_dwordx4 v[52:55], v3, s[8:11], s29 offen offset:1024 sc1
    s_waitcnt vmcnt(13)
    v_mfma_f32_16x16x32_bf16 v[140:143], v[28:31], v[96:99], v[140:143]
    s_waitcnt vmcnt(12)
    v_mfma_f32_16x16x32_bf16 v[144:147], v[16:19], v[100:103], v[144:147]
    buffer_load_dwordx4 v[56:59], v3, s[8:11], s29 offen offset:2048 sc1
    v_mfma_f32_16x16x32_bf16 v[148:151], v[20:23], v[100:103], v[148:151]
    v_mfma_f32_16x16x32_bf16 v[152:155], v[24:27], v[100:103], v[152:155]
    buffer_load_dwordx4 v[60:63], v3, s[8:11], s29 offen offset:3072 sc1
    s_add_u32 s29, s29, 16384
    v_mfma_f32_16x16x32_bf16 v[156:159], v[28:31], v[100:103], v[156:159]
    s_waitcnt vmcnt(13)
    v_mfma_f32_16x16x32_bf16 v[160:163], v[16:19], v[104:107], v[160:163]
    v_mfma_f32_16x16x32_bf16 v[164:167], v[20:23], v[104:107], v[164:167]
    v_mfma_f32_16x16x32_bf16 v[168:171], v[24:27], v[104:107], v[168:171]
    v_mfma_f32_16x16x32_bf16 v[172:175], v[28:31], v[104:107], v[172:175]
    s_waitcnt vmcnt(12)
    v_mfma_f32_16x16x32_bf16 v[176:179], v[16:19], v[108:111], v[176:179]
    v_mfma_f32_16x16x32_bf16 v[180:183], v[20:23], v[108:111], v[180:183]
    v_mfma_f32_16x16x32_bf16 v[184:187], v[24:27], v[108:111], v[184:187]
    v_mfma_f32_16x16x32_bf16 v[188:191], v[28:31], v[108:111], v[188:191]
    s_waitcnt vmcnt(11)
    v_mfma_f32_16x16x32_bf16 v[192:195], v[16:19], v[112:115], v[192:195]
    v_mfma_f32_16x16x32_bf16 v[196:199], v[20:23], v[112:115], v[196:199]
    v_mfma_f32_16x16x32_bf16 v[200:203], v[24:27], v[112:115], v[200:203]
    v_mfma_f32_16x16x32_bf16 v[204:207], v[28:31], v[112:115], v[204:207]
    s_waitcnt vmcnt(10)
    v_mfma_f32_16x16x32_bf16 v[208:211], v[16:19], v[116:119], v[208:211]
    v_mfma_f32_16x16x32_bf16 v[212:215], v[20:23], v[116:119], v[212:215]
    v_mfma_f32_16x16x32_bf16 v[216:219], v[24:27], v[116:119], v[216:219]
    v_mfma_f32_16x16x32_bf16 v[220:223], v[28:31], v[116:119], v[220:223]
    s_waitcnt vmcnt(9)
    v_mfma_f32_16x16x32_bf16 v[224:227], v[16:19], v[120:123], v[224:227]
    v_mfma_f32_16x16x32_bf16 v[228:231], v[20:23], v[120:123], v[228:231]
    v_mfma_f32_16x16x32_bf16 v[232:235], v[24:27], v[120:123], v[232:235]
    v_mfma_f32_16x16x32_bf16 v[236:239], v[28:31], v[120:123], v[236:239]
    s_waitcnt vmcnt(8)
    v_mfma_f32_16x16x32_bf16 v[240:243], v[16:19], v[124:127], v[240:243]
    v_mfma_f32_16x16x32_bf16 v[244:247], v[20:23], v[124:127], v[244:247]
    v_mfma_f32_16x16x32_bf16 v[248:251], v[24:27], v[124:127], v[248:251]
    v_mfma_f32_16x16x32_bf16 v[252:255], v[28:31], v[124:127], v[252:255]
    buffer_load_dwordx4 v[16:19], v3, s[8:11], s29 offen offset:0 sc1
    buffer_load_dwordx4 v[20:23], v3, s[8:11], s29 offen offset:1024 sc1
    buffer_load_dwordx4 v[24:27], v3, s[8:11], s29 offen offset:2048 sc1
    buffer_load_dwordx4 v[28:31], v3, s[8:11], s29 offen offset:3072 sc1
    s_add_u32 s29, s29, 16384
    s_add_u32 s3, s33, 51904512
    s_mov_b32 s4, 200000
mk_poll3:
    buffer_load_dword v13, v12, s[8:11], s3 offen sc1
    s_waitcnt vmcnt(0)
    v_cmp_ne_u32 vcc, s25, v13
    s_cbranch_vccz mk_polld3
    s_sleep 2
    s_sub_u32 s4, s4, 1
    s_cmp_lg_u32 s4, 0
    s_cbranch_scc1 mk_poll3
mk_polld3:
    s_mov_b32 s28, s38
    buffer_load_dwordx4 v[64:67], v4, s[8:11], s28 offen offset:0 sc1
    buffer_load_dwordx4 v[68:71], v4, s[8:11], s28 offen offset:256 sc1
    buffer_load_dwordx4 v[72:75], v5, s[8:11], s28 offen offset:0 sc1
    buffer_load_dwordx4 v[76:79], v5, s[8:11], s28 offen offset:256 sc1
    buffer_load_dwordx4 v[80:83], v6, s[8:11], s28 offen offset:0 sc1
    buffer_load_dwordx4 v[84:87], v6, s[8:11], s28 offen offset:256 sc1
    buffer_load_dwordx4 v[88:91], v7, s[8:11], s28 offen offset:0 sc1
    buffer_load_dwordx4 v[92:95], v7, s[8:11], s28 offen offset:256 sc1
    s_add_u32 s28, s28, 8192
    buffer_load_dwordx4 v[96:99], v4, s[8:11], s28 offen offset:0 sc1
    buffer_load_dwordx4 v[100:103], v4, s[8:11], s28 offen offset:256 sc1
    buffer_load_dwordx4 v[104:107], v5, s[8:11], s28 offen offset:0 sc1
    buffer_load_dwordx4 v[108:111], v5, s[8:11], s28 offen offset:256 sc1
    buffer_load_dwordx4 v[112:115], v6, s[8:11], s28 offen offset:0 sc1
    buffer_load_dwordx4 v[116:119], v6, s[8:11], s28 offen offset:256 sc1
    buffer_load_dwordx4 v[120:123], v7, s[8:11], s28 offen offset:0 sc1
    buffer_load_dwordx4 v[124:127], v7, s[8:11], s28 offen offset:256 sc1
    s_add_u32 s28, s28, 8192
    s_waitcnt vmcnt(15)
    v_mfma_f32_16x16x32_bf16 v[128:131], v[32:35], v[64:67], v[128:131]
    v_mfma_f32_16x16x32_bf16 v[132:135], v[36:39], v[64:67], v[132:135]
    v_mfma_f32_16x16x32_bf16 v[136:139], v[40:43], v[64:67], v[136:139]
    v_mfma_f32_16x16x32_bf16 v[140:143], v[44:47], v[64:67], v[140:143]
    buffer_load_dwordx4 v[64:67], v4, s[8:11], s28 offen offset:0 sc1
    s_waitcnt vmcnt(15)
    v_mfma_f32_16x16x32_bf16 v[144:147], v[32:35], v[68:71], v[144:147]
    v_mfma_f32_16x16x32_bf16 v[148:151], v[36:39], v[68:71], v[148:151]
    v_mfma_f32_16x16x32_bf16 v[152:155], v[40:43], v[68:71], v[152:155]
    v_mfma_f32_16x16x32_bf16 v[156:159], v[44:47], v[68:71], v[156:159]
    buffer_load_dwordx4 v[68:71], v4, s[8:11], s28 offen offset:256 sc1
    s_waitcnt vmcnt(15)
    v_mfma_f32_16x16x32_bf16 v[160:163], v[32:35], v[72:75], v[160:163]
    v_mfma_f32_16x16x32_bf16 v[164:167], v[36:39], v[72:75], v[164:167]
    v_mfma_f32_16x16x32_bf16 v[168:171], v[40:43], v[72:75], v[168:171]
    v_mfma_f32_16x16x32_bf16 v[172:175], v[44:47], v[72:75], v[172:175]
    buffer_load_dwordx4 v[72:75], v5, s[8:11], s28 offen offset:0 sc1
    s_waitcnt vmcnt(15)
    v_mfma_f32_16x16x32_bf16 v[176:179], v[32:35], v[76:79], v[176:179]
    v_mfma_f32_16x16x32_bf16 v[180:183], v[36:39], v[76:79], v[180:183]
    v_mfma_f32_16x16x32_bf16 v[184:187], v[40:43], v[76:79], v[184:187]
    v_mfma_f32_16x16x32_bf16 v[188:191], v[44:47], v[76:79], v[188:191]
    buffer_load_dwordx4 v[76:79], v5, s[8:11], s28 offen offset:256 sc1
    s_waitcnt vmcnt(15)
    v_mfma_f32_16x16x32_bf16 v[192:195], v[32:35], v[80:83], v[192:195]
    v_mfma_f32_16x16x32_bf16 v[196:199], v[36:39], v[80:83], v[196:199]
    v_mfma_f32_16x16x32_bf16 v[200:203], v[40:43], v[80:83], v[200:203]
    v_mfma_f32_16x16x32_bf16 v[204:207], v[44:47], v[80:83], v[204:207]
    buffer_load_dwordx4 v[80:83], v6, s[8:11], s28 offen offset:0 sc1
    s_waitcnt vmcnt(15)
    v_mfma_f32_16x16x32_bf16 v[208:211], v[32:35], v[84:87], v[208:211]
    v_mfma_f32_16x16x32_bf16 v[212:215], v[36:39], v[84:87], v[212:215]
    v_mfma_f32_16x16x32_bf16 v[216:219], v[40:43], v[84:87], v[216:219]
    v_mfma_f32_16x16x32_bf16 v[220:223], v[44:47], v[84:87], v[220:223]
    buffer_load_dwordx4 v[84:87], v6, s[8:11], s28 offen offset:256 sc1
    s_waitcnt vmcnt(15)
    v_mfma_f32_16x16x32_bf16 v[224:227], v[32:35], v[88:91], v[224:227]
    v_mfma_f32_16x16x32_bf16 v[228:231], v[36:39], v[88:91], v[228:231]
    v_mfma_f32_16x16x32_bf16 v[232:235], v[40:43], v[88:91], v[232:235]
    v_mfma_f32_16x16x32_bf16 v[236:239], v[44:47], v[88:91], v[236:239]
    buffer_load_dwordx4 v[88:91], v7, s[8:11], s28 offen offset:0 sc1
    s_waitcnt vmcnt(15)
    v_mfma_f32_16x16x32_bf16 v[240:243], v[32:35], v[92:95], v[240:243]
    v_mfma_f32_16x16x32_bf16 v[244:247], v[36:39], v[92:95], v[244:247]
    v_mfma_f32_16x16x32_bf16 v[248:251], v[40:43], v[92:95], v[248:251]
    v_mfma_f32_16x16x32_bf16 v[252:255], v[44:47], v[92:95], v[252:255]
    buffer_load_dwordx4 v[92:95], v7, s[8:11], s28 offen offset:256 sc1
    s_add_u32 s28, s28, 8192
    s_waitcnt vmcnt(15)
    v_mfma_f32_16x16x32_bf16 v[128:131], v[48:51], v[96:99], v[128:131]
    v_mfma_f32_16x16x32_bf16 v[132:135], v[52:55], v[96:99], v[132:135]
    v_mfma_f32_16x16x32_bf16 v[136:139], v[56:59], v[96:99], v[136:139]
    v_mfma_f32_16x16x32_bf16 v[140:143], v[60:63], v[96:99], v[140:143]
    buffer_load_dwordx4 v[96:99], v4, s[8:11], s28 offen offset:0 sc1
    s_waitcnt vmcnt(15)
    v_mfma_f32_16x16x32_bf16 v[144:147], v[48:51], v[100:103], v[144:147]
    v_mfma_f32_16x16x32_bf16 v[148:151], v[52:55], v[100:103], v[148:151]
    v_mfma_f32_16x16x32_bf16 v[152:155], v[56:59], v[100:103], v[152:155]
    v_mfma_f32_16x16x32_bf16 v[156:159], v[60:63], v[100:103], v[156:159]
    buffer_load_dwordx4 v[100:103], v4, s[8:11], s28 offen offset:256 sc1
    s_waitcnt vmcnt(15)
    v_mfma_f32_16x16x32_bf16 v[160:163], v[48:51], v[104:107], v[160:163]
    v_mfma_f32_16x16x32_bf16 v[164:167], v[52:55], v[104:107], v[164:167]
    v_mfma_f32_16x16x32_bf16 v[168:171], v[56:59], v[104:107], v[168:171]
    v_mfma_f32_16x16x32_bf16 v[172:175], v[60:63], v[104:107], v[172:175]
    buffer_load_dwordx4 v[104:107], v5, s[8:11], s28 offen offset:0 sc1
    s_waitcnt vmcnt(15)
    v_mfma_f32_16x16x32_bf16 v[176:179], v[48:51], v[108:111], v[176:179]
    v_mfma_f32_16x16x32_bf16 v[180:183], v[52:55], v[108:111], v[180:183]
    v_mfma_f32_16x16x32_bf16 v[184:187], v[56:59], v[108:111], v[184:187]
    v_mfma_f32_16x16x32_bf16 v[188:191], v[60:63], v[108:111], v[188:191]
    buffer_load_dwordx4 v[108:111], v5, s[8:11], s28 offen offset:256 sc1
    s_waitcnt vmcnt(15)
    v_mfma_f32_16x16x32_bf16 v[192:195], v[48:51], v[112:115], v[192:195]
    v_mfma_f32_16x16x32_bf16 v[196:199], v[52:55], v[112:115], v[196:199]
    v_mfma_f32_16x16x32_bf16 v[200:203], v[56:59], v[112:115], v[200:203]
    v_mfma_f32_16x16x32_bf16 v[204:207], v[60:63], v[112:115], v[204:207]
    buffer_load_dwordx4 v[112:115], v6, s[8:11], s28 offen offset:0 sc1
    s_waitcnt vmcnt(15)
    v_mfma_f32_16x16x32_bf16 v[208:211], v[48:51], v[116:119], v[208:211]
    v_mfma_f32_16x16x32_bf16 v[212:215], v[52:55], v[116:119], v[212:215]
    v_mfma_f32_16x16x32_bf16 v[216:219], v[56:59], v[116:119], v[216:219]
    v_mfma_f32_16x16x32_bf16 v[220:223], v[60:63], v[116:119], v[220:223]
    buffer_load_dwordx4 v[116:119], v6, s[8:11], s28 offen offset:256 sc1
    s_waitcnt vmcnt(15)
    v_mfma_f32_16x16x32_bf16 v[224:227], v[48:51], v[120:123], v[224:227]
    v_mfma_f32_16x16x32_bf16 v[228:231], v[52:55], v[120:123], v[228:231]
    v_mfma_f32_16x16x32_bf16 v[232:235], v[56:59], v[120:123], v[232:235]
    v_mfma_f32_16x16x32_bf16 v[236:239], v[60:63], v[120:123], v[236:239]
    buffer_load_dwordx4 v[120:123], v7, s[8:11], s28 offen offset:0 sc1
    s_waitcnt vmcnt(15)
    v_mfma_f32_16x16x32_bf16 v[240:243], v[48:51], v[124:127], v[240:243]
    v_mfma_f32_16x16x32_bf16 v[244:247], v[52:55], v[124:127], v[244:247]
    v_mfma_f32_16x16x32_bf16 v[248:251], v[56:59], v[124:127], v[248:251]
    v_mfma_f32_16x16x32_bf16 v[252:255], v[60:63], v[124:127], v[252:255]
    buffer_load_dwordx4 v[124:127], v7, s[8:11], s28 offen offset:256 sc1
    s_add_u32 s28, s28, 8192
    s_waitcnt vmcnt(15)
    v_mfma_f32_16x16x32_bf16 v[128:131], v[16:19], v[64:67], v[128:131]
    ds_read_b128 v[32:35], v8 offset:0
    v_mfma_f32_16x16x32_bf16 v[132:135], v[20:23], v[64:67], v[132:135]
    ds_read_b128 v[36:39], v8 offset:1024
    v_mfma_f32_16x16x32_bf16 v[136:139], v[24:27], v[64:67], v[136:139]
    ds_read_b128 v[40:43], v8 offset:2048
    v_mfma_f32_16x16x32_bf16 v[140:143], v[28:31], v[64:67], v[140:143]
    ds_read_b128 v[44:47], v8 offset:3072
    buffer_load_dwordx4 v[64:67], v4, s[8:11], s28 offen offset:0 sc1
    s_waitcnt vmcnt(15)
    v_mfma_f32_16x16x32_bf16 v[144:147], v[16:19], v[68:71], v[144:147]
    v_mfma_f32_16x16x32_bf16 v[148:151], v[20:23], v[68:71], v[148:151]
    v_mfma_f32_16x16x32_bf16 v[152:155], v[24:27], v[68:71], v[152:155]
    v_mfma_f32_16x16x32_bf16 v[156:159], v[28:31], v[68:71], v[156:159]
    buffer_load_dwordx4 v[68:71], v4, s[8:11], s28 offen offset:256 sc1
    s_waitcnt vmcnt(15)
    v_mfma_f32_16x16x32_bf16 v[160:163], v[16:19], v[72:75], v[160:163]
    v_mfma_f32_16x16x32_bf16 v[164:167], v[20:23], v[72:75], v[164:167]
    v_mfma_f32_16x16x32_bf16 v[168:171], v[24:27], v[72:75], v[168:171]
    v_mfma_f32_16x16x32_bf16 v[172:175], v[28:31], v[72:75], v[172:175]
    buffer_load_dwordx4 v[72:75], v5, s[8:11], s28 offen offset:0 sc1
    s_waitcnt vmcnt(15)
    v_mfma_f32_16x16x32_bf16 v[176:179], v[16:19], v[76:79], v[176:179]
    v_mfma_f32_16x16x32_bf16 v[180:183], v[20:23], v[76:79], v[180:183]
    v_mfma_f32_16x16x32_bf16 v[184:187], v[24:27], v[76:79], v[184:187]
    v_mfma_f32_16x16x32_bf16 v[188:191], v[28:31], v[76:79], v[188:191]
    buffer_load_dwordx4 v[76:79], v5, s[8:11], s28 offen offset:256 sc1
    s_waitcnt vmcnt(15)
    v_mfma_f32_16x16x32_bf16 v[192:195], v[16:19], v[80:83], v[192:195]
    v_mfma_f32_16x16x32_bf16 v[196:199], v[20:23], v[80:83], v[196:199]
    v_mfma_f32_16x16x32_bf16 v[200:203], v[24:27], v[80:83], v[200:203]
    v_mfma_f32_16x16x32_bf16 v[204:207], v[28:31], v[80:83], v[204:207]
    buffer_load_dwordx4 v[80:83], v6, s[8:11], s28 offen offset:0 sc1
    s_waitcnt vmcnt(15)
    v_mfma_f32_16x16x32_bf16 v[208:211], v[16:19], v[84:87], v[208:211]
    v_mfma_f32_16x16x32_bf16 v[212:215], v[20:23], v[84:87], v[212:215]
    v_mfma_f32_16x16x32_bf16 v[216:219], v[24:27], v[84:87], v[216:219]
    v_mfma_f32_16x16x32_bf16 v[220:223], v[28:31], v[84:87], v[220:223]
    buffer_load_dwordx4 v[84:87], v6, s[8:11], s28 offen offset:256 sc1
    s_waitcnt vmcnt(15)
    v_mfma_f32_16x16x32_bf16 v[224:227], v[16:19], v[88:91], v[224:227]
    v_mfma_f32_16x16x32_bf16 v[228:231], v[20:23], v[88:91], v[228:231]
    v_mfma_f32_16x16x32_bf16 v[232:235], v[24:27], v[88:91], v[232:235]
    v_mfma_f32_16x16x32_bf16 v[236:239], v[28:31], v[88:91], v[236:239]
    buffer_load_dwordx4 v[88:91], v7, s[8:11], s28 offen offset:0 sc1
    s_waitcnt vmcnt(15)
    v_mfma_f32_16x16x32_bf16 v[240:243], v[16:19], v[92:95], v[240:243]
    v_mfma_f32_16x16x32_bf16 v[244:247], v[20:23], v[92:95], v[244:247]
    v_mfma_f32_16x16x32_bf16 v[248:251], v[24:27], v[92:95], v[248:251]
    v_mfma_f32_16x16x32_bf16 v[252:255], v[28:31], v[92:95], v[252:255]
    buffer_load_dwordx4 v[92:95], v7, s[8:11], s28 offen offset:256 sc1
    s_add_u32 s28, s28, 8192
    s_waitcnt vmcnt(15) lgkmcnt(3)
    v_mfma_f32_16x16x32_bf16 v[128:131], v[32:35], v[96:99], v[128:131]
    ds_read_b128 v[48:51], v8 offset:4096
    s_waitcnt lgkmcnt(3)
    v_mfma_f32_16x16x32_bf16 v[132:135], v[36:39], v[96:99], v[132:135]
    ds_read_b128 v[52:55], v8 offset:5120
    s_waitcnt lgkmcnt(3)
    v_mfma_f32_16x16x32_bf16 v[136:139], v[40:43], v[96:99], v[136:139]
    ds_read_b128 v[56:59], v8 offset:6144
    s_waitcnt lgkmcnt(3)
    v_mfma_f32_16x16x32_bf16 v[140:143], v[44:47], v[96:99], v[140:143]
    ds_read_b128 v[60:63], v8 offset:7168
    buffer_load_dwordx4 v[96:99], v4, s[8:11], s28 offen offset:0 sc1
    s_waitcnt vmcnt(15)
    v_mfma_f32_16x16x32_bf16 v[144:147], v[32:35], v[100:103], v[144:147]
    v_mfma_f32_16x16x32_bf16 v[148:151], v[36:39], v[100:103], v[148:151]
    v_mfma_f32_16x16x32_bf16 v[152:155], v[40:43], v[100:103], v[152:155]
    v_mfma_f32_16x16x32_bf16 v[156:159], v[44:47], v[100:103], v[156:159]
    buffer_load_dwordx4 v[100:103], v4, s[8:11], s28 offen offset:256 sc1
    s_waitcnt vmcnt(15)
    v_mfma_f32_16x16x32_bf16 v[160:163], v[32:35], v[104:107], v[160:163]
    v_mfma_f32_16x16x32_bf16 v[164:167], v[36:39], v[104:107], v[164:167]
    v_mfma_f32_16x16x32_bf16 v[168:171], v[40:43], v[104:107], v[168:171]
    v_mfma_f32_16x16x32_bf16 v[172:175], v[44:47], v[104:107], v[172:175]
    buffer_load_dwordx4 v[104:107], v5, s[8:11], s28 offen offset:0 sc1
    s_waitcnt vmcnt(15)
    v_mfma_f32_16x16x32_bf16 v[176:179], v[32:35], v[108:111], v[176:179]
    v_mfma_f32_16x16x32_bf16 v[180:183], v[36:39], v[108:111], v[180:183]
    v_mfma_f32_16x16x32_bf16 v[184:187], v[40:43], v[108:111], v[184:187]
    v_mfma_f32_16x16x32_bf16 v[188:191], v[44:47], v[108:111], v[188:191]
    buffer_load_dwordx4 v[108:111], v5, s[8:11], s28 offen offset:256 sc1
    s_waitcnt vmcnt(15)
    v_mfma_f32_16x16x32_bf16 v[192:195], v[32:35], v[112:115], v[192:195]
    v_mfma_f32_16x16x32_bf16 v[196:199], v[36:39], v[112:115], v[196:199]
    v_mfma_f32_16x16x32_bf16 v[200:203], v[40:43], v[112:115], v[200:203]
    v_mfma_f32_16x16x32_bf16 v[204:207], v[44:47], v[112:115], v[204:207]
    buffer_load_dwordx4 v[112:115], v6, s[8:11], s28 offen offset:0 sc1
    s_waitcnt vmcnt(15)
    v_mfma_f32_16x16x32_bf16 v[208:211], v[32:35], v[116:119], v[208:211]
    v_mfma_f32_16x16x32_bf16 v[212:215], v[36:39], v[116:119], v[212:215]
    v_mfma_f32_16x16x32_bf16 v[216:219], v[40:43], v[116:119], v[216:219]
    v_mfma_f32_16x16x32_bf16 v[220:223], v[44:47], v[116:119], v[220:223]
    buffer_load_dwordx4 v[116:119], v6, s[8:11], s28 offen offset:256 sc1
    s_waitcnt vmcnt(15)
    v_mfma_f32_16x16x32_bf16 v[224:227], v[32:35], v[120:123], v[224:227]
    v_mfma_f32_16x16x32_bf16 v[228:231], v[36:39], v[120:123], v[228:231]
    v_mfma_f32_16x16x32_bf16 v[232:235], v[40:43], v[120:123], v[232:235]
    v_mfma_f32_16x16x32_bf16 v[236:239], v[44:47], v[120:123], v[236:239]
    buffer_load_dwordx4 v[120:123], v7, s[8:11], s28 offen offset:0 sc1
    s_waitcnt vmcnt(15)
    v_mfma_f32_16x16x32_bf16 v[240:243], v[32:35], v[124:127], v[240:243]
    v_mfma_f32_16x16x32_bf16 v[244:247], v[36:39], v[124:127], v[244:247]
    v_mfma_f32_16x16x32_bf16 v[248:251], v[40:43], v[124:127], v[248:251]
    v_mfma_f32_16x16x32_bf16 v[252:255], v[44:47], v[124:127], v[252:255]
    buffer_load_dwordx4 v[124:127], v7, s[8:11], s28 offen offset:256 sc1
    s_add_u32 s28, s28, 8192
    s_waitcnt vmcnt(15) lgkmcnt(3)
    v_mfma_f32_16x16x32_bf16 v[128:131], v[48:51], v[64:67], v[128:131]
    ds_read_b128 v[16:19], v8 offset:8192
    s_waitcnt lgkmcnt(3)
    v_mfma_f32_16x16x32_bf16 v[132:135], v[52:55], v[64:67], v[132:135]
    ds_read_b128 v[20:23], v8 offset:9216
    s_waitcnt lgkmcnt(3)
    v_mfma_f32_16x16x32_bf16 v[136:139], v[56:59], v[64:67], v[136:139]
    ds_read_b128 v[24:27], v8 offset:10240
    s_waitcnt lgkmcnt(3)
    v_mfma_f32_16x16x32_bf16 v[140:143], v[60:63], v[64:67], v[140:143]
    ds_read_b128 v[28:31], v8 offset:11264
    buffer_load_dwordx4 v[64:67], v4, s[8:11], s28 offen offset:0 sc1
    s_waitcnt vmcnt(15)
    v_mfma_f32_16x16x32_bf16 v[144:147], v[48:51], v[68:71], v[144:147]
    v_mfma_f32_16x16x32_bf16 v[148:151], v[52:55], v[68:71], v[148:151]
    v_mfma_f32_16x16x32_bf16 v[152:155], v[56:59], v[68:71], v[152:155]
    v_mfma_f32_16x16x32_bf16 v[156:159], v[60:63], v[68:71], v[156:159]
    buffer_load_dwordx4 v[68:71], v4, s[8:11], s28 offen offset:256 sc1
    s_waitcnt vmcnt(15)
    v_mfma_f32_16x16x32_bf16 v[160:163], v[48:51], v[72:75], v[160:163]
    v_mfma_f32_16x16x32_bf16 v[164:167], v[52:55], v[72:75], v[164:167]
    v_mfma_f32_16x16x32_bf16 v[168:171], v[56:59], v[72:75], v[168:171]
    v_mfma_f32_16x16x32_bf16 v[172:175], v[60:63], v[72:75], v[172:175]
    buffer_load_dwordx4 v[72:75], v5, s[8:11], s28 offen offset:0 sc1
    s_waitcnt vmcnt(15)
    v_mfma_f32_16x16x32_bf16 v[176:179], v[48:51], v[76:79], v[176:179]
    v_mfma_f32_16x16x32_bf16 v[180:183], v[52:55], v[76:79], v[180:183]
    v_mfma_f32_16x16x32_bf16 v[184:187], v[56:59], v[76:79], v[184:187]
    v_mfma_f32_16x16x32_bf16 v[188:191], v[60:63], v[76:79], v[188:191]
    buffer_load_dwordx4 v[76:79], v5, s[8:11], s28 offen offset:256 sc1
    s_waitcnt vmcnt(15)
    v_mfma_f32_16x16x32_bf16 v[192:195], v[48:51], v[80:83], v[192:195]
    v_mfma_f32_16x16x32_bf16 v[196:199], v[52:55], v[80:83], v[196:199]
    v_mfma_f32_16x16x32_bf16 v[200:203], v[56:59], v[80:83], v[200:203]
    v_mfma_f32_16x16x32_bf16 v[204:207], v[60:63], v[80:83], v[204:207]
    buffer_load_dwordx4 v[80:83], v6, s[8:11], s28 offen offset:0 sc1
    s_waitcnt vmcnt(15)
    v_mfma_f32_16x16x32_bf16 v[208:211], v[48:51], v[84:87], v[208:211]
    v_mfma_f32_16x16x32_bf16 v[212:215], v[52:55], v[84:87], v[212:215]
    v_mfma_f32_16x16x32_bf16 v[216:219], v[56:59], v[84:87], v[216:219]
    v_mfma_f32_16x16x32_bf16 v[220:223], v[60:63], v[84:87], v[220:223]
    buffer_load_dwordx4 v[84:87], v6, s[8:11], s28 offen offset:256 sc1
    s_waitcnt vmcnt(15)
    v_mfma_f32_16x16x32_bf16 v[224:227], v[48:51], v[88:91], v[224:227]
    v_mfma_f32_16x16x32_bf16 v[228:231], v[52:55], v[88:91], v[228:231]
    v_mfma_f32_16x16x32_bf16 v[232:235], v[56:59], v[88:91], v[232:235]
    v_mfma_f32_16x16x32_bf16 v[236:239], v[60:63], v[88:91], v[236:239]
    buffer_load_dwordx4 v[88:91], v7, s[8:11], s28 offen offset:0 sc1
    s_waitcnt vmcnt(15)
    v_mfma_f32_16x16x32_bf16 v[240:243], v[48:51], v[92:95], v[240:243]
    v_mfma_f32_16x16x32_bf16 v[244:247], v[52:55], v[92:95], v[244:247]
    v_mfma_f32_16x16x32_bf16 v[248:251], v[56:59], v[92:95], v[248:251]
    v_mfma_f32_16x16x32_bf16 v[252:255], v[60:63], v[92:95], v[252:255]
    buffer_load_dwordx4 v[92:95], v7, s[8:11], s28 offen offset:256 sc1
    s_add_u32 s28, s28, 8192
    v_and_b32 v15, 15, v0
    v_mul_u32_u24 v15, 272, v15
    v_and_b32 v1, 48, v0
    v_add_u32 v15, v1, v15
    s_mul_i32 s3, s62, 34816
    v_add_u32 v15, s3, v15
    s_waitcnt vmcnt(15) lgkmcnt(3)
    v_mfma_f32_16x16x32_bf16 v[128:131], v[16:19], v[96:99], v[128:131]
    ds_read_b128 v[32:35], v8 offset:12288
    s_waitcnt lgkmcnt(3)
    v_mfma_f32_16x16x32_bf16 v[132:135], v[20:23], v[96:99], v[132:135]
    ds_read_b128 v[36:39], v8 offset:13312
    s_waitcnt lgkmcnt(3)
    v_mfma_f32_16x16x32_bf16 v[136:139], v[24:27], v[96:99], v[136:139]
    ds_read_b128 v[40:43], v8 offset:14336
    s_waitcnt lgkmcnt(3)
    v_mfma_f32_16x16x32_bf16 v[140:143], v[28:31], v[96:99], v[140:143]
    ds_read_b128 v[44:47], v8 offset:15360
    buffer_load_dwordx4 v[96:99], v4, s[8:11], s28 offen offset:0 sc1
    s_waitcnt vmcnt(15)
    v_mfma_f32_16x16x32_bf16 v[144:147], v[16:19], v[100:103], v[144:147]
    ds_read_b128 v[48:51], v8 offset:16384
    v_mfma_f32_16x16x32_bf16 v[148:151], v[20:23], v[100:103], v[148:151]
    ds_read_b128 v[52:55], v8 offset:17408
    v_mfma_f32_16x16x32_bf16 v[152:155], v[24:27], v[100:103], v[152:155]
    ds_read_b128 v[56:59], v8 offset:18432
    v_mfma_f32_16x16x32_bf16 v[156:159], v[28:31], v[100:103], v[156:159]
    ds_read_b128 v[60:63], v8 offset:19456
    buffer_load_dwordx4 v[100:103], v4, s[8:11], s28 offen offset:256 sc1
    s_waitcnt vmcnt(15)
    v_mfma_f32_16x16x32_bf16 v[160:163], v[16:19], v[104:107], v[160:163]
    v_mfma_f32_16x16x32_bf16 v[164:167], v[20:23], v[104:107], v[164:167]
    v_mfma_f32_16x16x32_bf16 v[168:171], v[24:27], v[104:107], v[168:171]
    v_mfma_f32_16x16x32_bf16 v[172:175], v[28:31], v[104:107], v[172:175]
    buffer_load_dwordx4 v[104:107], v5, s[8:11], s28 offen offset:0 sc1
    s_waitcnt vmcnt(15)
    v_mfma_f32_16x16x32_bf16 v[176:179], v[16:19], v[108:111], v[176:179]
    v_mfma_f32_16x16x32_bf16 v[180:183], v[20:23], v[108:111], v[180:183]
    v_mfma_f32_16x16x32_bf16 v[184:187], v[24:27], v[108:111], v[184:187]
    v_mfma_f32_16x16x32_bf16 v[188:191], v[28:31], v[108:111], v[188:191]
    buffer_load_dwordx4 v[108:111], v5, s[8:11], s28 offen offset:256 sc1
    s_waitcnt vmcnt(15)
    v_mfma_f32_16x16x32_bf16 v[192:195], v[16:19], v[112:115], v[192:195]
    v_mfma_f32_16x16x32_bf16 v[196:199], v[20:23], v[112:115], v[196:199]
    v_mfma_f32_16x16x32_bf16 v[200:203], v[24:27], v[112:115], v[200:203]
    v_mfma_f32_16x16x32_bf16 v[204:207], v[28:31], v[112:115], v[204:207]
    buffer_load_dwordx4 v[112:115], v6, s[8:11], s28 offen offset:0 sc1
    s_waitcnt vmcnt(15)
    v_mfma_f32_16x16x32_bf16 v[208:211], v[16:19], v[116:119], v[208:211]
    v_mfma_f32_16x16x32_bf16 v[212:215], v[20:23], v[116:119], v[212:215]
    v_mfma_f32_16x16x32_bf16 v[216:219], v[24:27], v[116:119], v[216:219]
    v_mfma_f32_16x16x32_bf16 v[220:223], v[28:31], v[116:119], v[220:223]
    buffer_load_dwordx4 v[116:119], v6, s[8:11], s28 offen offset:256 sc1
    s_waitcnt vmcnt(15)
    v_mfma_f32_16x16x32_bf16 v[224:227], v[16:19], v[120:123], v[224:227]
    v_mfma_f32_16x16x32_bf16 v[228:231], v[20:23], v[120:123], v[228:231]
    v_mfma_f32_16x16x32_bf16 v[232:235], v[24:27], v[120:123], v[232:235]
    v_mfma_f32_16x16x32_bf16 v[236:239], v[28:31], v[120:123], v[236:239]
    buffer_load_dwordx4 v[120:123], v7, s[8:11], s28 offen offset:0 sc1
    s_waitcnt vmcnt(15)
    v_mfma_f32_16x16x32_bf16 v[240:243], v[16:19], v[124:127], v[240:243]
    v_mfma_f32_16x16x32_bf16 v[244:247], v[20:23], v[124:127], v[244:247]
    v_mfma_f32_16x16x32_bf16 v[248:251], v[24:27], v[124:127], v[248:251]
    v_mfma_f32_16x16x32_bf16 v[252:255], v[28:31], v[124:127], v[252:255]
    buffer_load_dwordx4 v[124:127], v7, s[8:11], s28 offen offset:256 sc1
    s_add_u32 s28, s28, 8192
    s_mov_b32 s16, s40
    s_mov_b32 s17, s41
    s_mov_b32 s18, 0x400000
    s_mov_b32 s19, 0x00020000
    s_mov_b32 s20, s54
    s_mov_b32 s21, s55
    s_mov_b32 s22, 0x800
    s_mov_b32 s23, 0x00020000
    s_mov_b32 s12, s56
    s_mov_b32 s13, s57
    s_mov_b32 s14, 0x400000
    s_mov_b32 s15, 0x00020000
    s_lshl_b32 s3, s36, 7
    s_lshl_b32 s35, s24, 4
    s_add_u32 s3, s3, s35
    s_lshl_b32 s3, s3, 11
    s_lshl_b32 s35, s37, 7
    s_add_u32 s3, s3, s35
    v_lshrrev_b32 v8, 3, v0
    v_lshlrev_b32 v9, 11, v8
    v_and_b32 v10, 7, v0
    v_lshl_add_u32 v9, v10, 4, v9
    v_add_u32 v9, s3, v9
    v_add_u32 v11, 16384, v9
    v_lshlrev_b32 v12, 4, v10
    buffer_load_dwordx4 v[16:19], v9, s[16:19], 0 offen
    buffer_load_dwordx4 v[20:23], v11, s[16:19], 0 offen
    buffer_load_dwordx4 v[24:27], v12, s[20:23], s35 offen
    s_mul_i32 s3, s24, 4352
    v_mul_u32_u24 v13, 272, v8
    v_lshl_add_u32 v13, v10, 5, v13
    v_add_u32 v13, s3, v13
    v_add_u32 v14, 69632, v13
    s_waitcnt lgkmcnt(0)
    s_barrier
    s_waitcnt vmcnt(18)
    v_mfma_f32_16x16x32_bf16 v[128:131], v[32:35], v[64:67], v[128:131]
    v_mfma_f32_16x16x32_bf16 v[132:135], v[36:39], v[64:67], v[132:135]
    v_mfma_f32_16x16x32_bf16 v[136:139], v[40:43], v[64:67], v[136:139]
    v_mfma_f32_16x16x32_bf16 v[140:143], v[44:47], v[64:67], v[140:143]
    s_waitcnt vmcnt(10)
    v_mfma_f32_16x16x32_bf16 v[128:131], v[48:51], v[96:99], v[128:131]
    v_mfma_f32_16x16x32_bf16 v[132:135], v[52:55], v[96:99], v[132:135]
    v_mfma_f32_16x16x32_bf16 v[136:139], v[56:59], v[96:99], v[136:139]
    v_mfma_f32_16x16x32_bf16 v[140:143], v[60:63], v[96:99], v[140:143]
    v_mfma_f32_16x16x32_bf16 v[144:147], v[32:35], v[68:71], v[144:147]
    v_mfma_f32_16x16x32_bf16 v[148:151], v[36:39], v[68:71], v[148:151]
    v_mfma_f32_16x16x32_bf16 v[152:155], v[40:43], v[68:71], v[152:155]
    v_mfma_f32_16x16x32_bf16 v[156:159], v[44:47], v[68:71], v[156:159]
    s_waitcnt vmcnt(9)
    v_mfma_f32_16x16x32_bf16 v[144:147], v[48:51], v[100:103], v[144:147]
    v_mfma_f32_16x16x32_bf16 v[148:151], v[52:55], v[100:103], v[148:151]
    v_mfma_f32_16x16x32_bf16 v[152:155], v[56:59], v[100:103], v[152:155]
    v_mfma_f32_16x16x32_bf16 v[156:159], v[60:63], v[100:103], v[156:159]
    v_mfma_f32_16x16x32_bf16 v[160:163], v[32:35], v[72:75], v[160:163]
    v_mfma_f32_16x16x32_bf16 v[164:167], v[36:39], v[72:75], v[164:167]
    ds_write_b128 v15, v[128:131] offset:0
    v_mfma_f32_16x16x32_bf16 v[168:171], v[40:43], v[72:75], v[168:171]
    v_mfma_f32_16x16x32_bf16 v[172:175], v[44:47], v[72:75], v[172:175]
    ds_write_b128 v15, v[132:135] offset:64
    s_waitcnt vmcnt(8)
    v_mfma_f32_16x16x32_bf16 v[160:163], v[48:51], v[104:107], v[160:163]
    v_mfma_f32_16x16x32_bf16 v[164:167], v[52:55], v[104:107], v[164:167]
    ds_write_b128 v15, v[136:139] offset:128
    v_mfma_f32_16x16x32_bf16 v[168:171], v[56:59], v[104:107], v[168:171]
    v_mfma_f32_16x16x32_bf16 v[172:175], v[60:63], v[104:107], v[172:175]
    ds_write_b128 v15, v[140:143] offset:192
    v_mfma_f32_16x16x32_bf16 v[176:179], v[32:35], v[76:79], v[176:179]
    v_mfma_f32_16x16x32_bf16 v[180:183], v[36:39], v[76:79], v[180:183]
    ds_write_b128 v15, v[144:147] offset:4352
    v_mfma_f32_16x16x32_bf16 v[184:187], v[40:43], v[76:79], v[184:187]
    v_mfma_f32_16x16x32_bf16 v[188:191], v[44:47], v[76:79], v[188:191]
    ds_write_b128 v15, v[148:151] offset:4416
    s_waitcnt vmcnt(7)
    v_mfma_f32_16x16x32_bf16 v[176:179], v[48:51], v[108:111], v[176:179]
    v_mfma_f32_16x16x32_bf16 v[180:183], v[52:55], v[108:111], v[180:183]
    ds_write_b128 v15, v[152:155] offset:4480
    v_mfma_f32_16x16x32_bf16 v[184:187], v[56:59], v[108:111], v[184:187]
    v_mfma_f32_16x16x32_bf16 v[188:191], v[60:63], v[108:111], v[188:191]
    ds_write_b128 v15, v[156:159] offset:4544
    v_mfma_f32_16x16x32_bf16 v[192:195], v[32:35], v[80:83], v[192:195]
    v_mfma_f32_16x16x32_bf16 v[196:199], v[36:39], v[80:83], v[196:199]
    ds_write_b128 v15, v[160:163] offset:8704
    v_mfma_f32_16x16x32_bf16 v[200:203], v[40:43], v[80:83], v[200:203]
    v_mfma_f32_16x16x32_bf16 v[204:207], v[44:47], v[80:83], v[204:207]
    ds_write_b128 v15, v[164:167] offset:8768
    s_waitcnt vmcnt(6)
    v_mfma_f32_16x16x32_bf16 v[192:195], v[48:51], v[112:115], v[192:195]
    v_mfma_f32_16x16x32_bf16 v[196:199], v[52:55], v[112:115], v[196:199]
    ds_write_b128 v15, v[168:171] offset:8832
    v_mfma_f32_16x16x32_bf16 v[200:203], v[56:59], v[112:115], v[200:203]
    v_mfma_f32_16x16x32_bf16 v[204:207], v[60:63], v[112:115], v[204:207]
    ds_write_b128 v15, v[172:175] offset:8896
    v_mfma_f32_16x16x32_bf16 v[208:211], v[32:35], v[84:87], v[208:211]
    v_mfma_f32_16x16x32_bf16 v[212:215], v[36:39], v[84:87], v[212:215]
    ds_write_b128 v15, v[176:179] offset:13056
    v_mfma_f32_16x16x32_bf16 v[216:219], v[40:43], v[84:87], v[216:219]
    v_mfma_f32_16x16x32_bf16 v[220:223], v[44:47], v[84:87], v[220:223]
    ds_write_b128 v15, v[180:183] offset:13120
    s_waitcnt vmcnt(5)
    v_mfma_f32_16x16x32_bf16 v[208:211], v[48:51], v[116:119], v[208:211]
    v_mfma_f32_16x16x32_bf16 v[212:215], v[52:55], v[116:119], v[212:215]
    ds_write_b128 v15, v[184:187] offset:13184
    v_mfma_f32_16x16x32_bf16 v[216:219], v[56:59], v[116:119], v[216:219]
    v_mfma_f32_16x16x32_bf16 v[220:223], v[60:63], v[116:119], v[220:223]
    ds_write_b128 v15, v[188:191] offset:13248
    v_mfma_f32_16x16x32_bf16 v[224:227], v[32:35], v[88:91], v[224:227]
    v_mfma_f32_16x16x32_bf16 v[228:231], v[36:39], v[88:91], v[228:231]
    ds_write_b128 v15, v[192:195] offset:17408
    v_mfma_f32_16x16x32_bf16 v[232:235], v[40:43], v[88:91], v[232:235]
    v_mfma_f32_16x16x32_bf16 v[236:239], v[44:47], v[88:91], v[236:239]
    ds_write_b128 v15, v[196:199] offset:17472
    s_waitcnt vmcnt(4)
    v_mfma_f32_16x16x32_bf16 v[224:227], v[48:51], v[120:123], v[224:227]
    v_mfma_f32_16x16x32_bf16 v[228:231], v[52:55], v[120:123], v[228:231]
    ds_write_b128 v15, v[200:203] offset:17536
    v_mfma_f32_16x16x32_bf16 v[232:235], v[56:59], v[120:123], v[232:235]
    v_mfma_f32_16x16x32_bf16 v[236:239], v[60:63], v[120:123], v[236:239]
    ds_write_b128 v15, v[204:207] offset:17600
    v_mfma_f32_16x16x32_bf16 v[240:243], v[32:35], v[92:95], v[240:243]
    v_mfma_f32_16x16x32_bf16 v[244:247], v[36:39], v[92:95], v[244:247]
    ds_write_b128 v15, v[208:211] offset:21760
    v_mfma_f32_16x16x32_bf16 v[248:251], v[40:43], v[92:95], v[248:251]
    v_mfma_f32_16x16x32_bf16 v[252:255], v[44:47], v[92:95], v[252:255]
    ds_write_b128 v15, v[212:215] offset:21824
    s_waitcnt vmcnt(3)
    v_mfma_f32_16x16x32_bf16 v[240:243], v[48:51], v[124:127], v[240:243]
    v_mfma_f32_16x16x32_bf16 v[244:247], v[52:55], v[124:127], v[244:247]
    ds_write_b128 v15, v[216:219] offset:21888
    v_mfma_f32_16x16x32_bf16 v[248:251], v[56:59], v[124:127], v[248:251]
    v_mfma_f32_16x16x32_bf16 v[252:255], v[60:63], v[124:127], v[252:255]
    ds_write_b128 v15, v[220:223] offset:21952
    ds_write_b128 v15, v[224:227] offset:26112
    ds_write_b128 v15, v[228:231] offset:26176
    ds_write_b128 v15, v[232:235] offset:26240
    ds_write_b128 v15, v[236:239] offset:26304
    s_nop 3
    ds_write_b128 v15, v[240:243] offset:30464
    ds_write_b128 v15, v[244:247] offset:30528
    ds_write_b128 v15, v[248:251] offset:30592
    ds_write_b128 v15, v[252:255] offset:30656
    s_branch mk_final
mk_final_a:
    s_and_b32 s3, s2, 7
    s_lshr_b32 s5, s2, 3
    s_lshr_b32 s36, s3, 1
    s_lshl_b32 s36, s36, 2
    s_and_b32 s4, s5, 3
    s_add_u32 s36, s36, s4
    s_and_b32 s37, s3, 1
    s_lshl_b32 s37, s37, 3
    s_lshr_b32 s4, s5, 2
    s_add_u32 s37, s37, s4
    s_mov_b32 s16, s40
    s_mov_b32 s17, s41
    s_mov_b32 s18, 0x400000
    s_mov_b32 s19, 0x00020000
    s_mov_b32 s20, s54
    s_mov_b32 s21, s55
    s_mov_b32 s22, 0x800
    s_mov_b32 s23, 0x00020000
    s_mov_b32 s12, s56
    s_mov_b32 s13, s57
    s_mov_b32 s14, 0x400000
    s_mov_b32 s15, 0x00020000
    s_lshl_b32 s3, s36, 7
    s_lshl_b32 s35, s24, 4
    s_add_u32 s3, s3, s35
    s_lshl_b32 s3, s3, 11
    s_lshl_b32 s35, s37, 7
    s_add_u32 s3, s3, s35
    v_lshrrev_b32 v8, 3, v0
    v_lshlrev_b32 v9, 11, v8
    v_and_b32 v10, 7, v0
    v_lshl_add_u32 v9, v10, 4, v9
    v_add_u32 v9, s3, v9
    v_add_u32 v11, 16384, v9
    v_lshlrev_b32 v12, 4, v10
    buffer_load_dwordx4 v[16:19], v9, s[16:19], 0 offen
    buffer_load_dwordx4 v[20:23], v11, s[16:19], 0 offen
    buffer_load_dwordx4 v[24:27], v12, s[20:23], s35 offen
    s_mul_i32 s3, s24, 4352
    v_mul_u32_u24 v13, 272, v8
    v_lshl_add_u32 v13, v10, 5, v13
    v_add_u32 v13, s3, v13
    v_add_u32 v14, 69632, v13
    s_barrier
mk_final:
    s_waitcnt lgkmcnt(0)
    s_barrier
    ds_read_b128 v[64:67], v13 offset:0
    ds_read_b128 v[68:71], v13 offset:16
    ds_read_b128 v[72:75], v13 offset:34816
    ds_read_b128 v[76:79], v13 offset:34832
    ds_read_b128 v[80:83], v14 offset:0
    ds_read_b128 v[84:87], v14 offset:16
    ds_read_b128 v[88:91], v14 offset:34816
    ds_read_b128 v[92:95], v14 offset:34832
    ds_read_b128 v[96:99], v13 offset:2176
    ds_read_b128 v[100:103], v13 offset:2192
    ds_read_b128 v[104:107], v13 offset:36992
    ds_read_b128 v[108:111], v13 offset:37008
    ds_read_b128 v[112:115], v14 offset:2176
    ds_read_b128 v[116:119], v14 offset:2192
    ds_read_b128 v[120:123], v14 offset:36992
    ds_read_b128 v[124:127], v14 offset:37008
    s_waitcnt vmcnt(0)
    v_lshlrev_b32 v44, 16, v24
    v_and_b32 v45, 0xffff0000, v24
    v_lshlrev_b32 v46, 16, v25
    v_and_b32 v47, 0xffff0000, v25
    v_lshlrev_b32 v48, 16, v26
    v_and_b32 v49, 0xffff0000, v26
    v_lshlrev_b32 v50, 16, v27
    v_and_b32 v51, 0xffff0000, v27
    v_lshlrev_b32 v52, 16, v16
    v_and_b32 v53, 0xffff0000, v16
    v_lshlrev_b32 v54, 16, v17
    v_and_b32 v55, 0xffff0000, v17
    v_lshlrev_b32 v56, 16, v18
    v_and_b32 v57, 0xffff0000, v18
    v_lshlrev_b32 v58, 16, v19
    v_and_b32 v59, 0xffff0000, v19
    v_add_f32 v52, v52, v44
    v_add_f32 v53, v53, v45
    v_add_f32 v54, v54, v46
    v_add_f32 v55, v55, v47
    v_add_f32 v56, v56, v48
    v_add_f32 v57, v57, v49
    v_add_f32 v58, v58, v50
    v_add_f32 v59, v59, v51
    s_waitcnt lgkmcnt(8)
    v_add_f32 v64, v64, v72
    v_add_f32 v65, v65, v73
    v_add_f32 v66, v66, v74
    v_add_f32 v67, v67, v75
    v_add_f32 v68, v68, v76
    v_add_f32 v69, v69, v77
    v_add_f32 v70, v70, v78
    v_add_f32 v71, v71, v79
    v_add_f32 v80, v80, v88
    v_add_f32 v81, v81, v89
    v_add_f32 v82, v82, v90
    v_add_f32 v83, v83, v91
    v_add_f32 v84, v84, v92
    v_add_f32 v85, v85, v93
    v_add_f32 v86, v86, v94
    v_add_f32 v87, v87, v95
    v_add_f32 v52, v52, v64
    v_add_f32 v53, v53, v65
    v_add_f32 v54, v54, v66
    v_add_f32 v55, v55, v67
    v_add_f32 v56, v56, v68
    v_add_f32 v57, v57, v69
    v_add_f32 v58, v58, v70
    v_add_f32 v59, v59, v71
    v_add_f32 v52, v52, v80
    v_add_f32 v53, v53, v81
    v_add_f32 v54, v54, v82
    v_add_f32 v55, v55, v83
    v_add_f32 v56, v56, v84
    v_add_f32 v57, v57, v85
    v_add_f32 v58, v58, v86
    v_add_f32 v59, v59, v87
    v_cvt_pk_bf16_f32 v32, v52, v53
    v_cvt_pk_bf16_f32 v33, v54, v55
    v_cvt_pk_bf16_f32 v34, v56, v57
    v_cvt_pk_bf16_f32 v35, v58, v59
    buffer_store_dwordx4 v[32:35], v9, s[12:15], 0 offen sc1
    v_lshlrev_b32 v52, 16, v20
    v_and_b32 v53, 0xffff0000, v20
    v_lshlrev_b32 v54, 16, v21
    v_and_b32 v55, 0xffff0000, v21
    v_lshlrev_b32 v56, 16, v22
    v_and_b32 v57, 0xffff0000, v22
    v_lshlrev_b32 v58, 16, v23
    v_and_b32 v59, 0xffff0000, v23
    v_add_f32 v52, v52, v44
    v_add_f32 v53, v53, v45
    v_add_f32 v54, v54, v46
    v_add_f32 v55, v55, v47
    v_add_f32 v56, v56, v48
    v_add_f32 v57, v57, v49
    v_add_f32 v58, v58, v50
    v_add_f32 v59, v59, v51
    s_waitcnt lgkmcnt(0)
    v_add_f32 v96, v96, v104
    v_add_f32 v97, v97, v105
    v_add_f32 v98, v98, v106
    v_add_f32 v99, v99, v107
    v_add_f32 v100, v100, v108
    v_add_f32 v101, v101, v109
    v_add_f32 v102, v102, v110
    v_add_f32 v103, v103, v111
    v_add_f32 v112, v112, v120
    v_add_f32 v113, v113, v121
    v_add_f32 v114, v114, v122
    v_add_f32 v115, v115, v123
    v_add_f32 v116, v116, v124
    v_add_f32 v117, v117, v125
    v_add_f32 v118, v118, v126
    v_add_f32 v119, v119, v127
    v_add_f32 v52, v52, v96
    v_add_f32 v53, v53, v97
    v_add_f32 v54, v54, v98
    v_add_f32 v55, v55, v99
    v_add_f32 v56, v56, v100
    v_add_f32 v57, v57, v101
    v_add_f32 v58, v58, v102
    v_add_f32 v59, v59, v103
    v_add_f32 v52, v52, v112
    v_add_f32 v53, v53, v113
    v_add_f32 v54, v54, v114
    v_add_f32 v55, v55, v115
    v_add_f32 v56, v56, v116
    v_add_f32 v57, v57, v117
    v_add_f32 v58, v58, v118
    v_add_f32 v59, v59, v119
    v_cvt_pk_bf16_f32 v36, v52, v53
    v_cvt_pk_bf16_f32 v37, v54, v55
    v_cvt_pk_bf16_f32 v38, v56, v57
    v_cvt_pk_bf16_f32 v39, v58, v59
    buffer_store_dwordx4 v[36:39], v11, s[12:15], 0 offen sc1
    s_or_b32 s3, s2, s24
    s_cmp_lg_u32 s3, 0
    s_cbranch_scc1 mk_noep
    s_mov_b32 s3, 50331648
    v_mov_b32 v16, s25
    v_mov_b32 v17, 0
    s_mov_b64 exec, 1
    buffer_store_dword v16, v17, s[8:11], s3 offen sc1
    s_mov_b64 exec, -1
mk_noep:
mk_end:
    s_endpgm
mk_code1:

.section .rodata,"a"
.p2align 6
.amdhsa_kernel parallel_sum__softmax_full_mha__dense_activation_gelu__prompt_kernel
  .amdhsa_next_free_vgpr 256
  .amdhsa_next_free_sgpr 102
  .amdhsa_accum_offset 256
  .amdhsa_group_segment_fixed_size 0
  .amdhsa_kernarg_size 88
  .amdhsa_user_sgpr_count 2
  .amdhsa_user_sgpr_kernarg_segment_ptr 1
  .amdhsa_system_sgpr_workgroup_id_x 1
  .amdhsa_float_denorm_mode_32 3
.end_amdhsa_kernel
```
